```python
import torch

def _softmax(x, axis=-1):
    return torch.softmax(x, dim=axis)
def _gelu(x):
    return torch.nn.functional.gelu(x, approximate="tanh")
def _silu(x):
    return torch.nn.functional.silu(x)
def _sigmoid(x):
    return torch.sigmoid(x)
def _layernorm(x, axis=-1, eps=1e-5):
    m = x.mean(dim=axis, keepdim=True)
    v = x.var(dim=axis, keepdim=True, unbiased=False)
    return (x - m) / torch.sqrt(v + eps)
def _scatter_add(tgt, idx, src, axis=0):
    return tgt.clone().index_add_(axis, idx, src)
def _segment_sum(src, seg, n):
    out = torch.zeros((n,) + src.shape[1:], dtype=src.dtype)
    return out.index_add_(0, seg, src)
def _pad(x, pw):
    flat = tuple(v for pair in reversed(pw) for v in pair)
    return torch.nn.functional.pad(x, flat)

kernel_name = 'sequential_preLN__ssm_conv_s4d__dense_activation_squared_relu__prompt'

def setup_inputs():

    _w = (lambda a: (lambda t: t.to(torch.bfloat16) if t.is_floating_point() else t)(torch.as_tensor(a)))
    def _A_setup():
        Bsz, L, D, N = 1, 2048, 576, 128
        return {
            "u": _w((lambda *s: torch.randn(*s, dtype=torch.bfloat16) * 0.05)(Bsz, L, D)),
            "log_A_real": _w((lambda *s: torch.randn(*s, dtype=torch.bfloat16) * 3.2)(D, N) * 0.5),
            "A_imag": _w((lambda *s: torch.randn(*s, dtype=torch.bfloat16) * 0.05)(D, N) * 3.14),
            "C_real": _w((lambda *s: torch.randn(*s, dtype=torch.bfloat16) * 0.1)(D, N) / N ** 0.5),
            "C_imag": _w((lambda *s: torch.randn(*s, dtype=torch.bfloat16) * 0.1)(D, N) / N ** 0.5),
            "log_dt": _w((lambda *s: torch.randn(*s, dtype=torch.bfloat16) * 0.05)(D) * 0.5 - 4.0),
            "D_skip": _w((lambda *s: torch.randn(*s, dtype=torch.bfloat16) * 0.05)(D)),
        }
    _A_in = _A_setup()

    def _B_setup():
        B, S, D, F = 1, 2048, 576, 4608
        return {
            "x": _w((lambda *s: torch.randn(*s, dtype=torch.bfloat16) * 0.05)(B, S, D)),
            "w1": _w((lambda *s: torch.randn(*s, dtype=torch.bfloat16) * 0.05)(D, F)),
            "b1": _w((lambda *s: torch.randn(*s, dtype=torch.bfloat16) * 0.2)(F)),
            "w2": _w((lambda *s: torch.randn(*s, dtype=torch.bfloat16) * 0.05)(F, D)),
            "b2": _w((lambda *s: torch.randn(*s, dtype=torch.bfloat16) * 1.6)(D)),
        }
    _B_in = _B_setup()

    return {
        "A_u": _A_in["u"],
        "A_log_A_real": _A_in["log_A_real"],
        "A_A_imag": _A_in["A_imag"],
        "A_C_real": _A_in["C_real"],
        "A_C_imag": _A_in["C_imag"],
        "A_log_dt": _A_in["log_dt"],
        "A_D_skip": _A_in["D_skip"],
        "B_x": _B_in["x"],
        "B_w1": _B_in["w1"],
        "B_b1": _B_in["b1"],
        "B_w2": _B_in["w2"],
        "B_b2": _B_in["b2"],
    }

def reference(A_u, A_log_A_real, A_A_imag, A_C_real, A_C_imag, A_log_dt, A_D_skip, B_x, B_w1, B_b1, B_w2, B_b2):
    def _A_ref(u, log_A_real, A_imag, C_real, C_imag, log_dt, D_skip):
        L = u.shape[1]
        dt = torch.exp(log_dt)
        A = -torch.exp(log_A_real) + 1j * A_imag
        C = (C_real + 1j * C_imag) * dt[:, None]
        pos = (lambda x, dt: x.to(dt))(torch.arange(L), log_dt.dtype)
        P = torch.exp((A * dt[:, None])[:, :, None] * pos[None, None, :])
        K = 2.0 * torch.einsum("dn,dnl->dl", C, P).real
        L2 = 2 * L
        u_t = (lambda x, *d: x.permute(*d))(u, 0, 2, 1)
        Kf = (lambda x, *a, **k: torch.fft.rfft(x.float(), *a, **k))(K, L2)
        Uf = (lambda x, *a, **k: torch.fft.rfft(x.float(), *a, **k))(u_t, L2)
        y = (lambda x, *a, **k: torch.fft.irfft(x, *a, **k).to(torch.bfloat16))(Uf * Kf[None, :, :], L2)[:, :, :L]
        y = (lambda x, *d: x.permute(*d))(y, 0, 2, 1)
        return y + u * D_skip[None, None, :]

    def _B_ref(x, w1, b1, w2, b2):
        h = torch.einsum("bsd,df->bsf", x, w1) + b1
        zero = torch.zeros_like(h)
        r = torch.where(h > zero, h, zero)
        h = r * r
        out = torch.einsum("bsf,fd->bsd", h, w2) + b2
        return out

    x = A_u
    h = x + _A_ref(_layernorm(x, axis=-1), A_log_A_real, A_A_imag, A_C_real, A_C_imag, A_log_dt, A_D_skip)
    h2 = h + _B_ref(_layernorm(h, axis=-1), B_w1, B_b1, B_w2, B_b2)
    return h2
```

```asm
; @launch grid=(256,1,1) block=(256,1,1) lds=161792
.amdgcn_target "amdgcn-amd-amdhsa--gfx950"
.text
.globl sequential_preLN__ssm_conv_s4d__dense_activation_squared_relu__prompt_kernel
.p2align 8
.type sequential_preLN__ssm_conv_s4d__dense_activation_squared_relu__prompt_kernel,@function
sequential_preLN__ssm_conv_s4d__dense_activation_squared_relu__prompt_kernel:
LF_codestart:
s_load_dwordx2 s[56:57], s[0:1], 0
s_load_dwordx16 s[16:31], s[0:1], 0
s_load_dwordx8 s[36:43], s[0:1], 64
s_load_dwordx2 s[44:45], s[0:1], 96
s_load_dwordx2 s[8:9], s[0:1], 112
s_cmp_ge_u32 s2, 256
s_cbranch_scc1 L3_end
s_getpc_b64 s[32:33]
LF_pc:
v_lshlrev_b32 v3, 7, v0
v_min_u32 v3, LF_codeend-LF_pc-4, v3
global_load_dword v255, v3, s[32:33]
s_mov_b32 s58, 2359296
s_mov_b32 s59, 0x20000
s_mul_i32 s35, s2, 9216
v_lshrrev_b32 v3, 5, v0
v_and_b32 v4, 31, v0
v_mul_u32_u24 v5, 1152, v3
v_lshl_add_u32 v6, v4, 4, v5
v_lshl_add_u32 v7, v4, 2, v5
s_and_b32 s4, s2, 7
s_lshr_b32 s5, s2, 3
s_mul_i32 s6, s4, 18
s_add_u32 s6, s6, s5
s_lshl_b32 s14, s6, 10
v_lshl_add_u32 v200, v0, 2, s14
v_lshrrev_b32 v201, 7, v200
v_and_b32 v201, -2, v201
s_waitcnt lgkmcnt(0)
buffer_load_dwordx4 v[112:115], v6, s[56:59], s35 offen nt
buffer_load_dwordx4 v[116:119], v6, s[56:59], s35 offen offset:512 nt
buffer_load_dword v120, v7, s[56:59], s35 offen offset:1024 nt
s_cmp_ge_u32 s5, 18
s_cbranch_scc1 LF_help
global_load_dword v202, v200, s[18:19]
global_load_dword v203, v200, s[20:21]
global_load_ushort v206, v201, s[26:27]
global_load_dword v204, v200, s[22:23]
global_load_dword v205, v200, s[24:25]
global_load_ushort v207, v201, s[28:29]
s_add_u32 s46, s8, 44449792
s_addc_u32 s47, s9, 0
s_load_dword s12, s[46:47], 0
v_lshrrev_b32 v1, 6, v0
v_and_b32 v2, 63, v0
s_mov_b32 s10, 268435456
v_readfirstlane_b32 s3, v1
s_mov_b32 s11, 0x20000
v_lshlrev_b32 v210, 4, v0
v_mov_b32 v251, 0
s_lshl_b32 s34, s3, 10
s_mov_b32 s62, 5308416
s_mov_b32 s63, 0x20000
s_add_u32 s32, s32, T_w-LF_pc
s_addc_u32 s33, s33, 0
s_lshl_b32 s15, s2, 5
s_add_u32 s15, s15, 47054848
s_mul_i32 s13, s2, 18560
s_add_u32 s13, s13, 53489664
v_mul_u32_u24 v5, 2368, v3
v_add_u32 v5, 129024, v5
v_lshl_add_u32 v216, v4, 5, v5
v_lshl_add_u32 v217, v4, 3, v5
v_bfe_u32 v3, v2, 2, 2
v_mul_u32_u24 v3, 2368, v3
v_lshrrev_b32 v4, 4, v0
v_lshl_add_u32 v3, v4, 5, v3
v_and_b32 v4, 3, v2
v_lshl_add_u32 v3, v4, 3, v3
v_add_u32 v218, 129024, v3
v_cmp_gt_u32 vcc, 128, v0
v_mov_b32 v211, 0x40000000
s_nop 0
v_cndmask_b32 v211, v211, v210, vcc
s_mul_i32 s14, s3, 32208
v_lshl_add_u32 v3, v2, 3, s14
s_mov_b32 s64, 0x3fb8aa3b
s_mov_b32 s65, 0x3e22f983
v_lshrrev_b32 v4, 3, v2
v_and_b32 v5, 7, v2
v_lshl_add_u32 v4, v4, 5, v5
v_lshlrev_b32 v214, 5, v4
s_lshl_b32 s48, s3, 8
s_add_u32 s48, s48, 47054848
s_and_b32 s49, s2, 7
s_mul_i32 s49, s49, 8320
s_add_u32 s48, s48, s49
v_lshrrev_b32 v215, 3, v0
v_mul_u32_u24 v215, 18560, v215
v_lshrrev_b32 v4, 4, v0
v_xor_b32 v4, v4, v0
v_and_b32 v4, 7, v4
v_lshl_add_u32 v215, v4, 4, v215
s_lshl_b32 s49, s6, 7
s_add_u32 s49, s49, 53489664
v_and_b32 v5, 31, v2
v_mul_u32_u24 v6, 528, v5
v_lshrrev_b32 v7, 5, v2
v_lshl_add_u32 v6, v7, 4, v6
v_add_u32 v219, s14, v6
v_cmp_lt_u32 vcc, 27, v5
v_subrev_u32 v6, 7920, v219
v_cmp_eq_u32 s[52:53], 31, v5
v_cndmask_b32 v6, v219, v6, vcc
v_subrev_u32 v7, 5808, v219
v_cndmask_b32 v6, v6, v7, s[52:53]
s_mul_i32 s14, s3, 33792
v_and_b32 v7, 1, v2
v_lshlrev_b32 v7, 9, v7
v_and_b32 v8, 30, v2
v_sub_u32 v7, v7, v8
v_and_b32 v8, 32, v2
v_lshlrev_b32 v8, 1, v8
v_sub_u32 v7, v7, v8
s_add_u32 s52, s34, 118366
v_add_u32 v222, s52, v7
s_add_u32 s52, s34, 118272
v_lshl_add_u32 v223, v2, 4, s52
v_sub_u32 v5, 131, v5
v_lshl_add_u32 v5, v5, 4, s14
v_cmp_lt_u32 vcc, 31, v2
v_mov_b32 v7, 0
v_mov_b32 v8, 512
v_cndmask_b32 v7, v7, v8, vcc
v_sub_u32 v220, v5, v7
v_mov_b32 v7, 1024
v_mov_b32 v8, 1536
v_cndmask_b32 v7, v7, v8, vcc
v_sub_u32 v221, v5, v7
v_and_b32 v7, 1, v2
v_lshlrev_b32 v7, 4, v7
v_add_u32 v7, 2112, v7
v_and_b32 v8, 3, v2
v_lshlrev_b32 v8, 4, v8
v_cmp_gt_u32 vcc, 4, v2
v_cmp_eq_u32 s[54:55], 0, v2
v_add_u32 v9, 6, v2
v_cndmask_b32 v7, v8, v7, vcc
v_add_u32 v9, -2, v2
v_cmp_ge_u32 vcc, 5, v9
v_add_u32 v8, 4176, v7
v_cmp_eq_u32 s[52:53], 7, v2
v_cndmask_b32 v7, v7, v8, vcc
v_add_u32 v224, s14, v7
v_mov_b32 v7, 0xffff0000
v_cndmask_b32 v225, 0, v7, s[52:53]
v_cmp_eq_u32 vcc, 11, v2
s_or_b64 vcc, vcc, s[52:53]
s_nop 1
v_cndmask_b32 v226, 0, -1, vcc
v_add_u32 v232, 0, v3
v_add_u32 v233, 2112, v3
v_add_u32 v234, 4224, v3
v_add_u32 v235, 6336, v3
v_add_u32 v236, 8448, v3
v_add_u32 v237, 10560, v3
v_add_u32 v238, 12672, v3
v_add_u32 v239, 14784, v3
v_add_u32 v240, 16896, v3
v_add_u32 v241, 19008, v3
v_add_u32 v242, 21120, v3
v_add_u32 v243, 23232, v3
v_add_u32 v244, 25344, v3
v_add_u32 v245, 27456, v3
v_add_u32 v246, 29568, v3
s_mov_b64 exec, 0
s_cmp_eq_u32 s3, 0
s_cbranch_scc1 FPAD0
s_cmp_eq_u32 s3, 1
s_cbranch_scc1 FPAD1
s_cmp_eq_u32 s3, 2
s_cbranch_scc1 FPAD2
s_branch FPAD_ret
FPAD_ret:
s_mov_b64 exec, -1
s_waitcnt vmcnt(6)
v_lshlrev_b32 v122, 16, v112
v_and_b32 v123, 0xffff0000, v112
v_lshlrev_b32 v124, 16, v113
v_and_b32 v125, 0xffff0000, v113
v_lshlrev_b32 v126, 16, v114
v_and_b32 v127, 0xffff0000, v114
v_lshlrev_b32 v128, 16, v115
v_and_b32 v129, 0xffff0000, v115
v_lshlrev_b32 v130, 16, v116
v_and_b32 v131, 0xffff0000, v116
v_lshlrev_b32 v132, 16, v117
v_and_b32 v133, 0xffff0000, v117
v_lshlrev_b32 v134, 16, v118
v_and_b32 v135, 0xffff0000, v118
v_lshlrev_b32 v136, 16, v119
v_and_b32 v137, 0xffff0000, v119
v_lshlrev_b32 v138, 16, v120
v_and_b32 v139, 0xffff0000, v120
v_pk_mul_f32 v[144:145], v[122:123], v[122:123]
v_pk_add_f32 v[140:141], v[122:123], v[124:125]
v_pk_fma_f32 v[144:145], v[124:125], v[124:125], v[144:145]
v_pk_add_f32 v[140:141], v[140:141], v[126:127]
v_pk_fma_f32 v[144:145], v[126:127], v[126:127], v[144:145]
v_pk_add_f32 v[140:141], v[140:141], v[128:129]
v_pk_fma_f32 v[144:145], v[128:129], v[128:129], v[144:145]
v_pk_add_f32 v[140:141], v[140:141], v[130:131]
v_pk_fma_f32 v[144:145], v[130:131], v[130:131], v[144:145]
v_pk_add_f32 v[140:141], v[140:141], v[132:133]
v_pk_fma_f32 v[144:145], v[132:133], v[132:133], v[144:145]
v_pk_add_f32 v[140:141], v[140:141], v[134:135]
v_pk_fma_f32 v[144:145], v[134:135], v[134:135], v[144:145]
v_pk_add_f32 v[140:141], v[140:141], v[136:137]
v_pk_fma_f32 v[144:145], v[136:137], v[136:137], v[144:145]
v_pk_add_f32 v[140:141], v[140:141], v[138:139]
v_pk_fma_f32 v[144:145], v[138:139], v[138:139], v[144:145]
s_waitcnt vmcnt(0)
v_add_f32 v140, v140, v141
v_lshlrev_b32 v14, 16, v202
v_add_f32 v144, v144, v145
v_and_b32 v15, 0xffff0000, v202
v_add_f32 v140, v140, v140 row_ror:8
v_lshlrev_b32 v12, 16, v206
v_add_f32 v144, v144, v144 row_ror:8
v_lshlrev_b32 v16, 16, v203
v_add_f32 v140, v140, v140 row_ror:4
v_and_b32 v17, 0xffff0000, v203
v_add_f32 v144, v144, v144 row_ror:4
v_mul_f32 v14, s64, v14
v_add_f32 v140, v140, v140 row_ror:2
v_mul_f32 v15, s64, v15
v_add_f32 v144, v144, v144 row_ror:2
v_mul_f32 v12, s64, v12
v_add_f32 v140, v140, v140 row_ror:1
v_exp_f32 v14, v14
v_add_f32 v144, v144, v144 row_ror:1
v_exp_f32 v15, v15
v_mov_b32 v141, v140
v_exp_f32 v12, v12
v_mov_b32 v145, v144
v_lshlrev_b32 v250, 16, v207
v_permlane16_swap_b32 v140, v141
v_cvt_pk_bf16_f32 v15, v14, v15
v_permlane16_swap_b32 v144, v145
v_cvt_pk_bf16_f32 v12, v12, v12
v_add_f32 v140, v140, v141
v_lshlrev_b32 v14, 16, v15
v_add_f32 v144, v144, v145
v_and_b32 v15, 0xffff0000, v15
v_mul_f32 v140, 0x3ae38e39, v140
v_lshlrev_b32 v12, 16, v12
v_mul_f32 v144, 0x3ae38e39, v144
v_pk_mul_f32 v[14:15], v[14:15], v[12:13] op_sel_hi:[1,0]
v_fma_f32 v144, -v140, v140, v144
v_pk_mul_f32 v[16:17], v[16:17], v[12:13] op_sel_hi:[1,0]
v_max_f32 v144, 0, v144
v_mul_f32 v14, s64, v14
v_cvt_pk_bf16_f32 v144, v144, v140
v_mul_f32 v15, s64, v15
v_and_b32 v140, 0xffff0000, v144
v_mul_f32 v16, s65, v16
v_lshlrev_b32 v144, 16, v144
v_mul_f32 v17, s65, v17
v_add_f32 v144, 0x3727c5ac, v144
v_mul_f32 v72, 0x41000000, v14
v_cvt_pk_bf16_f32 v144, v144, v144
v_lshlrev_b32 v144, 16, v144
v_sqrt_f32 v144, v144
v_pk_add_f32 v[148:149], v[122:123], v[140:141] op_sel_hi:[1,0] neg_lo:[0,1] neg_hi:[0,1]
v_cvt_pk_bf16_f32 v144, v144, v144
v_lshlrev_b32 v144, 16, v144
v_rcp_f32 v144, v144
v_pk_add_f32 v[150:151], v[124:125], v[140:141] op_sel_hi:[1,0] neg_lo:[0,1] neg_hi:[0,1]
v_pk_add_f32 v[152:153], v[126:127], v[140:141] op_sel_hi:[1,0] neg_lo:[0,1] neg_hi:[0,1]
v_pk_add_f32 v[154:155], v[128:129], v[140:141] op_sel_hi:[1,0] neg_lo:[0,1] neg_hi:[0,1]
v_pk_add_f32 v[156:157], v[130:131], v[140:141] op_sel_hi:[1,0] neg_lo:[0,1] neg_hi:[0,1]
v_pk_add_f32 v[158:159], v[132:133], v[140:141] op_sel_hi:[1,0] neg_lo:[0,1] neg_hi:[0,1]
v_pk_add_f32 v[160:161], v[134:135], v[140:141] op_sel_hi:[1,0] neg_lo:[0,1] neg_hi:[0,1]
v_pk_add_f32 v[162:163], v[136:137], v[140:141] op_sel_hi:[1,0] neg_lo:[0,1] neg_hi:[0,1]
v_pk_add_f32 v[164:165], v[138:139], v[140:141] op_sel_hi:[1,0] neg_lo:[0,1] neg_hi:[0,1]
v_cvt_pk_bf16_f32 v149, v148, v149
v_cvt_pk_bf16_f32 v151, v150, v151
v_cvt_pk_bf16_f32 v153, v152, v153
v_cvt_pk_bf16_f32 v155, v154, v155
v_cvt_pk_bf16_f32 v157, v156, v157
v_cvt_pk_bf16_f32 v159, v158, v159
v_cvt_pk_bf16_f32 v161, v160, v161
v_cvt_pk_bf16_f32 v163, v162, v163
v_cvt_pk_bf16_f32 v165, v164, v165
v_lshlrev_b32 v148, 16, v149
v_and_b32 v149, 0xffff0000, v149
v_lshlrev_b32 v150, 16, v151
v_and_b32 v151, 0xffff0000, v151
v_lshlrev_b32 v152, 16, v153
v_and_b32 v153, 0xffff0000, v153
v_lshlrev_b32 v154, 16, v155
v_and_b32 v155, 0xffff0000, v155
v_lshlrev_b32 v156, 16, v157
v_and_b32 v157, 0xffff0000, v157
v_lshlrev_b32 v158, 16, v159
v_and_b32 v159, 0xffff0000, v159
v_lshlrev_b32 v160, 16, v161
v_and_b32 v161, 0xffff0000, v161
v_lshlrev_b32 v162, 16, v163
v_and_b32 v163, 0xffff0000, v163
v_lshlrev_b32 v164, 16, v165
v_and_b32 v165, 0xffff0000, v165
v_pk_mul_f32 v[148:149], v[148:149], v[144:145] op_sel_hi:[1,0]
v_pk_mul_f32 v[150:151], v[150:151], v[144:145] op_sel_hi:[1,0]
v_pk_mul_f32 v[152:153], v[152:153], v[144:145] op_sel_hi:[1,0]
v_pk_mul_f32 v[154:155], v[154:155], v[144:145] op_sel_hi:[1,0]
v_pk_mul_f32 v[156:157], v[156:157], v[144:145] op_sel_hi:[1,0]
v_pk_mul_f32 v[158:159], v[158:159], v[144:145] op_sel_hi:[1,0]
v_pk_mul_f32 v[160:161], v[160:161], v[144:145] op_sel_hi:[1,0]
v_pk_mul_f32 v[162:163], v[162:163], v[144:145] op_sel_hi:[1,0]
v_pk_mul_f32 v[164:165], v[164:165], v[144:145] op_sel_hi:[1,0]
v_cvt_pk_bf16_f32 v148, v148, v122
v_cvt_pk_bf16_f32 v149, v149, v123
v_cvt_pk_bf16_f32 v150, v150, v124
v_cvt_pk_bf16_f32 v151, v151, v125
ds_write_b128 v216, v[148:151] offset:0
v_cvt_pk_bf16_f32 v152, v152, v126
v_cvt_pk_bf16_f32 v153, v153, v127
v_cvt_pk_bf16_f32 v154, v154, v128
v_cvt_pk_bf16_f32 v155, v155, v129
ds_write_b128 v216, v[152:155] offset:16
v_cvt_pk_bf16_f32 v156, v156, v130
v_cvt_pk_bf16_f32 v157, v157, v131
v_cvt_pk_bf16_f32 v158, v158, v132
v_cvt_pk_bf16_f32 v159, v159, v133
ds_write_b128 v216, v[156:159] offset:1024
v_cvt_pk_bf16_f32 v160, v160, v134
v_cvt_pk_bf16_f32 v161, v161, v135
v_cvt_pk_bf16_f32 v162, v162, v136
v_cvt_pk_bf16_f32 v163, v163, v137
ds_write_b128 v216, v[160:163] offset:1040
v_cvt_pk_bf16_f32 v164, v164, v138
v_cvt_pk_bf16_f32 v165, v165, v139
ds_write_b64 v217, v[164:165] offset:2048
v_mul_f32 v80, 0x43000000, v14
v_mul_f32 v88, 0x3f800000, v14
v_mul_f32 v96, 0x43800000, v14
v_mul_f32 v74, 0x41000000, v15
v_mul_f32 v82, 0x43000000, v15
v_mul_f32 v90, 0x3f800000, v15
v_mul_f32 v98, 0x43800000, v15
v_mul_f32 v73, 0x41000000, v16
v_mul_f32 v81, 0x43000000, v16
v_mul_f32 v89, 0x3f800000, v16
s_waitcnt lgkmcnt(0)
s_barrier
ds_read_b64_tr_b16 v[176:177], v218 offset:0
ds_read_b64_tr_b16 v[178:179], v218 offset:9472
ds_read_b64_tr_b16 v[180:181], v218 offset:512
ds_read_b64_tr_b16 v[182:183], v218 offset:9984
ds_read_b64_tr_b16 v[184:185], v218 offset:1024
ds_read_b64_tr_b16 v[186:187], v218 offset:10496
ds_read_b64_tr_b16 v[188:189], v218 offset:1536
ds_read_b64_tr_b16 v[190:191], v218 offset:11008
ds_read_b64_tr_b16 v[192:193], v218 offset:2048
ds_read_b64_tr_b16 v[194:195], v218 offset:11520
s_mul_i32 s12, s12, 0x9e3779b1
s_add_u32 s12, s12, 0x7f4a7c15
v_mov_b32 v212, s12
v_mul_f32 v97, 0x43800000, v16
v_mul_f32 v75, 0x41000000, v17
v_mul_f32 v83, 0x43000000, v17
v_mul_f32 v91, 0x3f800000, v17
v_mul_f32 v99, 0x43800000, v17
v_exp_f32 v72, -v72
v_exp_f32 v80, -v80
v_exp_f32 v88, -v88
v_exp_f32 v96, -v96
v_exp_f32 v74, -v74
v_exp_f32 v82, -v82
v_exp_f32 v90, -v90
v_exp_f32 v98, -v98
v_fract_f32 v73, v73
s_waitcnt lgkmcnt(8)
buffer_store_dwordx4 v[176:179], v210, s[8:11], s13 offen sc1
s_add_u32 s13, s13, 4096
s_waitcnt lgkmcnt(6)
buffer_store_dwordx4 v[180:183], v210, s[8:11], s13 offen sc1
s_add_u32 s13, s13, 4096
s_waitcnt lgkmcnt(4)
buffer_store_dwordx4 v[184:187], v210, s[8:11], s13 offen sc1
s_add_u32 s13, s13, 4096
s_waitcnt lgkmcnt(2)
buffer_store_dwordx4 v[188:191], v210, s[8:11], s13 offen sc1
s_add_u32 s13, s13, 4096
s_waitcnt lgkmcnt(0)
buffer_store_dwordx4 v[192:195], v211, s[8:11], s13 offen sc1
v_fract_f32 v81, v81
v_fract_f32 v89, v89
v_fract_f32 v97, v97
v_fract_f32 v75, v75
v_fract_f32 v83, v83
v_fract_f32 v91, v91
v_fract_f32 v99, v99
v_cos_f32 v32, v73
v_cos_f32 v40, v81
v_cos_f32 v44, v89
v_cos_f32 v48, v97
v_sin_f32 v33, v73
v_sin_f32 v41, v81
v_sin_f32 v45, v89
v_sin_f32 v49, v97
v_cos_f32 v34, v75
v_cos_f32 v42, v83
v_cos_f32 v46, v91
v_cos_f32 v50, v99
v_sin_f32 v35, v75
v_sin_f32 v43, v83
v_sin_f32 v47, v91
v_sin_f32 v51, v99
v_pk_mul_f32 v[32:33], v[32:33], v[72:73] op_sel_hi:[1,0]
v_pk_mul_f32 v[40:41], v[40:41], v[80:81] op_sel_hi:[1,0]
v_pk_mul_f32 v[44:45], v[44:45], v[88:89] op_sel_hi:[1,0]
v_pk_mul_f32 v[48:49], v[48:49], v[96:97] op_sel_hi:[1,0]
v_pk_mul_f32 v[34:35], v[34:35], v[74:75] op_sel_hi:[1,0]
v_pk_mul_f32 v[42:43], v[42:43], v[82:83] op_sel_hi:[1,0]
v_pk_mul_f32 v[46:47], v[46:47], v[90:91] op_sel_hi:[1,0]
v_pk_mul_f32 v[50:51], v[50:51], v[98:99] op_sel_hi:[1,0]
v_add_f32 v12, v12, v12
v_lshlrev_b32 v60, 16, v204
v_lshlrev_b32 v61, 16, v205
v_and_b32 v62, 0xffff0000, v204
v_and_b32 v63, 0xffff0000, v205
v_pk_mul_f32 v[60:61], v[60:61], v[12:13] op_sel_hi:[1,0]
v_pk_mul_f32 v[62:63], v[62:63], v[12:13] op_sel_hi:[1,0]
v_mov_b32 v76, 0x3f80
v_cvt_pk_bf16_f32 v84, v40, v41
v_pk_mul_f32 v[88:89], v[60:61], v[48:49] op_sel:[0,0] op_sel_hi:[0,1]
v_pk_mul_f32 v[96:97], v[44:45], v[44:45] op_sel:[0,0] op_sel_hi:[0,1]
v_mov_b32 v77, 0x3f80
v_cvt_pk_bf16_f32 v85, v42, v43
v_pk_mul_f32 v[90:91], v[62:63], v[50:51] op_sel:[0,0] op_sel_hi:[0,1]
v_pk_mul_f32 v[98:99], v[46:47], v[46:47] op_sel:[0,0] op_sel_hi:[0,1]
v_cvt_pk_bf16_f32 v78, v32, v33
v_pk_mul_f32 v[80:81], v[40:41], v[32:33] op_sel:[0,0] op_sel_hi:[0,1]
v_pk_fma_f32 v[104:105], v[60:61], v[48:49], v[88:89] op_sel:[1,1,0] op_sel_hi:[1,0,1] neg_lo:[1,0,0]
v_pk_fma_f32 v[52:53], v[44:45], v[44:45], v[96:97] op_sel:[1,1,0] op_sel_hi:[1,0,1] neg_lo:[1,0,0]
v_cvt_pk_bf16_f32 v79, v34, v35
v_pk_mul_f32 v[82:83], v[42:43], v[34:35] op_sel:[0,0] op_sel_hi:[0,1]
v_pk_fma_f32 v[106:107], v[62:63], v[50:51], v[90:91] op_sel:[1,1,0] op_sel_hi:[1,0,1] neg_lo:[1,0,0]
v_pk_fma_f32 v[54:55], v[46:47], v[46:47], v[98:99] op_sel:[1,1,0] op_sel_hi:[1,0,1] neg_lo:[1,0,0]
ds_write2_b64 v239, v[76:77], v[78:79] offset0:0 offset1:66
v_pk_fma_f32 v[40:41], v[40:41], v[32:33], v[80:81] op_sel:[1,1,0] op_sel_hi:[1,0,1] neg_lo:[1,0,0]
v_cvt_pk_bf16_f32 v92, v104, -v105
v_pk_mul_f32 v[96:97], v[52:53], v[52:53] op_sel:[0,0] op_sel_hi:[0,1]
v_pk_mul_f32 v[72:73], v[32:33], v[32:33] op_sel:[0,0] op_sel_hi:[0,1]
v_pk_fma_f32 v[42:43], v[42:43], v[34:35], v[82:83] op_sel:[1,1,0] op_sel_hi:[1,0,1] neg_lo:[1,0,0]
v_cvt_pk_bf16_f32 v93, v106, -v107
v_pk_mul_f32 v[98:99], v[54:55], v[54:55] op_sel:[0,0] op_sel_hi:[0,1]
v_pk_mul_f32 v[74:75], v[34:35], v[34:35] op_sel:[0,0] op_sel_hi:[0,1]
v_cvt_pk_bf16_f32 v86, v40, v41
ds_write_b64 v3, v[92:93] offset:2112
v_pk_fma_f32 v[56:57], v[52:53], v[52:53], v[96:97] op_sel:[1,1,0] op_sel_hi:[1,0,1] neg_lo:[1,0,0]
v_pk_fma_f32 v[36:37], v[32:33], v[32:33], v[72:73] op_sel:[1,1,0] op_sel_hi:[1,0,1] neg_lo:[1,0,0]
v_cvt_pk_bf16_f32 v87, v42, v43
v_pk_mul_f32 v[88:89], v[104:105], v[48:49] op_sel:[0,0] op_sel_hi:[0,1]
v_pk_fma_f32 v[58:59], v[54:55], v[54:55], v[98:99] op_sel:[1,1,0] op_sel_hi:[1,0,1] neg_lo:[1,0,0]
v_pk_fma_f32 v[38:39], v[34:35], v[34:35], v[74:75] op_sel:[1,1,0] op_sel_hi:[1,0,1] neg_lo:[1,0,0]
ds_write2_b64 v243, v[84:85], v[86:87] offset0:0 offset1:66
v_pk_mul_f32 v[90:91], v[106:107], v[50:51] op_sel:[0,0] op_sel_hi:[0,1]
v_cvt_pk_bf16_f32 v100, v60, -v61
v_cvt_pk_bf16_f32 v76, v36, v37
v_pk_mul_f32 v[80:81], v[40:41], v[32:33] op_sel:[0,0] op_sel_hi:[0,1]
v_pk_fma_f32 v[64:65], v[104:105], v[48:49], v[88:89] op_sel:[1,1,0] op_sel_hi:[1,0,1] neg_lo:[1,0,0]
v_cvt_pk_bf16_f32 v101, v62, -v63
v_cvt_pk_bf16_f32 v77, v38, v39
v_pk_mul_f32 v[82:83], v[42:43], v[34:35] op_sel:[0,0] op_sel_hi:[0,1]
v_pk_fma_f32 v[66:67], v[106:107], v[50:51], v[90:91] op_sel:[1,1,0] op_sel_hi:[1,0,1] neg_lo:[1,0,0]
v_pk_mul_f32 v[96:97], v[60:61], v[44:45] op_sel:[0,0] op_sel_hi:[0,1]
v_pk_mul_f32 v[72:73], v[36:37], v[32:33] op_sel:[0,0] op_sel_hi:[0,1]
v_pk_fma_f32 v[40:41], v[40:41], v[32:33], v[80:81] op_sel:[1,1,0] op_sel_hi:[1,0,1] neg_lo:[1,0,0]
v_cvt_pk_bf16_f32 v92, v64, -v65
v_pk_mul_f32 v[98:99], v[62:63], v[46:47] op_sel:[0,0] op_sel_hi:[0,1]
v_pk_mul_f32 v[74:75], v[38:39], v[34:35] op_sel:[0,0] op_sel_hi:[0,1]
v_pk_fma_f32 v[42:43], v[42:43], v[34:35], v[82:83] op_sel:[1,1,0] op_sel_hi:[1,0,1] neg_lo:[1,0,0]
v_cvt_pk_bf16_f32 v93, v66, -v67
v_pk_fma_f32 v[108:109], v[60:61], v[44:45], v[96:97] op_sel:[1,1,0] op_sel_hi:[1,0,1] neg_lo:[1,0,0]
v_pk_fma_f32 v[36:37], v[36:37], v[32:33], v[72:73] op_sel:[1,1,0] op_sel_hi:[1,0,1] neg_lo:[1,0,0]
v_cvt_pk_bf16_f32 v84, v40, v41
v_pk_mul_f32 v[88:89], v[64:65], v[56:57] op_sel:[0,0] op_sel_hi:[0,1]
v_pk_fma_f32 v[110:111], v[62:63], v[46:47], v[98:99] op_sel:[1,1,0] op_sel_hi:[1,0,1] neg_lo:[1,0,0]
v_pk_fma_f32 v[38:39], v[38:39], v[34:35], v[74:75] op_sel:[1,1,0] op_sel_hi:[1,0,1] neg_lo:[1,0,0]
v_cvt_pk_bf16_f32 v85, v42, v43
v_pk_mul_f32 v[90:91], v[66:67], v[58:59] op_sel:[0,0] op_sel_hi:[0,1]
v_cvt_pk_bf16_f32 v102, v108, -v109
v_cvt_pk_bf16_f32 v78, v36, v37
v_pk_mul_f32 v[80:81], v[40:41], v[32:33] op_sel:[0,0] op_sel_hi:[0,1]
v_pk_fma_f32 v[68:69], v[64:65], v[56:57], v[88:89] op_sel:[1,1,0] op_sel_hi:[1,0,1] neg_lo:[1,0,0]
v_cvt_pk_bf16_f32 v103, v110, -v111
v_cvt_pk_bf16_f32 v79, v38, v39
v_pk_mul_f32 v[82:83], v[42:43], v[34:35] op_sel:[0,0] op_sel_hi:[0,1]
v_pk_fma_f32 v[70:71], v[66:67], v[58:59], v[90:91] op_sel:[1,1,0] op_sel_hi:[1,0,1] neg_lo:[1,0,0]
ds_write2_b64 v232, v[100:101], v[102:103] offset0:0 offset1:66
ds_write2_b64 v239, v[76:77], v[78:79] offset0:132 offset1:198
v_pk_fma_f32 v[40:41], v[40:41], v[32:33], v[80:81] op_sel:[1,1,0] op_sel_hi:[1,0,1] neg_lo:[1,0,0]
v_cvt_pk_bf16_f32 v94, v68, -v69
v_pk_mul_f32 v[96:97], v[108:109], v[44:45] op_sel:[0,0] op_sel_hi:[0,1]
v_pk_mul_f32 v[72:73], v[36:37], v[32:33] op_sel:[0,0] op_sel_hi:[0,1]
v_pk_fma_f32 v[42:43], v[42:43], v[34:35], v[82:83] op_sel:[1,1,0] op_sel_hi:[1,0,1] neg_lo:[1,0,0]
v_cvt_pk_bf16_f32 v95, v70, -v71
v_pk_mul_f32 v[98:99], v[110:111], v[46:47] op_sel:[0,0] op_sel_hi:[0,1]
v_pk_mul_f32 v[74:75], v[38:39], v[34:35] op_sel:[0,0] op_sel_hi:[0,1]
v_cvt_pk_bf16_f32 v86, v40, v41
ds_write2_b64 v236, v[92:93], v[94:95] offset0:66 offset1:132
v_pk_fma_f32 v[108:109], v[108:109], v[44:45], v[96:97] op_sel:[1,1,0] op_sel_hi:[1,0,1] neg_lo:[1,0,0]
FPAD0:
s_cbranch_execz FPAD_ret
v_pk_fma_f32 v[36:37], v[36:37], v[32:33], v[72:73] op_sel:[1,1,0] op_sel_hi:[1,0,1] neg_lo:[1,0,0]
v_cvt_pk_bf16_f32 v87, v42, v43
v_pk_mul_f32 v[88:89], v[68:69], v[56:57] op_sel:[0,0] op_sel_hi:[0,1]
v_pk_fma_f32 v[110:111], v[110:111], v[46:47], v[98:99] op_sel:[1,1,0] op_sel_hi:[1,0,1] neg_lo:[1,0,0]
v_pk_fma_f32 v[38:39], v[38:39], v[34:35], v[74:75] op_sel:[1,1,0] op_sel_hi:[1,0,1] neg_lo:[1,0,0]
ds_write2_b64 v243, v[84:85], v[86:87] offset0:132 offset1:198
v_pk_mul_f32 v[90:91], v[70:71], v[58:59] op_sel:[0,0] op_sel_hi:[0,1]
v_cvt_pk_bf16_f32 v100, v108, -v109
v_cvt_pk_bf16_f32 v76, v36, v37
v_pk_mul_f32 v[80:81], v[40:41], v[32:33] op_sel:[0,0] op_sel_hi:[0,1]
v_pk_fma_f32 v[68:69], v[68:69], v[56:57], v[88:89] op_sel:[1,1,0] op_sel_hi:[1,0,1] neg_lo:[1,0,0]
v_cvt_pk_bf16_f32 v101, v110, -v111
s_waitcnt vmcnt(0)
v_mul_u32_u24 v213, 8320, v0
s_barrier
s_cmp_lg_u32 s3, 0
s_cbranch_scc1 LF_pub1
s_mov_b64 exec, 255
buffer_store_dword v212, v213, s[8:11], s15 offen sc1
s_mov_b64 exec, -1
LF_pub1:
v_cvt_pk_bf16_f32 v77, v38, v39
v_pk_mul_f32 v[82:83], v[42:43], v[34:35] op_sel:[0,0] op_sel_hi:[0,1]
v_pk_fma_f32 v[70:71], v[70:71], v[58:59], v[90:91] op_sel:[1,1,0] op_sel_hi:[1,0,1] neg_lo:[1,0,0]
v_pk_mul_f32 v[96:97], v[108:109], v[44:45] op_sel:[0,0] op_sel_hi:[0,1]
v_pk_mul_f32 v[72:73], v[36:37], v[32:33] op_sel:[0,0] op_sel_hi:[0,1]
v_pk_fma_f32 v[40:41], v[40:41], v[32:33], v[80:81] op_sel:[1,1,0] op_sel_hi:[1,0,1] neg_lo:[1,0,0]
v_cvt_pk_bf16_f32 v92, v68, -v69
v_pk_mul_f32 v[98:99], v[110:111], v[46:47] op_sel:[0,0] op_sel_hi:[0,1]
v_pk_mul_f32 v[74:75], v[38:39], v[34:35] op_sel:[0,0] op_sel_hi:[0,1]
v_pk_fma_f32 v[42:43], v[42:43], v[34:35], v[82:83] op_sel:[1,1,0] op_sel_hi:[1,0,1] neg_lo:[1,0,0]
v_cvt_pk_bf16_f32 v93, v70, -v71
v_pk_fma_f32 v[108:109], v[108:109], v[44:45], v[96:97] op_sel:[1,1,0] op_sel_hi:[1,0,1] neg_lo:[1,0,0]
v_pk_fma_f32 v[36:37], v[36:37], v[32:33], v[72:73] op_sel:[1,1,0] op_sel_hi:[1,0,1] neg_lo:[1,0,0]
v_cvt_pk_bf16_f32 v84, v40, v41
ds_write_b64 v3, v[92:93] offset:10032
v_pk_fma_f32 v[110:111], v[110:111], v[46:47], v[98:99] op_sel:[1,1,0] op_sel_hi:[1,0,1] neg_lo:[1,0,0]
v_pk_fma_f32 v[38:39], v[38:39], v[34:35], v[74:75] op_sel:[1,1,0] op_sel_hi:[1,0,1] neg_lo:[1,0,0]
v_cvt_pk_bf16_f32 v85, v42, v43
v_pk_mul_f32 v[88:89], v[64:65], v[48:49] op_sel:[0,0] op_sel_hi:[0,1]
v_cvt_pk_bf16_f32 v102, v108, -v109
v_cvt_pk_bf16_f32 v78, v36, v37
v_pk_mul_f32 v[80:81], v[40:41], v[32:33] op_sel:[0,0] op_sel_hi:[0,1]
v_pk_mul_f32 v[90:91], v[66:67], v[50:51] op_sel:[0,0] op_sel_hi:[0,1]
v_cvt_pk_bf16_f32 v103, v110, -v111
v_cvt_pk_bf16_f32 v79, v38, v39
v_pk_mul_f32 v[82:83], v[42:43], v[34:35] op_sel:[0,0] op_sel_hi:[0,1]
v_pk_fma_f32 v[64:65], v[64:65], v[48:49], v[88:89] op_sel:[1,1,0] op_sel_hi:[1,0,1] neg_lo:[1,0,0]
ds_write2_b64 v232, v[100:101], v[102:103] offset0:132 offset1:198
ds_write2_b64 v240, v[76:77], v[78:79] offset0:0 offset1:66
v_pk_fma_f32 v[40:41], v[40:41], v[32:33], v[80:81] op_sel:[1,1,0] op_sel_hi:[1,0,1] neg_lo:[1,0,0]
v_pk_fma_f32 v[66:67], v[66:67], v[50:51], v[90:91] op_sel:[1,1,0] op_sel_hi:[1,0,1] neg_lo:[1,0,0]
v_pk_mul_f32 v[96:97], v[108:109], v[44:45] op_sel:[0,0] op_sel_hi:[0,1]
v_pk_mul_f32 v[72:73], v[36:37], v[32:33] op_sel:[0,0] op_sel_hi:[0,1]
v_pk_fma_f32 v[42:43], v[42:43], v[34:35], v[82:83] op_sel:[1,1,0] op_sel_hi:[1,0,1] neg_lo:[1,0,0]
v_cvt_pk_bf16_f32 v92, v64, -v65
v_pk_mul_f32 v[98:99], v[110:111], v[46:47] op_sel:[0,0] op_sel_hi:[0,1]
v_pk_mul_f32 v[74:75], v[38:39], v[34:35] op_sel:[0,0] op_sel_hi:[0,1]
v_cvt_pk_bf16_f32 v86, v40, v41
v_cvt_pk_bf16_f32 v93, v66, -v67
v_pk_fma_f32 v[108:109], v[108:109], v[44:45], v[96:97] op_sel:[1,1,0] op_sel_hi:[1,0,1] neg_lo:[1,0,0]
v_pk_fma_f32 v[36:37], v[36:37], v[32:33], v[72:73] op_sel:[1,1,0] op_sel_hi:[1,0,1] neg_lo:[1,0,0]
v_cvt_pk_bf16_f32 v87, v42, v43
v_pk_mul_f32 v[88:89], v[64:65], v[56:57] op_sel:[0,0] op_sel_hi:[0,1]
v_pk_fma_f32 v[110:111], v[110:111], v[46:47], v[98:99] op_sel:[1,1,0] op_sel_hi:[1,0,1] neg_lo:[1,0,0]
v_pk_fma_f32 v[38:39], v[38:39], v[34:35], v[74:75] op_sel:[1,1,0] op_sel_hi:[1,0,1] neg_lo:[1,0,0]
ds_write2_b64 v244, v[84:85], v[86:87] offset0:0 offset1:66
v_pk_mul_f32 v[90:91], v[66:67], v[58:59] op_sel:[0,0] op_sel_hi:[0,1]
v_cvt_pk_bf16_f32 v100, v108, -v109
v_cvt_pk_bf16_f32 v76, v36, v37
v_pk_mul_f32 v[80:81], v[40:41], v[32:33] op_sel:[0,0] op_sel_hi:[0,1]
v_pk_fma_f32 v[68:69], v[64:65], v[56:57], v[88:89] op_sel:[1,1,0] op_sel_hi:[1,0,1] neg_lo:[1,0,0]
v_cvt_pk_bf16_f32 v101, v110, -v111
v_cvt_pk_bf16_f32 v77, v38, v39
v_pk_mul_f32 v[82:83], v[42:43], v[34:35] op_sel:[0,0] op_sel_hi:[0,1]
v_pk_fma_f32 v[70:71], v[66:67], v[58:59], v[90:91] op_sel:[1,1,0] op_sel_hi:[1,0,1] neg_lo:[1,0,0]
v_pk_mul_f32 v[96:97], v[108:109], v[44:45] op_sel:[0,0] op_sel_hi:[0,1]
v_pk_mul_f32 v[72:73], v[36:37], v[32:33] op_sel:[0,0] op_sel_hi:[0,1]
v_pk_fma_f32 v[40:41], v[40:41], v[32:33], v[80:81] op_sel:[1,1,0] op_sel_hi:[1,0,1] neg_lo:[1,0,0]
v_cvt_pk_bf16_f32 v94, v68, -v69
v_pk_mul_f32 v[98:99], v[110:111], v[46:47] op_sel:[0,0] op_sel_hi:[0,1]
v_pk_mul_f32 v[74:75], v[38:39], v[34:35] op_sel:[0,0] op_sel_hi:[0,1]
v_pk_fma_f32 v[42:43], v[42:43], v[34:35], v[82:83] op_sel:[1,1,0] op_sel_hi:[1,0,1] neg_lo:[1,0,0]
v_cvt_pk_bf16_f32 v95, v70, -v71
v_pk_fma_f32 v[108:109], v[108:109], v[44:45], v[96:97] op_sel:[1,1,0] op_sel_hi:[1,0,1] neg_lo:[1,0,0]
v_pk_fma_f32 v[36:37], v[36:37], v[32:33], v[72:73] op_sel:[1,1,0] op_sel_hi:[1,0,1] neg_lo:[1,0,0]
v_cvt_pk_bf16_f32 v84, v40, v41
ds_write2_b64 v237, v[92:93], v[94:95] offset0:66 offset1:132
v_pk_fma_f32 v[110:111], v[110:111], v[46:47], v[98:99] op_sel:[1,1,0] op_sel_hi:[1,0,1] neg_lo:[1,0,0]
v_pk_fma_f32 v[38:39], v[38:39], v[34:35], v[74:75] op_sel:[1,1,0] op_sel_hi:[1,0,1] neg_lo:[1,0,0]
v_cvt_pk_bf16_f32 v85, v42, v43
v_pk_mul_f32 v[88:89], v[68:69], v[56:57] op_sel:[0,0] op_sel_hi:[0,1]
v_cvt_pk_bf16_f32 v102, v108, -v109
v_cvt_pk_bf16_f32 v78, v36, v37
v_pk_mul_f32 v[80:81], v[40:41], v[32:33] op_sel:[0,0] op_sel_hi:[0,1]
v_pk_mul_f32 v[90:91], v[70:71], v[58:59] op_sel:[0,0] op_sel_hi:[0,1]
v_cvt_pk_bf16_f32 v103, v110, -v111
v_cvt_pk_bf16_f32 v79, v38, v39
v_pk_mul_f32 v[82:83], v[42:43], v[34:35] op_sel:[0,0] op_sel_hi:[0,1]
v_pk_fma_f32 v[68:69], v[68:69], v[56:57], v[88:89] op_sel:[1,1,0] op_sel_hi:[1,0,1] neg_lo:[1,0,0]
ds_write2_b64 v234, v[100:101], v[102:103] offset0:0 offset1:66
ds_write2_b64 v240, v[76:77], v[78:79] offset0:132 offset1:198
v_pk_fma_f32 v[40:41], v[40:41], v[32:33], v[80:81] op_sel:[1,1,0] op_sel_hi:[1,0,1] neg_lo:[1,0,0]
v_pk_fma_f32 v[70:71], v[70:71], v[58:59], v[90:91] op_sel:[1,1,0] op_sel_hi:[1,0,1] neg_lo:[1,0,0]
v_pk_mul_f32 v[96:97], v[108:109], v[44:45] op_sel:[0,0] op_sel_hi:[0,1]
v_pk_mul_f32 v[72:73], v[36:37], v[32:33] op_sel:[0,0] op_sel_hi:[0,1]
v_pk_fma_f32 v[42:43], v[42:43], v[34:35], v[82:83] op_sel:[1,1,0] op_sel_hi:[1,0,1] neg_lo:[1,0,0]
v_cvt_pk_bf16_f32 v92, v68, -v69
v_pk_mul_f32 v[98:99], v[110:111], v[46:47] op_sel:[0,0] op_sel_hi:[0,1]
v_pk_mul_f32 v[74:75], v[38:39], v[34:35] op_sel:[0,0] op_sel_hi:[0,1]
v_cvt_pk_bf16_f32 v86, v40, v41
v_cvt_pk_bf16_f32 v93, v70, -v71
v_pk_fma_f32 v[108:109], v[108:109], v[44:45], v[96:97] op_sel:[1,1,0] op_sel_hi:[1,0,1] neg_lo:[1,0,0]
v_pk_fma_f32 v[36:37], v[36:37], v[32:33], v[72:73] op_sel:[1,1,0] op_sel_hi:[1,0,1] neg_lo:[1,0,0]
v_cvt_pk_bf16_f32 v87, v42, v43
s_waitcnt lgkmcnt(12)
ds_write_b64 v3, v[92:93] offset:12144
v_pk_fma_f32 v[110:111], v[110:111], v[46:47], v[98:99] op_sel:[1,1,0] op_sel_hi:[1,0,1] neg_lo:[1,0,0]
v_pk_fma_f32 v[38:39], v[38:39], v[34:35], v[74:75] op_sel:[1,1,0] op_sel_hi:[1,0,1] neg_lo:[1,0,0]
ds_write2_b64 v244, v[84:85], v[86:87] offset0:132 offset1:198
v_pk_mul_f32 v[88:89], v[68:69], v[48:49] op_sel:[0,0] op_sel_hi:[0,1]
v_cvt_pk_bf16_f32 v100, v108, -v109
v_cvt_pk_bf16_f32 v76, v36, v37
v_pk_mul_f32 v[80:81], v[40:41], v[32:33] op_sel:[0,0] op_sel_hi:[0,1]
v_pk_mul_f32 v[90:91], v[70:71], v[50:51] op_sel:[0,0] op_sel_hi:[0,1]
v_cvt_pk_bf16_f32 v101, v110, -v111
v_cvt_pk_bf16_f32 v77, v38, v39
v_pk_mul_f32 v[82:83], v[42:43], v[34:35] op_sel:[0,0] op_sel_hi:[0,1]
v_pk_fma_f32 v[68:69], v[68:69], v[48:49], v[88:89] op_sel:[1,1,0] op_sel_hi:[1,0,1] neg_lo:[1,0,0]
v_pk_mul_f32 v[96:97], v[108:109], v[44:45] op_sel:[0,0] op_sel_hi:[0,1]
v_pk_mul_f32 v[72:73], v[36:37], v[32:33] op_sel:[0,0] op_sel_hi:[0,1]
v_pk_fma_f32 v[40:41], v[40:41], v[32:33], v[80:81] op_sel:[1,1,0] op_sel_hi:[1,0,1] neg_lo:[1,0,0]
v_pk_fma_f32 v[70:71], v[70:71], v[50:51], v[90:91] op_sel:[1,1,0] op_sel_hi:[1,0,1] neg_lo:[1,0,0]
v_pk_mul_f32 v[98:99], v[110:111], v[46:47] op_sel:[0,0] op_sel_hi:[0,1]
v_pk_mul_f32 v[74:75], v[38:39], v[34:35] op_sel:[0,0] op_sel_hi:[0,1]
v_pk_fma_f32 v[42:43], v[42:43], v[34:35], v[82:83] op_sel:[1,1,0] op_sel_hi:[1,0,1] neg_lo:[1,0,0]
v_cvt_pk_bf16_f32 v94, v68, -v69
v_pk_fma_f32 v[108:109], v[108:109], v[44:45], v[96:97] op_sel:[1,1,0] op_sel_hi:[1,0,1] neg_lo:[1,0,0]
v_pk_fma_f32 v[36:37], v[36:37], v[32:33], v[72:73] op_sel:[1,1,0] op_sel_hi:[1,0,1] neg_lo:[1,0,0]
v_cvt_pk_bf16_f32 v84, v40, v41
v_cvt_pk_bf16_f32 v95, v70, -v71
v_pk_fma_f32 v[110:111], v[110:111], v[46:47], v[98:99] op_sel:[1,1,0] op_sel_hi:[1,0,1] neg_lo:[1,0,0]
v_pk_fma_f32 v[38:39], v[38:39], v[34:35], v[74:75] op_sel:[1,1,0] op_sel_hi:[1,0,1] neg_lo:[1,0,0]
v_cvt_pk_bf16_f32 v85, v42, v43
v_pk_mul_f32 v[88:89], v[68:69], v[48:49] op_sel:[0,0] op_sel_hi:[0,1]
v_cvt_pk_bf16_f32 v102, v108, -v109
v_cvt_pk_bf16_f32 v78, v36, v37
v_pk_mul_f32 v[80:81], v[40:41], v[32:33] op_sel:[0,0] op_sel_hi:[0,1]
v_pk_mul_f32 v[90:91], v[70:71], v[50:51] op_sel:[0,0] op_sel_hi:[0,1]
v_cvt_pk_bf16_f32 v103, v110, -v111
v_cvt_pk_bf16_f32 v79, v38, v39
v_pk_mul_f32 v[82:83], v[42:43], v[34:35] op_sel:[0,0] op_sel_hi:[0,1]
v_pk_fma_f32 v[68:69], v[68:69], v[48:49], v[88:89] op_sel:[1,1,0] op_sel_hi:[1,0,1] neg_lo:[1,0,0]
s_waitcnt lgkmcnt(12)
ds_write2_b64 v234, v[100:101], v[102:103] offset0:132 offset1:198
ds_write2_b64 v241, v[76:77], v[78:79] offset0:0 offset1:66
v_pk_fma_f32 v[40:41], v[40:41], v[32:33], v[80:81] op_sel:[1,1,0] op_sel_hi:[1,0,1] neg_lo:[1,0,0]
v_pk_fma_f32 v[70:71], v[70:71], v[50:51], v[90:91] op_sel:[1,1,0] op_sel_hi:[1,0,1] neg_lo:[1,0,0]
v_pk_mul_f32 v[96:97], v[108:109], v[44:45] op_sel:[0,0] op_sel_hi:[0,1]
v_pk_mul_f32 v[72:73], v[36:37], v[32:33] op_sel:[0,0] op_sel_hi:[0,1]
v_pk_fma_f32 v[42:43], v[42:43], v[34:35], v[82:83] op_sel:[1,1,0] op_sel_hi:[1,0,1] neg_lo:[1,0,0]
v_cvt_pk_bf16_f32 v92, v68, -v69
v_pk_mul_f32 v[98:99], v[110:111], v[46:47] op_sel:[0,0] op_sel_hi:[0,1]
v_pk_mul_f32 v[74:75], v[38:39], v[34:35] op_sel:[0,0] op_sel_hi:[0,1]
v_cvt_pk_bf16_f32 v86, v40, v41
v_cvt_pk_bf16_f32 v93, v70, -v71
v_pk_fma_f32 v[108:109], v[108:109], v[44:45], v[96:97] op_sel:[1,1,0] op_sel_hi:[1,0,1] neg_lo:[1,0,0]
v_pk_fma_f32 v[36:37], v[36:37], v[32:33], v[72:73] op_sel:[1,1,0] op_sel_hi:[1,0,1] neg_lo:[1,0,0]
buffer_load_dword v213, v214, s[8:11], s48 offen sc1
v_cvt_pk_bf16_f32 v87, v42, v43
s_waitcnt lgkmcnt(12)
ds_write2_b64 v238, v[94:95], v[92:93] offset0:0 offset1:66
v_pk_fma_f32 v[110:111], v[110:111], v[46:47], v[98:99] op_sel:[1,1,0] op_sel_hi:[1,0,1] neg_lo:[1,0,0]
v_pk_fma_f32 v[38:39], v[38:39], v[34:35], v[74:75] op_sel:[1,1,0] op_sel_hi:[1,0,1] neg_lo:[1,0,0]
ds_write2_b64 v245, v[84:85], v[86:87] offset0:0 offset1:66
v_pk_mul_f32 v[88:89], v[68:69], v[48:49] op_sel:[0,0] op_sel_hi:[0,1]
v_cvt_pk_bf16_f32 v100, v108, -v109
v_cvt_pk_bf16_f32 v76, v36, v37
v_pk_mul_f32 v[80:81], v[40:41], v[32:33] op_sel:[0,0] op_sel_hi:[0,1]
v_pk_mul_f32 v[90:91], v[70:71], v[50:51] op_sel:[0,0] op_sel_hi:[0,1]
v_cvt_pk_bf16_f32 v101, v110, -v111
v_cvt_pk_bf16_f32 v77, v38, v39
v_pk_mul_f32 v[82:83], v[42:43], v[34:35] op_sel:[0,0] op_sel_hi:[0,1]
v_pk_fma_f32 v[68:69], v[68:69], v[48:49], v[88:89] op_sel:[1,1,0] op_sel_hi:[1,0,1] neg_lo:[1,0,0]
s_waitcnt lgkmcnt(12)
ds_write_b64 v3, v[100:101] offset:8448
v_pk_mul_f32 v[72:73], v[36:37], v[32:33] op_sel:[0,0] op_sel_hi:[0,1]
v_pk_fma_f32 v[40:41], v[40:41], v[32:33], v[80:81] op_sel:[1,1,0] op_sel_hi:[1,0,1] neg_lo:[1,0,0]
v_pk_fma_f32 v[70:71], v[70:71], v[50:51], v[90:91] op_sel:[1,1,0] op_sel_hi:[1,0,1] neg_lo:[1,0,0]
v_pk_mul_f32 v[96:97], v[104:105], v[52:53] op_sel:[0,0] op_sel_hi:[0,1]
v_pk_mul_f32 v[74:75], v[38:39], v[34:35] op_sel:[0,0] op_sel_hi:[0,1]
v_pk_fma_f32 v[42:43], v[42:43], v[34:35], v[82:83] op_sel:[1,1,0] op_sel_hi:[1,0,1] neg_lo:[1,0,0]
v_cvt_pk_bf16_f32 v94, v68, -v69
v_pk_mul_f32 v[98:99], v[106:107], v[54:55] op_sel:[0,0] op_sel_hi:[0,1]
v_pk_fma_f32 v[36:37], v[36:37], v[32:33], v[72:73] op_sel:[1,1,0] op_sel_hi:[1,0,1] neg_lo:[1,0,0]
v_cvt_pk_bf16_f32 v84, v40, v41
v_cvt_pk_bf16_f32 v95, v70, -v71
v_pk_fma_f32 v[108:109], v[104:105], v[52:53], v[96:97] op_sel:[1,1,0] op_sel_hi:[1,0,1] neg_lo:[1,0,0]
v_pk_fma_f32 v[38:39], v[38:39], v[34:35], v[74:75] op_sel:[1,1,0] op_sel_hi:[1,0,1] neg_lo:[1,0,0]
v_cvt_pk_bf16_f32 v85, v42, v43
v_pk_mul_f32 v[88:89], v[68:69], v[48:49] op_sel:[0,0] op_sel_hi:[0,1]
v_pk_fma_f32 v[110:111], v[106:107], v[54:55], v[98:99] op_sel:[1,1,0] op_sel_hi:[1,0,1] neg_lo:[1,0,0]
v_cvt_pk_bf16_f32 v78, v36, v37
v_pk_mul_f32 v[80:81], v[40:41], v[32:33] op_sel:[0,0] op_sel_hi:[0,1]
v_pk_mul_f32 v[90:91], v[70:71], v[50:51] op_sel:[0,0] op_sel_hi:[0,1]
v_cvt_pk_bf16_f32 v102, v108, -v109
v_cvt_pk_bf16_f32 v79, v38, v39
v_pk_mul_f32 v[82:83], v[42:43], v[34:35] op_sel:[0,0] op_sel_hi:[0,1]
v_pk_fma_f32 v[68:69], v[68:69], v[48:49], v[88:89] op_sel:[1,1,0] op_sel_hi:[1,0,1] neg_lo:[1,0,0]
v_cvt_pk_bf16_f32 v103, v110, -v111
ds_write2_b64 v241, v[76:77], v[78:79] offset0:132 offset1:198
v_pk_fma_f32 v[40:41], v[40:41], v[32:33], v[80:81] op_sel:[1,1,0] op_sel_hi:[1,0,1] neg_lo:[1,0,0]
v_pk_fma_f32 v[70:71], v[70:71], v[50:51], v[90:91] op_sel:[1,1,0] op_sel_hi:[1,0,1] neg_lo:[1,0,0]
v_pk_mul_f32 v[96:97], v[108:109], v[52:53] op_sel:[0,0] op_sel_hi:[0,1]
v_pk_mul_f32 v[72:73], v[36:37], v[32:33] op_sel:[0,0] op_sel_hi:[0,1]
v_pk_fma_f32 v[42:43], v[42:43], v[34:35], v[82:83] op_sel:[1,1,0] op_sel_hi:[1,0,1] neg_lo:[1,0,0]
v_cvt_pk_bf16_f32 v92, v68, -v69
v_pk_mul_f32 v[98:99], v[110:111], v[54:55] op_sel:[0,0] op_sel_hi:[0,1]
v_pk_mul_f32 v[74:75], v[38:39], v[34:35] op_sel:[0,0] op_sel_hi:[0,1]
v_cvt_pk_bf16_f32 v86, v40, v41
v_cvt_pk_bf16_f32 v93, v70, -v71
v_pk_fma_f32 v[108:109], v[108:109], v[52:53], v[96:97] op_sel:[1,1,0] op_sel_hi:[1,0,1] neg_lo:[1,0,0]
v_pk_fma_f32 v[36:37], v[36:37], v[32:33], v[72:73] op_sel:[1,1,0] op_sel_hi:[1,0,1] neg_lo:[1,0,0]
v_cvt_pk_bf16_f32 v87, v42, v43
s_waitcnt lgkmcnt(12)
ds_write2_b64 v235, v[94:95], v[92:93] offset0:66 offset1:132
v_pk_fma_f32 v[110:111], v[110:111], v[54:55], v[98:99] op_sel:[1,1,0] op_sel_hi:[1,0,1] neg_lo:[1,0,0]
v_pk_fma_f32 v[38:39], v[38:39], v[34:35], v[74:75] op_sel:[1,1,0] op_sel_hi:[1,0,1] neg_lo:[1,0,0]
ds_write2_b64 v245, v[84:85], v[86:87] offset0:132 offset1:198
v_cvt_pk_bf16_f32 v100, v108, -v109
v_cvt_pk_bf16_f32 v76, v36, v37
v_pk_mul_f32 v[80:81], v[40:41], v[32:33] op_sel:[0,0] op_sel_hi:[0,1]
v_cvt_pk_bf16_f32 v101, v110, -v111
v_cvt_pk_bf16_f32 v77, v38, v39
v_pk_mul_f32 v[82:83], v[42:43], v[34:35] op_sel:[0,0] op_sel_hi:[0,1]
s_waitcnt lgkmcnt(12)
ds_write2_b64 v233, v[102:103], v[100:101] offset0:66 offset1:132
v_pk_mul_f32 v[72:73], v[36:37], v[32:33] op_sel:[0,0] op_sel_hi:[0,1]
v_pk_fma_f32 v[40:41], v[40:41], v[32:33], v[80:81] op_sel:[1,1,0] op_sel_hi:[1,0,1] neg_lo:[1,0,0]
v_pk_mul_f32 v[96:97], v[108:109], v[52:53] op_sel:[0,0] op_sel_hi:[0,1]
v_pk_mul_f32 v[74:75], v[38:39], v[34:35] op_sel:[0,0] op_sel_hi:[0,1]
v_pk_fma_f32 v[42:43], v[42:43], v[34:35], v[82:83] op_sel:[1,1,0] op_sel_hi:[1,0,1] neg_lo:[1,0,0]
v_pk_mul_f32 v[98:99], v[110:111], v[54:55] op_sel:[0,0] op_sel_hi:[0,1]
v_pk_fma_f32 v[36:37], v[36:37], v[32:33], v[72:73] op_sel:[1,1,0] op_sel_hi:[1,0,1] neg_lo:[1,0,0]
v_cvt_pk_bf16_f32 v84, v40, v41
v_pk_fma_f32 v[108:109], v[108:109], v[52:53], v[96:97] op_sel:[1,1,0] op_sel_hi:[1,0,1] neg_lo:[1,0,0]
v_pk_fma_f32 v[38:39], v[38:39], v[34:35], v[74:75] op_sel:[1,1,0] op_sel_hi:[1,0,1] neg_lo:[1,0,0]
v_cvt_pk_bf16_f32 v85, v42, v43
v_pk_fma_f32 v[110:111], v[110:111], v[54:55], v[98:99] op_sel:[1,1,0] op_sel_hi:[1,0,1] neg_lo:[1,0,0]
v_cvt_pk_bf16_f32 v78, v36, v37
v_pk_mul_f32 v[80:81], v[40:41], v[32:33] op_sel:[0,0] op_sel_hi:[0,1]
v_cvt_pk_bf16_f32 v102, v108, -v109
v_cvt_pk_bf16_f32 v79, v38, v39
s_mov_b32 s66, 0
LF_poll:
s_waitcnt vmcnt(0)
v_cmp_ne_u32 vcc, s12, v213
s_cbranch_vccz LF_pollok
s_add_u32 s66, s66, 1
s_cmp_ge_u32 s66, 0x40000
s_cbranch_scc1 LF_pollok
buffer_load_dword v213, v214, s[8:11], s48 offen sc1
s_branch LF_poll
LF_pollok:
s_add_u32 m0, s34, 129024
s_nop 0
buffer_load_dwordx4 v215, s[8:11], s49 offen sc1 lds
s_add_u32 s49, s49, 593920
v_pk_mul_f32 v[82:83], v[42:43], v[34:35] op_sel:[0,0] op_sel_hi:[0,1]
v_cvt_pk_bf16_f32 v103, v110, -v111
ds_write2_b64 v242, v[76:77], v[78:79] offset0:0 offset1:66
v_pk_fma_f32 v[40:41], v[40:41], v[32:33], v[80:81] op_sel:[1,1,0] op_sel_hi:[1,0,1] neg_lo:[1,0,0]
s_waitcnt lgkmcnt(12)
ds_write_b64 v3, v[102:103] offset:3696
s_add_u32 m0, s34, 133120
s_nop 0
buffer_load_dwordx4 v215, s[8:11], s49 offen sc1 lds
s_add_u32 s49, s49, 593920
v_pk_mul_f32 v[72:73], v[36:37], v[32:33] op_sel:[0,0] op_sel_hi:[0,1]
v_pk_fma_f32 v[42:43], v[42:43], v[34:35], v[82:83] op_sel:[1,1,0] op_sel_hi:[1,0,1] neg_lo:[1,0,0]
v_pk_mul_f32 v[96:97], v[108:109], v[52:53] op_sel:[0,0] op_sel_hi:[0,1]
v_pk_mul_f32 v[74:75], v[38:39], v[34:35] op_sel:[0,0] op_sel_hi:[0,1]
v_cvt_pk_bf16_f32 v86, v40, v41
s_add_u32 m0, s34, 137216
s_nop 0
buffer_load_dwordx4 v215, s[8:11], s49 offen sc1 lds
s_add_u32 s49, s49, 593920
v_pk_mul_f32 v[98:99], v[110:111], v[54:55] op_sel:[0,0] op_sel_hi:[0,1]
v_pk_fma_f32 v[36:37], v[36:37], v[32:33], v[72:73] op_sel:[1,1,0] op_sel_hi:[1,0,1] neg_lo:[1,0,0]
v_cvt_pk_bf16_f32 v87, v42, v43
v_pk_fma_f32 v[108:109], v[108:109], v[52:53], v[96:97] op_sel:[1,1,0] op_sel_hi:[1,0,1] neg_lo:[1,0,0]
v_pk_fma_f32 v[38:39], v[38:39], v[34:35], v[74:75] op_sel:[1,1,0] op_sel_hi:[1,0,1] neg_lo:[1,0,0]
s_add_u32 m0, s34, 141312
s_nop 0
buffer_load_dwordx4 v215, s[8:11], s49 offen sc1 lds
s_add_u32 s49, s49, 593920
ds_write2_b64 v246, v[84:85], v[86:87] offset0:0 offset1:66
v_pk_fma_f32 v[110:111], v[110:111], v[54:55], v[98:99] op_sel:[1,1,0] op_sel_hi:[1,0,1] neg_lo:[1,0,0]
v_cvt_pk_bf16_f32 v76, v36, v37
v_pk_mul_f32 v[80:81], v[40:41], v[32:33] op_sel:[0,0] op_sel_hi:[0,1]
v_cvt_pk_bf16_f32 v100, v108, -v109
s_add_u32 m0, s34, 145408
s_nop 0
buffer_load_dwordx4 v215, s[8:11], s49 offen sc1 lds
s_add_u32 s49, s49, 593920
v_cvt_pk_bf16_f32 v77, v38, v39
v_pk_mul_f32 v[82:83], v[42:43], v[34:35] op_sel:[0,0] op_sel_hi:[0,1]
v_cvt_pk_bf16_f32 v101, v110, -v111
v_pk_mul_f32 v[72:73], v[36:37], v[32:33] op_sel:[0,0] op_sel_hi:[0,1]
v_pk_fma_f32 v[40:41], v[40:41], v[32:33], v[80:81] op_sel:[1,1,0] op_sel_hi:[1,0,1] neg_lo:[1,0,0]
s_add_u32 m0, s34, 149504
s_nop 0
buffer_load_dwordx4 v215, s[8:11], s49 offen sc1 lds
s_add_u32 s49, s49, 593920
s_waitcnt lgkmcnt(12)
ds_write_b64 v3, v[100:101] offset:6336
v_pk_mul_f32 v[74:75], v[38:39], v[34:35] op_sel:[0,0] op_sel_hi:[0,1]
v_pk_fma_f32 v[42:43], v[42:43], v[34:35], v[82:83] op_sel:[1,1,0] op_sel_hi:[1,0,1] neg_lo:[1,0,0]
v_pk_fma_f32 v[36:37], v[36:37], v[32:33], v[72:73] op_sel:[1,1,0] op_sel_hi:[1,0,1] neg_lo:[1,0,0]
v_cvt_pk_bf16_f32 v84, v40, v41
s_add_u32 m0, s34, 153600
s_nop 0
buffer_load_dwordx4 v215, s[8:11], s49 offen sc1 lds
s_add_u32 s49, s49, 593920
v_pk_fma_f32 v[38:39], v[38:39], v[34:35], v[74:75] op_sel:[1,1,0] op_sel_hi:[1,0,1] neg_lo:[1,0,0]
v_cvt_pk_bf16_f32 v85, v42, v43
v_cvt_pk_bf16_f32 v78, v36, v37
v_pk_mul_f32 v[80:81], v[40:41], v[32:33] op_sel:[0,0] op_sel_hi:[0,1]
v_cvt_pk_bf16_f32 v79, v38, v39
s_add_u32 m0, s34, 157696
s_nop 0
buffer_load_dwordx4 v215, s[8:11], s49 offen sc1 lds
s_add_u32 s49, s49, 593920
v_pk_mul_f32 v[82:83], v[42:43], v[34:35] op_sel:[0,0] op_sel_hi:[0,1]
ds_write2_b64 v242, v[76:77], v[78:79] offset0:132 offset1:198
v_pk_fma_f32 v[40:41], v[40:41], v[32:33], v[80:81] op_sel:[1,1,0] op_sel_hi:[1,0,1] neg_lo:[1,0,0]
v_pk_fma_f32 v[42:43], v[42:43], v[34:35], v[82:83] op_sel:[1,1,0] op_sel_hi:[1,0,1] neg_lo:[1,0,0]
v_cvt_pk_bf16_f32 v86, v40, v41
v_cvt_pk_bf16_f32 v87, v42, v43
s_waitcnt lgkmcnt(12)
ds_write2_b64 v246, v[84:85], v[86:87] offset0:132 offset1:198
ds_read_b128 v[112:115], v6 offset:0
s_waitcnt lgkmcnt(12)
ds_read_b128 v[116:119], v219 offset:14784
ds_read_b128 v[120:123], v6 offset:32
s_waitcnt lgkmcnt(12)
ds_read_b128 v[124:127], v219 offset:14816
ds_read_b128 v[128:131], v6 offset:64
s_waitcnt lgkmcnt(12)
ds_read_b128 v[132:135], v219 offset:14848
ds_read_b128 v[136:139], v6 offset:96
s_waitcnt lgkmcnt(12)
ds_read_b128 v[140:143], v219 offset:14880
ds_read_b128 v[144:147], v6 offset:128
s_waitcnt lgkmcnt(12)
ds_read_b128 v[148:151], v219 offset:14912
ds_read_b128 v[152:155], v6 offset:160
s_waitcnt lgkmcnt(12)
ds_read_b128 v[156:159], v219 offset:14944
v_and_b32 v34, 15, v2
v_lshrrev_b32 v35, 4, v2
v_lshlrev_b32 v36, 3, v35
v_sub_u32 v36, v36, v34
v_add_u32 v37, 1, v36
v_and_b32 v37, 1, v37
v_mul_u32_u24 v33, 97, v37
v_add3_u32 v33, v33, v36, 15
v_lshlrev_b32 v32, 2, v35
v_sub_u32 v33, v33, v32
s_add_u32 s28, s34, 118272
v_lshl_add_u32 v237, v33, 1, s28
v_sub_u32 v239, 24, v36
v_mul_u32_u24 v37, 2087, v37
v_mov_b32 v8, 0
v_mov_b32 v9, 0
v_mov_b32 v10, 0
v_mov_b32 v11, 0
v_add_u32 v7, 124928, v210
s_waitcnt lgkmcnt(10)
v_mfma_f32_32x32x16_bf16 v[16:31], v[112:115], v[116:119], 0
ds_read_b128 v[112:115], v6 offset:192
ds_read_b128 v[116:119], v219 offset:14976
v_add_u32 v36, 3127, v36
v_sub_u32 v36, v36, v37
v_lshl_add_u32 v36, v36, 1, s14
v_subrev_u32 v232, 448, v36
s_waitcnt lgkmcnt(10)
v_mfma_f32_32x32x16_bf16 v[16:31], v[120:123], v[124:127], v[16:31]
ds_read_b128 v[120:123], v6 offset:224
ds_read_b128 v[124:127], v219 offset:15008
v_subrev_u32 v233, 960, v36
v_subrev_u32 v234, 1472, v36
v_subrev_u32 v235, 1984, v36
v_subrev_u32 v236, 2048, v36
s_waitcnt lgkmcnt(10)
v_mfma_f32_32x32x16_bf16 v[16:31], v[128:131], v[132:135], v[16:31]
ds_read_b128 v[128:131], v6 offset:256
ds_read_b128 v[132:135], v219 offset:15040
v_lshl_add_u32 v37, v34, 1, v35
s_lshl_b32 s50, s3, 1
v_add_u32 v33, 1006, v37
v_bfe_u32 v36, v33, 1, 3
v_xor_b32 v36, s50, v36
s_waitcnt lgkmcnt(10)
v_mfma_f32_32x32x16_bf16 v[16:31], v[136:139], v[140:143], v[16:31]
ds_read_b128 v[136:139], v6 offset:288
ds_read_b128 v[140:143], v219 offset:15072
v_lshlrev_b32 v36, 4, v36
v_lshl_add_u32 v240, v33, 7, v36
v_add_u32 v33, 1002, v37
v_bfe_u32 v36, v33, 1, 3
s_waitcnt lgkmcnt(10)
v_mfma_f32_32x32x16_bf16 v[16:31], v[144:147], v[148:151], v[16:31]
ds_read_b128 v[144:147], v6 offset:320
ds_read_b128 v[148:151], v219 offset:15104
v_xor_b32 v36, s50, v36
v_lshlrev_b32 v36, 4, v36
v_lshl_add_u32 v241, v33, 7, v36
v_add_u32 v33, 998, v37
s_waitcnt lgkmcnt(10)
v_mfma_f32_32x32x16_bf16 v[16:31], v[152:155], v[156:159], v[16:31]
ds_read_b128 v[152:155], v6 offset:352
ds_read_b128 v[156:159], v219 offset:15136
v_bfe_u32 v36, v33, 1, 3
v_xor_b32 v36, s50, v36
v_lshlrev_b32 v36, 4, v36
v_lshl_add_u32 v242, v33, 7, v36
s_waitcnt lgkmcnt(10)
v_mfma_f32_32x32x16_bf16 v[16:31], v[112:115], v[116:119], v[16:31]
ds_read_b128 v[112:115], v6 offset:384
ds_read_b128 v[116:119], v219 offset:15168
v_add_u32 v33, 994, v37
v_bfe_u32 v36, v33, 1, 3
v_xor_b32 v36, s50, v36
v_lshlrev_b32 v36, 4, v36
s_waitcnt lgkmcnt(10)
v_mfma_f32_32x32x16_bf16 v[16:31], v[120:123], v[124:127], v[16:31]
ds_read_b128 v[120:123], v6 offset:416
ds_read_b128 v[124:127], v219 offset:15200
v_lshl_add_u32 v243, v33, 7, v36
v_add_u32 v33, 990, v37
v_bfe_u32 v36, v33, 1, 3
v_xor_b32 v36, s50, v36
s_waitcnt lgkmcnt(10)
v_mfma_f32_32x32x16_bf16 v[16:31], v[128:131], v[132:135], v[16:31]
ds_read_b128 v[128:131], v6 offset:448
ds_read_b128 v[132:135], v219 offset:15232
v_lshlrev_b32 v36, 4, v36
v_lshl_add_u32 v244, v33, 7, v36
v_add_u32 v33, 986, v37
v_bfe_u32 v36, v33, 1, 3
s_waitcnt lgkmcnt(10)
v_mfma_f32_32x32x16_bf16 v[16:31], v[136:139], v[140:143], v[16:31]
ds_read_b128 v[136:139], v6 offset:480
ds_read_b128 v[140:143], v219 offset:15264
v_xor_b32 v36, s50, v36
v_lshlrev_b32 v36, 4, v36
v_lshl_add_u32 v245, v33, 7, v36
v_add_u32 v33, 982, v37
s_waitcnt lgkmcnt(10)
v_mfma_f32_32x32x16_bf16 v[16:31], v[144:147], v[148:151], v[16:31]
v_bfe_u32 v36, v33, 1, 3
v_xor_b32 v36, s50, v36
v_lshlrev_b32 v36, 4, v36
v_lshl_add_u32 v246, v33, 7, v36
v_add_u32 v33, 978, v37
v_bfe_u32 v36, v33, 1, 3
s_waitcnt lgkmcnt(8)
v_mfma_f32_32x32x16_bf16 v[16:31], v[152:155], v[156:159], v[16:31]
v_xor_b32 v36, s50, v36
v_lshlrev_b32 v36, 4, v36
v_lshl_add_u32 v247, v33, 7, v36
v_add_u32 v33, 1005, v37
v_bfe_u32 v36, v33, 1, 3
v_xor_b32 v36, s50, v36
s_waitcnt lgkmcnt(6)
v_mfma_f32_32x32x16_bf16 v[16:31], v[112:115], v[116:119], v[16:31]
v_lshlrev_b32 v36, 4, v36
v_lshl_add_u32 v238, v33, 7, v36
v_lshrrev_b32 v33, 1, v35
v_lshl_add_u32 v33, v34, 1, v33
v_and_b32 v36, 7, v34
v_xor_b32 v36, s50, v36
s_waitcnt lgkmcnt(4)
v_mfma_f32_32x32x16_bf16 v[16:31], v[120:123], v[124:127], v[16:31]
v_lshlrev_b32 v36, 4, v36
v_lshl_add_u32 v248, v33, 7, v36
v_and_b32 v36, 1, v35
v_lshl_add_u32 v248, v36, 3, v248
v_add_u32 v248, 129024, v248
v_xor_b32 v249, 16, v248
s_waitcnt lgkmcnt(2)
v_mfma_f32_32x32x16_bf16 v[16:31], v[128:131], v[132:135], v[16:31]
v_lshlrev_b32 v252, 4, v34
v_lshl_add_u32 v252, v35, 2, v252
s_mul_i32 s51, s3, 33856
v_add_u32 v252, s51, v252
v_bfe_u32 v33, v2, 2, 2
v_mul_u32_u24 v33, 33856, v33
v_lshrrev_b32 v36, 4, v0
s_waitcnt lgkmcnt(0)
v_mfma_f32_32x32x16_bf16 v[16:31], v[136:139], v[140:143], v[16:31]
v_lshl_add_u32 v33, v36, 5, v33
v_and_b32 v36, 3, v2
v_lshl_add_u32 v253, v36, 3, v33
s_mul_i32 s51, s6, 16512
s_add_u32 s51, s51, 50606080
s_mov_b32 s60, s36
s_mov_b32 s61, s37
s_and_b32 s26, s2, 6
s_lshl_b32 s26, s26, 1
s_barrier
ds_write_b128 v7, v[8:11]
s_nop 7
s_nop 1
ds_write_b128 v223, v[8:11]
v_cvt_pk_bf16_f32 v12, v28, v29
v_cvt_pk_bf16_f32 v13, v27, v27
ds_write_b16 v222, v12 offset:32
ds_write_b16 v222, v12 offset:226
ds_write_b16_d16_hi v222, v12
ds_write_b16_d16_hi v222, v12 offset:194
v_readlane_b32 s52, v13, 63
v_cvt_pk_bf16_f32 v104, v27, v27
v_cvt_pk_bf16_f32 v105, v26, v26
v_cvt_pk_bf16_f32 v106, v26, v25
v_cvt_pk_bf16_f32 v107, v25, v25
ds_write_b128 v221, v[104:107] offset:4176
v_cvt_pk_bf16_f32 v108, v27, v27
v_cvt_pk_bf16_f32 v109, v27, v26
v_cvt_pk_bf16_f32 v110, v26, v26
v_cvt_pk_bf16_f32 v111, v25, v25
ds_write_b128 v221, v[108:111]
v_cvt_pk_bf16_f32 v96, v23, v22
v_cvt_pk_bf16_f32 v97, v21, v20
v_cvt_pk_bf16_f32 v98, v19, v18
v_cvt_pk_bf16_f32 v99, v17, v16
v_cvt_pk_bf16_f32 v100, v24, v23
v_cvt_pk_bf16_f32 v101, v22, v21
v_cvt_pk_bf16_f32 v102, v20, v19
v_cvt_pk_bf16_f32 v103, v18, v17
s_mov_b32 exec_lo, 0
v_cvt_pk_bf16_f32 v96, v20, v19
v_cvt_pk_bf16_f32 v97, v18, v18
v_cvt_pk_bf16_f32 v98, v18, v17
v_cvt_pk_bf16_f32 v99, v16, v16
v_cvt_pk_bf16_f32 v100, v20, v20
v_cvt_pk_bf16_f32 v101, v19, v18
v_cvt_pk_bf16_f32 v102, v18, v18
v_cvt_pk_bf16_f32 v103, v17, v16
s_mov_b32 exec_lo, -1
ds_write_b128 v220, v[96:99] offset:4176
ds_write_b128 v220, v[100:103]
v_cvt_pk_bf16_f32 v8, v16, v9
v_cndmask_b32 v8, 0, v8, s[54:55]
v_and_b32 v9, s52, v225
v_and_b32 v10, s52, v226
v_and_b32 v11, s52, v226
s_mov_b64 exec, 0xfff
ds_write_b128 v224, v[8:11]
s_mov_b64 exec, -1
s_bfe_u32 s27, s2, 0x20003
s_add_u32 s26, s26, s27
s_mul_i32 s26, s26, 576
s_and_b32 s27, s27, 1
s_lshl_b32 s27, s27, 6
s_add_u32 s26, s26, s27
s_mul_i32 s27, s3, 1056
v_and_b32 v33, 16, v2
v_lshrrev_b32 v33, 2, v33
v_and_b32 v36, 32, v2
v_lshrrev_b32 v36, 1, v36
v_add3_u32 v33, v33, v36, s3
v_mul_u32_u24 v33, 9216, v33
v_and_b32 v36, 0xf0, v210
v_add_u32 v228, v33, v36
v_mov_b32 v4, v210
s_waitcnt vmcnt(0) lgkmcnt(0)
s_barrier
ds_read_b128 a[128:131], v240 offset:0
ds_read2_b32 a[64:65], v232 offset0:112 offset1:113
ds_read2_b32 a[66:67], v232 offset0:114 offset1:115
ds_read_b128 a[132:135], v240 offset:4096
ds_read2_b32 a[68:69], v233 offset0:112 offset1:113
ds_read2_b32 a[70:71], v233 offset0:114 offset1:115
ds_read_b64 v[196:197], v248 offset:0
ds_read_b64 v[198:199], v249 offset:0
ds_read_b64 v[200:201], v248 offset:4096
ds_read_b64 v[202:203], v249 offset:4096
ds_read_b128 a[136:139], v241 offset:0
ds_read2_b32 a[72:73], v232 offset0:96 offset1:97
s_waitcnt lgkmcnt(9)
v_mfma_f32_16x16x32_bf16 v[36:39], a[64:67], a[128:131], 0
FPAD1:
s_cbranch_execz FPAD_ret
s_waitcnt lgkmcnt(8)
ds_read2_b32 a[74:75], v232 offset0:98 offset1:99
ds_read_b128 a[140:143], v241 offset:4096
v_mfma_f32_16x16x32_bf16 v[40:43], a[64:67], a[132:135], 0
s_waitcnt lgkmcnt(8)
ds_read2_b32 a[76:77], v233 offset0:96 offset1:97
ds_read2_b32 a[78:79], v233 offset0:98 offset1:99
v_mfma_f32_16x16x32_bf16 v[40:43], a[68:71], a[128:131], v[40:43]
ds_read_b128 a[144:147], v242 offset:0
ds_read2_b32 a[80:81], v232 offset0:80 offset1:81
v_mfma_f32_16x16x32_bf16 v[44:47], a[68:71], a[132:135], 0
s_waitcnt lgkmcnt(5)
ds_read2_b32 a[82:83], v232 offset0:82 offset1:83
ds_read_b128 a[148:151], v242 offset:4096
v_lshlrev_b32 v8, 16, v196
v_and_b32 v9, 0xffff0000, v196
v_mfma_f32_16x16x32_bf16 v[36:39], a[72:75], a[136:139], v[36:39]
s_waitcnt lgkmcnt(6)
ds_read2_b32 a[84:85], v233 offset0:80 offset1:81
ds_read2_b32 a[86:87], v233 offset0:82 offset1:83
v_lshlrev_b32 v10, 16, v197
v_mfma_f32_16x16x32_bf16 v[40:43], a[72:75], a[140:143], v[40:43]
s_waitcnt lgkmcnt(6)
ds_read_b128 a[152:155], v243 offset:0
ds_read2_b32 a[88:89], v232 offset0:64 offset1:65
v_and_b32 v11, 0xffff0000, v197
v_mfma_f32_16x16x32_bf16 v[40:43], a[76:79], a[136:139], v[40:43]
ds_read2_b32 a[90:91], v232 offset0:66 offset1:67
ds_read_b128 a[156:159], v243 offset:4096
v_lshlrev_b32 v196, 16, v198
v_mfma_f32_16x16x32_bf16 v[44:47], a[76:79], a[140:143], v[44:47]
s_waitcnt lgkmcnt(7)
ds_read2_b32 a[92:93], v233 offset0:64 offset1:65
ds_read2_b32 a[94:95], v233 offset0:66 offset1:67
v_and_b32 v197, 0xffff0000, v198
v_lshlrev_b32 v198, 16, v199
v_mfma_f32_16x16x32_bf16 v[36:39], a[80:83], a[144:147], v[36:39]
s_waitcnt lgkmcnt(8)
ds_read_b128 a[160:163], v244 offset:0
ds_read2_b32 a[96:97], v232 offset0:48 offset1:49
v_and_b32 v199, 0xffff0000, v199
v_mfma_f32_16x16x32_bf16 v[40:43], a[80:83], a[148:151], v[40:43]
s_waitcnt lgkmcnt(8)
ds_read2_b32 a[98:99], v232 offset0:50 offset1:51
ds_read_b128 a[164:167], v244 offset:4096
v_fmac_f32 v196, v8, v250
v_mfma_f32_16x16x32_bf16 v[40:43], a[84:87], a[144:147], v[40:43]
ds_read2_b32 a[100:101], v233 offset0:48 offset1:49
ds_read2_b32 a[102:103], v233 offset0:50 offset1:51
v_fmac_f32 v197, v9, v250
v_mfma_f32_16x16x32_bf16 v[44:47], a[84:87], a[148:151], v[44:47]
s_waitcnt lgkmcnt(9)
ds_read_b128 a[168:171], v245 offset:0
ds_read2_b32 a[104:105], v232 offset0:32 offset1:33
v_fmac_f32 v198, v10, v250
v_fmac_f32 v199, v11, v250
v_mfma_f32_16x16x32_bf16 v[36:39], a[88:91], a[152:155], v[36:39]
s_waitcnt lgkmcnt(10)
ds_read2_b32 a[106:107], v232 offset0:34 offset1:35
ds_read_b128 a[172:175], v245 offset:4096
v_lshlrev_b32 v8, 16, v200
v_mfma_f32_16x16x32_bf16 v[40:43], a[88:91], a[156:159], v[40:43]
s_waitcnt lgkmcnt(10)
ds_read2_b32 a[108:109], v233 offset0:32 offset1:33
ds_read2_b32 a[110:111], v233 offset0:34 offset1:35
v_and_b32 v9, 0xffff0000, v200
v_mfma_f32_16x16x32_bf16 v[40:43], a[92:95], a[152:155], v[40:43]
ds_read_b128 a[176:179], v246 offset:0
ds_read2_b32 a[112:113], v232 offset0:16 offset1:17
v_lshlrev_b32 v10, 16, v201
v_mfma_f32_16x16x32_bf16 v[44:47], a[92:95], a[156:159], v[44:47]
s_waitcnt lgkmcnt(11)
ds_read2_b32 a[114:115], v232 offset0:18 offset1:19
ds_read_b128 a[180:183], v246 offset:4096
v_and_b32 v11, 0xffff0000, v201
v_lshlrev_b32 v200, 16, v202
v_mfma_f32_16x16x32_bf16 v[36:39], a[96:99], a[160:163], v[36:39]
s_waitcnt lgkmcnt(12)
ds_read2_b32 a[116:117], v233 offset0:16 offset1:17
ds_read2_b32 a[118:119], v233 offset0:18 offset1:19
v_and_b32 v201, 0xffff0000, v202
v_mfma_f32_16x16x32_bf16 v[40:43], a[96:99], a[164:167], v[40:43]
s_waitcnt lgkmcnt(12)
ds_read_b128 a[184:187], v247 offset:0
ds_read2_b32 a[120:121], v232 offset0:0 offset1:1
v_lshlrev_b32 v202, 16, v203
v_mfma_f32_16x16x32_bf16 v[40:43], a[100:103], a[160:163], v[40:43]
s_waitcnt lgkmcnt(9)
ds_read2_b32 a[122:123], v232 offset0:2 offset1:3
ds_read_b128 a[188:191], v247 offset:4096
v_and_b32 v203, 0xffff0000, v203
v_mfma_f32_16x16x32_bf16 v[44:47], a[100:103], a[164:167], v[44:47]
ds_read2_b32 a[124:125], v233 offset0:0 offset1:1
ds_read2_b32 a[126:127], v233 offset0:2 offset1:3
v_fmac_f32 v200, v8, v250
v_fmac_f32 v201, v9, v250
v_mfma_f32_16x16x32_bf16 v[36:39], a[104:107], a[168:171], v[36:39]
s_waitcnt lgkmcnt(9)
ds_read_b128 v[108:111], v240 offset:8192
ds_read2_b32 v[76:77], v234 offset0:112 offset1:113
v_fmac_f32 v202, v10, v250
v_mfma_f32_16x16x32_bf16 v[40:43], a[104:107], a[172:175], v[40:43]
ds_read2_b32 v[78:79], v234 offset0:114 offset1:115
ds_read_b128 v[112:115], v240 offset:12288
v_fmac_f32 v203, v11, v250
v_mfma_f32_16x16x32_bf16 v[40:43], a[108:111], a[168:171], v[40:43]
s_waitcnt lgkmcnt(9)
ds_read2_b32 v[80:81], v235 offset0:112 offset1:113
ds_read2_b32 v[82:83], v235 offset0:114 offset1:115
v_mov_b32 v24, s12
v_mfma_f32_16x16x32_bf16 v[44:47], a[108:111], a[172:175], v[44:47]
ds_read_b128 v[116:119], v240 offset:16384
ds_read2_b32 v[84:85], v236 offset0:0 offset1:1
v_mul_u32_u24 v25, 8320, v0
s_lshl_b32 s15, s2, 5
s_add_u32 s30, s15, 46006272
v_mfma_f32_16x16x32_bf16 v[36:39], a[112:115], a[176:179], v[36:39]
s_waitcnt lgkmcnt(9)
ds_read2_b32 v[86:87], v236 offset0:2 offset1:3
ds_read_b128 v[120:123], v240 offset:20480
v_mfma_f32_16x16x32_bf16 v[40:43], a[112:115], a[180:183], v[40:43]
ds_read_b128 v[124:127], v240 offset:24576
ds_read_b128 v[128:131], v240 offset:28672
v_mfma_f32_16x16x32_bf16 v[40:43], a[116:119], a[176:179], v[40:43]
s_waitcnt lgkmcnt(9)
v_mfma_f32_16x16x32_bf16 v[44:47], a[116:119], a[180:183], v[44:47]
v_mfma_f32_16x16x32_bf16 v[36:39], a[120:123], a[184:187], v[36:39]
v_mfma_f32_16x16x32_bf16 v[40:43], a[120:123], a[188:191], v[40:43]
v_mfma_f32_16x16x32_bf16 v[40:43], a[124:127], a[184:187], v[40:43]
v_mfma_f32_16x16x32_bf16 v[44:47], a[124:127], a[188:191], v[44:47]
v_mfma_f32_16x16x32_bf16 v[44:47], a[64:67], v[108:111], v[44:47]
v_min_u32 v239, 31, v239
v_mov_b32 v22, 0x3f80
v_mfma_f32_16x16x32_bf16 v[44:47], v[76:79], a[128:131], v[44:47]
v_mov_b32 v20, 511
v_lshlrev_b32 v20, v239, v20
v_mfma_f32_16x16x32_bf16 v[48:51], a[68:71], v[108:111], 0
v_add_f32 v36, v36, v196
v_add_f32 v37, v37, v197
v_mfma_f32_16x16x32_bf16 v[48:51], v[76:79], a[132:135], v[48:51]
ds_read_b128 v[172:175], v241 offset:8192
v_add_f32 v38, v38, v198
v_mfma_f32_16x16x32_bf16 v[52:55], v[76:79], v[108:111], 0
s_waitcnt lgkmcnt(9)
v_add_f32 v39, v39, v199
v_cvt_pk_bf16_f32 v36, v36, v38
v_mfma_f32_16x16x32_bf16 v[48:51], a[64:67], v[112:115], v[48:51]
s_waitcnt lgkmcnt(7)
ds_read2_b32 v[140:141], v234 offset0:96 offset1:97
v_cvt_pk_bf16_f32 v37, v37, v39
v_mfma_f32_16x16x32_bf16 v[48:51], v[80:83], a[128:131], v[48:51]
ds_write2st64_b32 v252, v36, v37 offset0:9 offset1:11
v_add_f32 v40, v40, v200
v_mfma_f32_16x16x32_bf16 v[52:55], a[68:71], v[112:115], v[52:55]
ds_read2_b32 v[142:143], v234 offset0:98 offset1:99
v_add_f32 v41, v41, v201
v_mfma_f32_16x16x32_bf16 v[52:55], v[80:83], a[132:135], v[52:55]
v_add_f32 v42, v42, v202
v_add_f32 v43, v43, v203
v_mfma_f32_16x16x32_bf16 v[56:59], v[76:79], v[112:115], 0
ds_read_b128 v[176:179], v241 offset:12288
v_cvt_pk_bf16_f32 v40, v40, v42
v_mfma_f32_16x16x32_bf16 v[56:59], v[80:83], v[108:111], v[56:59]
v_cvt_pk_bf16_f32 v41, v41, v43
ds_write2st64_b32 v252, v40, v41 offset0:10 offset1:12
v_mfma_f32_16x16x32_bf16 v[60:63], v[80:83], v[112:115], 0
s_waitcnt lgkmcnt(11)
ds_read2_b32 v[144:145], v235 offset0:96 offset1:97
v_bfe_u32 v21, v20, 21, 1
v_mfma_f32_16x16x32_bf16 v[52:55], a[64:67], v[116:119], v[52:55]
s_waitcnt lgkmcnt(10)
ds_read2_b32 v[146:147], v235 offset0:98 offset1:99
v_bfe_u32 v12, v20, 20, 1
v_mfma_f32_16x16x32_bf16 v[52:55], v[84:87], a[128:131], v[52:55]
v_lshl_or_b32 v12, v21, 16, v12
v_mul_u32_u24 v12, v22, v12
v_mfma_f32_16x16x32_bf16 v[56:59], a[68:71], v[116:119], v[56:59]
ds_read_b128 v[180:183], v241 offset:16384
v_bfe_u32 v21, v20, 23, 1
v_mfma_f32_16x16x32_bf16 v[56:59], v[84:87], a[132:135], v[56:59]
v_bfe_u32 v13, v20, 22, 1
v_lshl_or_b32 v13, v21, 16, v13
v_mfma_f32_16x16x32_bf16 v[60:63], v[76:79], v[116:119], v[60:63]
ds_read_b128 v[184:187], v241 offset:20480
v_mul_u32_u24 v13, v22, v13
v_mfma_f32_16x16x32_bf16 v[60:63], v[84:87], v[108:111], v[60:63]
s_waitcnt lgkmcnt(9)
v_bfe_u32 v21, v20, 25, 1
v_bfe_u32 v14, v20, 24, 1
v_mfma_f32_16x16x32_bf16 v[64:67], v[80:83], v[116:119], 0
s_waitcnt lgkmcnt(4)
s_barrier
ds_read_b64_tr_b16 v[28:29], v253 offset:2304
ds_read_b64_tr_b16 v[30:31], v253 offset:2816
v_mfma_f32_16x16x32_bf16 v[64:67], v[84:87], v[112:115], v[64:67]
ds_read_b128 v[188:191], v241 offset:24576
v_lshl_or_b32 v14, v21, 16, v14
v_mfma_f32_16x16x32_bf16 v[56:59], a[64:67], v[120:123], v[56:59]
ds_read_b128 v[192:195], v241 offset:28672
v_mul_u32_u24 v14, v22, v14
v_mfma_f32_16x16x32_bf16 v[60:63], a[68:71], v[120:123], v[60:63]
v_bfe_u32 v21, v20, 27, 1
v_bfe_u32 v15, v20, 26, 1
v_mfma_f32_16x16x32_bf16 v[64:67], v[76:79], v[120:123], v[64:67]
v_lshl_or_b32 v15, v21, 16, v15
v_mul_u32_u24 v15, v22, v15
v_mfma_f32_16x16x32_bf16 v[60:63], a[64:67], v[124:127], v[60:63]
v_mov_b32 v20, 254
v_lshlrev_b32 v20, v239, v20
v_mfma_f32_16x16x32_bf16 v[64:67], a[68:71], v[124:127], v[64:67]
v_bfe_u32 v21, v20, 21, 1
v_bfe_u32 v16, v20, 20, 1
v_mfma_f32_16x16x32_bf16 v[64:67], a[64:67], v[128:131], v[64:67]
s_waitcnt lgkmcnt(2)
buffer_store_dwordx4 v[28:31], v4, s[8:11], s51 offen sc1
v_mfma_f32_16x16x32_bf16 v[44:47], a[72:75], v[172:175], v[44:47]
ds_read_b128 v[108:111], v242 offset:8192
v_lshl_or_b32 v16, v21, 16, v16
v_mfma_f32_16x16x32_bf16 v[44:47], v[140:143], a[136:139], v[44:47]
ds_read2_b32 v[76:77], v234 offset0:80 offset1:81
v_mul_u32_u24 v16, v22, v16
v_mfma_f32_16x16x32_bf16 v[48:51], a[76:79], v[172:175], v[48:51]
ds_read_b64 v[204:205], v248 offset:8192
v_bfe_u32 v21, v20, 23, 1
v_mfma_f32_16x16x32_bf16 v[48:51], v[140:143], a[140:143], v[48:51]
ds_read2_b32 v[78:79], v234 offset0:82 offset1:83
v_bfe_u32 v17, v20, 22, 1
v_mfma_f32_16x16x32_bf16 v[52:55], v[140:143], v[172:175], v[52:55]
ds_read_b64 v[206:207], v249 offset:8192
v_lshl_or_b32 v17, v21, 16, v17
v_mfma_f32_16x16x32_bf16 v[48:51], a[72:75], v[176:179], v[48:51]
ds_read_b128 v[112:115], v242 offset:12288
v_mul_u32_u24 v17, v22, v17
v_mfma_f32_16x16x32_bf16 v[48:51], v[144:147], a[136:139], v[48:51]
ds_read2_b32 v[80:81], v235 offset0:80 offset1:81
v_bfe_u32 v21, v20, 25, 1
v_mfma_f32_16x16x32_bf16 v[52:55], a[76:79], v[176:179], v[52:55]
s_add_u32 m0, s27, 8448
ds_read_b64 v[208:209], v248 offset:12288
v_bfe_u32 v18, v20, 24, 1
v_mfma_f32_16x16x32_bf16 v[52:55], v[144:147], a[140:143], v[52:55]
buffer_load_dwordx4 v228, s[60:63], s26 offen lds
s_add_u32 s26, s26, 73728
v_mfma_f32_16x16x32_bf16 v[56:59], v[140:143], v[176:179], v[56:59]
ds_read2_b32 v[82:83], v235 offset0:82 offset1:83
v_lshl_or_b32 v18, v21, 16, v18
v_mfma_f32_16x16x32_bf16 v[56:59], v[144:147], v[172:175], v[56:59]
ds_read_b64 v[210:211], v249 offset:12288
v_mul_u32_u24 v18, v22, v18
v_mfma_f32_16x16x32_bf16 v[60:63], v[144:147], v[176:179], v[60:63]
ds_read_b128 v[116:119], v242 offset:16384
v_bfe_u32 v21, v20, 27, 1
v_mfma_f32_16x16x32_bf16 v[52:55], a[72:75], v[180:183], v[52:55]
s_waitcnt lgkmcnt(9)
ds_read_b128 v[120:123], v242 offset:20480
v_bfe_u32 v19, v20, 26, 1
v_mfma_f32_16x16x32_bf16 v[56:59], a[76:79], v[180:183], v[56:59]
ds_read_b64 v[212:213], v248 offset:16384
v_lshl_or_b32 v19, v21, 16, v19
v_mfma_f32_16x16x32_bf16 v[60:63], v[140:143], v[180:183], v[60:63]
ds_read_b128 v[124:127], v242 offset:24576
v_mul_u32_u24 v19, v22, v19
v_mfma_f32_16x16x32_bf16 v[64:67], v[144:147], v[180:183], v[64:67]
s_add_u32 m0, s27, 12672
ds_read_b64 v[214:215], v249 offset:16384
v_mfma_f32_16x16x32_bf16 v[56:59], a[72:75], v[184:187], v[56:59]
s_waitcnt lgkmcnt(9)
buffer_load_dwordx4 v228, s[60:63], s26 offen lds
s_add_u32 s26, s26, 221184
v_mfma_f32_16x16x32_bf16 v[60:63], a[76:79], v[184:187], v[60:63]
ds_read_b128 v[128:131], v242 offset:28672
v_lshlrev_b32 v8, 16, v204
v_mfma_f32_16x16x32_bf16 v[64:67], v[140:143], v[184:187], v[64:67]
v_and_b32 v9, 0xffff0000, v204
v_lshlrev_b32 v10, 16, v205
v_mfma_f32_16x16x32_bf16 v[60:63], a[72:75], v[188:191], v[60:63]
v_and_b32 v11, 0xffff0000, v205
v_lshlrev_b32 v204, 16, v206
v_mfma_f32_16x16x32_bf16 v[64:67], a[76:79], v[188:191], v[64:67]
v_and_b32 v205, 0xffff0000, v206
v_lshlrev_b32 v206, 16, v207
v_mfma_f32_16x16x32_bf16 v[64:67], a[72:75], v[192:195], v[64:67]
v_and_b32 v207, 0xffff0000, v207
v_fmac_f32 v204, v8, v250
v_mfma_f32_16x16x32_bf16 v[44:47], a[80:83], v[108:111], v[44:47]
ds_read_b128 a[0:3], v238 offset:0
v_fmac_f32 v205, v9, v250
v_mfma_f32_16x16x32_bf16 v[44:47], v[76:79], a[144:147], v[44:47]
s_add_u32 m0, s27, 16896
ds_read_b128 a[4:7], v238 offset:4096
v_fmac_f32 v206, v10, v250
v_mfma_f32_16x16x32_bf16 v[48:51], a[84:87], v[108:111], v[48:51]
buffer_load_dwordx4 v228, s[60:63], s26 offen lds
s_add_u32 s26, s26, 73728
v_mfma_f32_16x16x32_bf16 v[48:51], v[76:79], a[148:151], v[48:51]
ds_read_b128 v[172:175], v243 offset:8192
v_fmac_f32 v207, v11, v250
v_mfma_f32_16x16x32_bf16 v[52:55], v[76:79], v[108:111], v[52:55]
s_waitcnt lgkmcnt(9)
ds_read2_b32 v[140:141], v234 offset0:64 offset1:65
v_lshlrev_b32 v8, 16, v208
v_mfma_f32_16x16x32_bf16 v[48:51], a[80:83], v[112:115], v[48:51]
ds_read_b128 a[8:11], v238 offset:8192
v_and_b32 v9, 0xffff0000, v208
v_mfma_f32_16x16x32_bf16 v[48:51], v[80:83], a[144:147], v[48:51]
ds_read2_b32 v[142:143], v234 offset0:66 offset1:67
v_lshlrev_b32 v10, 16, v209
v_mfma_f32_16x16x32_bf16 v[52:55], a[84:87], v[112:115], v[52:55]
ds_read_b128 a[12:15], v238 offset:12288
ds_read_b128 v[176:179], v243 offset:12288
v_mfma_f32_16x16x32_bf16 v[52:55], v[80:83], a[148:151], v[52:55]
s_waitcnt lgkmcnt(9)
ds_read2_b32 v[144:145], v235 offset0:64 offset1:65
v_and_b32 v11, 0xffff0000, v209
v_mfma_f32_16x16x32_bf16 v[56:59], v[76:79], v[112:115], v[56:59]
s_add_u32 m0, s27, 21120
ds_read_b128 a[16:19], v240 offset:0
v_lshlrev_b32 v208, 16, v210
v_mfma_f32_16x16x32_bf16 v[56:59], v[80:83], v[108:111], v[56:59]
buffer_load_dwordx4 v228, s[60:63], s26 offen lds
s_add_u32 s26, s26, 221184
v_mfma_f32_16x16x32_bf16 v[60:63], v[80:83], v[112:115], v[60:63]
ds_read2_b32 v[146:147], v235 offset0:66 offset1:67
v_and_b32 v209, 0xffff0000, v210
v_mfma_f32_16x16x32_bf16 v[52:55], a[80:83], v[116:119], v[52:55]
ds_read_b128 a[20:23], v240 offset:4096
ds_read_b128 v[180:183], v243 offset:16384
v_mfma_f32_16x16x32_bf16 v[56:59], a[84:87], v[116:119], v[56:59]
s_waitcnt lgkmcnt(9)
ds_read_b128 v[184:187], v243 offset:20480
v_lshlrev_b32 v210, 16, v211
v_mfma_f32_16x16x32_bf16 v[60:63], v[76:79], v[116:119], v[60:63]
ds_read_b128 a[24:27], v240 offset:8192
v_and_b32 v211, 0xffff0000, v211
v_mfma_f32_16x16x32_bf16 v[64:67], v[80:83], v[116:119], v[64:67]
ds_read_b128 v[188:191], v243 offset:24576
ds_read_b128 a[28:31], v240 offset:12288
v_mfma_f32_16x16x32_bf16 v[56:59], a[80:83], v[120:123], v[56:59]
s_waitcnt lgkmcnt(9)
ds_read_b128 v[192:195], v243 offset:28672
v_fmac_f32 v208, v8, v250
v_mfma_f32_16x16x32_bf16 v[60:63], a[84:87], v[120:123], v[60:63]
s_add_u32 m0, s27, 25344
v_fmac_f32 v209, v9, v250
v_fmac_f32 v210, v10, v250
v_mfma_f32_16x16x32_bf16 v[64:67], v[76:79], v[120:123], v[64:67]
buffer_load_dwordx4 v228, s[60:63], s26 offen lds
s_add_u32 s26, s26, 73728
v_mfma_f32_16x16x32_bf16 v[60:63], a[80:83], v[124:127], v[60:63]
v_fmac_f32 v211, v11, v250
v_lshlrev_b32 v8, 16, v212
v_mfma_f32_16x16x32_bf16 v[64:67], a[84:87], v[124:127], v[64:67]
v_and_b32 v9, 0xffff0000, v212
v_lshlrev_b32 v10, 16, v213
v_mfma_f32_16x16x32_bf16 v[64:67], a[80:83], v[128:131], v[64:67]
v_and_b32 v11, 0xffff0000, v213
v_lshlrev_b32 v212, 16, v214
v_mfma_f32_16x16x32_bf16 v[84:87], a[0:3], v[12:15], 0
s_waitcnt vmcnt(5)
s_barrier
s_cmp_lg_u32 s3, 0
s_cbranch_scc1 LF_pubE
s_mov_b64 exec, 255
buffer_store_dword v24, v25, s[8:11], s30 offen sc1
s_mov_b64 exec, -1
LF_pubE:
v_mfma_f32_16x16x32_bf16 v[88:91], a[4:7], v[12:15], 0
v_and_b32 v213, 0xffff0000, v214
v_lshlrev_b32 v214, 16, v215
v_mfma_f32_16x16x32_bf16 v[92:95], a[8:11], v[12:15], 0
ds_read_b128 v[108:111], v244 offset:8192
v_and_b32 v215, 0xffff0000, v215
v_mfma_f32_16x16x32_bf16 v[96:99], a[12:15], v[12:15], 0
s_waitcnt lgkmcnt(9)
s_add_u32 m0, s27, 29568
ds_read2_b32 v[76:77], v234 offset0:48 offset1:49
v_fmac_f32 v212, v8, v250
v_mfma_f32_16x16x32_bf16 v[148:151], a[16:19], v[16:19], 0
s_waitcnt lgkmcnt(8)
buffer_load_dwordx4 v228, s[60:63], s26 offen lds
s_add_u32 s26, s26, 221184
v_mfma_f32_16x16x32_bf16 v[152:155], a[20:23], v[16:19], 0
s_waitcnt lgkmcnt(5)
v_fmac_f32 v213, v9, v250
v_fmac_f32 v214, v10, v250
v_mfma_f32_16x16x32_bf16 v[156:159], a[24:27], v[16:19], 0
s_waitcnt lgkmcnt(3)
ds_read_b64 v[216:217], v248 offset:20480
v_fmac_f32 v215, v11, v250
v_mfma_f32_16x16x32_bf16 v[160:163], a[28:31], v[16:19], 0
ds_read2_b32 v[78:79], v234 offset0:50 offset1:51
v_mfma_f32_16x16x32_bf16 v[44:47], a[88:91], v[172:175], v[44:47]
ds_read_b64 v[218:219], v249 offset:20480
v_mfma_f32_16x16x32_bf16 v[44:47], v[140:143], a[152:155], v[44:47]
v_mfma_f32_16x16x32_bf16 v[48:51], a[92:95], v[172:175], v[48:51]
ds_read_b128 v[112:115], v244 offset:12288
v_mfma_f32_16x16x32_bf16 v[48:51], v[140:143], a[156:159], v[48:51]
s_add_u32 m0, s27, 42240
ds_read2_b32 v[80:81], v235 offset0:48 offset1:49
v_mfma_f32_16x16x32_bf16 v[52:55], v[140:143], v[172:175], v[52:55]
buffer_load_dwordx4 v228, s[60:63], s26 offen lds
s_add_u32 s26, s26, 73728
v_mfma_f32_16x16x32_bf16 v[48:51], a[88:91], v[176:179], v[48:51]
ds_read_b64 v[220:221], v248 offset:24576
v_mfma_f32_16x16x32_bf16 v[48:51], v[144:147], a[152:155], v[48:51]
v_mfma_f32_16x16x32_bf16 v[52:55], a[92:95], v[176:179], v[52:55]
ds_read2_b32 v[82:83], v235 offset0:50 offset1:51
v_mfma_f32_16x16x32_bf16 v[52:55], v[144:147], a[156:159], v[52:55]
ds_read_b64 v[222:223], v249 offset:24576
v_cvt_pk_bf16_f32 v84, v84, v85
v_mfma_f32_16x16x32_bf16 v[56:59], v[140:143], v[176:179], v[56:59]
ds_read_b128 v[116:119], v244 offset:16384
v_cvt_pk_bf16_f32 v85, v86, v87
v_mfma_f32_16x16x32_bf16 v[56:59], v[144:147], v[172:175], v[56:59]
v_cvt_pk_bf16_f32 v86, v88, v89
v_cvt_pk_bf16_f32 v87, v90, v91
v_mfma_f32_16x16x32_bf16 v[60:63], v[144:147], v[176:179], v[60:63]
s_add_u32 m0, s27, 46464
ds_read_b128 v[120:123], v244 offset:20480
v_cvt_pk_bf16_f32 v92, v92, v93
v_mfma_f32_16x16x32_bf16 v[52:55], a[88:91], v[180:183], v[52:55]
s_waitcnt lgkmcnt(9)
buffer_load_dwordx4 v228, s[60:63], s26 offen lds
s_add_u32 s26, s26, 221184
v_mfma_f32_16x16x32_bf16 v[56:59], a[92:95], v[180:183], v[56:59]
ds_read_b64 v[224:225], v248 offset:28672
v_cvt_pk_bf16_f32 v93, v94, v95
v_mfma_f32_16x16x32_bf16 v[60:63], v[140:143], v[180:183], v[60:63]
ds_read_b128 v[124:127], v244 offset:24576
v_cvt_pk_bf16_f32 v94, v96, v97
v_mfma_f32_16x16x32_bf16 v[64:67], v[144:147], v[180:183], v[64:67]
ds_read_b64 v[226:227], v249 offset:28672
v_cvt_pk_bf16_f32 v95, v98, v99
v_mfma_f32_16x16x32_bf16 v[56:59], a[88:91], v[184:187], v[56:59]
ds_read_b128 v[128:131], v244 offset:28672
v_cvt_pk_bf16_f32 v148, v148, v149
v_mfma_f32_16x16x32_bf16 v[60:63], a[92:95], v[184:187], v[60:63]
s_waitcnt lgkmcnt(9)
v_cvt_pk_bf16_f32 v149, v150, v151
v_cvt_pk_bf16_f32 v150, v152, v153
v_mfma_f32_16x16x32_bf16 v[64:67], v[140:143], v[184:187], v[64:67]
v_cvt_pk_bf16_f32 v151, v154, v155
v_cvt_pk_bf16_f32 v156, v156, v157
v_mfma_f32_16x16x32_bf16 v[60:63], a[88:91], v[188:191], v[60:63]
s_add_u32 m0, s27, 50688
v_cvt_pk_bf16_f32 v157, v158, v159
v_cvt_pk_bf16_f32 v158, v160, v161
v_mfma_f32_16x16x32_bf16 v[64:67], a[92:95], v[188:191], v[64:67]
buffer_load_dwordx4 v228, s[60:63], s26 offen lds
s_add_u32 s26, s26, 73728
v_mfma_f32_16x16x32_bf16 v[64:67], a[88:91], v[192:195], v[64:67]
v_cvt_pk_bf16_f32 v159, v162, v163
v_lshlrev_b32 v8, 16, v216
v_mfma_f32_16x16x32_bf16 v[44:47], a[96:99], v[108:111], v[44:47]
ds_read2_b32 a[32:33], v237 offset0:152 offset1:153
v_and_b32 v9, 0xffff0000, v216
v_mfma_f32_16x16x32_bf16 v[44:47], v[76:79], a[160:163], v[44:47]
ds_read2_b32 a[34:35], v237 offset0:160 offset1:161
v_lshlrev_b32 v10, 16, v217
v_mfma_f32_16x16x32_bf16 v[48:51], a[100:103], v[108:111], v[48:51]
ds_read_b128 v[172:175], v245 offset:8192
v_and_b32 v11, 0xffff0000, v217
v_mfma_f32_16x16x32_bf16 v[48:51], v[76:79], a[164:167], v[48:51]
ds_read2_b32 v[140:141], v234 offset0:32 offset1:33
v_lshlrev_b32 v216, 16, v218
v_mfma_f32_16x16x32_bf16 v[52:55], v[76:79], v[108:111], v[52:55]
s_waitcnt lgkmcnt(9)
ds_read2_b32 a[36:37], v237 offset0:144 offset1:145
v_and_b32 v217, 0xffff0000, v218
v_mfma_f32_16x16x32_bf16 v[48:51], a[96:99], v[112:115], v[48:51]
s_add_u32 m0, s27, 54912
ds_read2_b32 v[142:143], v234 offset0:34 offset1:35
ds_read2_b32 a[38:39], v237 offset0:152 offset1:153
v_mfma_f32_16x16x32_bf16 v[48:51], v[80:83], a[160:163], v[48:51]
buffer_load_dwordx4 v228, s[60:63], s26 offen lds
s_add_u32 s26, s26, 221184
v_mfma_f32_16x16x32_bf16 v[52:55], a[100:103], v[112:115], v[52:55]
ds_read_b128 v[176:179], v245 offset:12288
v_lshlrev_b32 v218, 16, v219
v_mfma_f32_16x16x32_bf16 v[52:55], v[80:83], a[164:167], v[52:55]
s_waitcnt lgkmcnt(9)
ds_read2_b32 v[144:145], v235 offset0:32 offset1:33
v_and_b32 v219, 0xffff0000, v219
v_mfma_f32_16x16x32_bf16 v[56:59], v[76:79], v[112:115], v[56:59]
ds_read2_b32 a[40:41], v237 offset0:136 offset1:137
v_fmac_f32 v216, v8, v250
v_mfma_f32_16x16x32_bf16 v[56:59], v[80:83], v[108:111], v[56:59]
ds_read2_b32 v[146:147], v235 offset0:34 offset1:35
v_fmac_f32 v217, v9, v250
v_mfma_f32_16x16x32_bf16 v[60:63], v[80:83], v[112:115], v[60:63]
ds_read2_b32 a[42:43], v237 offset0:144 offset1:145
v_fmac_f32 v218, v10, v250
v_mfma_f32_16x16x32_bf16 v[52:55], a[96:99], v[116:119], v[52:55]
s_waitcnt lgkmcnt(9)
ds_read_b128 v[180:183], v245 offset:16384
v_fmac_f32 v219, v11, v250
v_mfma_f32_16x16x32_bf16 v[56:59], a[100:103], v[116:119], v[56:59]
s_add_u32 m0, s27, 59136
ds_read_b128 v[184:187], v245 offset:20480
ds_read2_b32 a[44:45], v237 offset0:128 offset1:129
v_mfma_f32_16x16x32_bf16 v[60:63], v[76:79], v[116:119], v[60:63]
buffer_load_dwordx4 v228, s[60:63], s26 offen lds
s_add_u32 s26, s26, 73728
v_mfma_f32_16x16x32_bf16 v[64:67], v[80:83], v[116:119], v[64:67]
ds_read_b128 v[188:191], v245 offset:24576
v_lshlrev_b32 v8, 16, v220
v_mfma_f32_16x16x32_bf16 v[56:59], a[96:99], v[120:123], v[56:59]
s_waitcnt lgkmcnt(9)
ds_read2_b32 a[46:47], v237 offset0:136 offset1:137
ds_read_b128 v[192:195], v245 offset:28672
v_mfma_f32_16x16x32_bf16 v[60:63], a[100:103], v[120:123], v[60:63]
v_and_b32 v9, 0xffff0000, v220
v_lshlrev_b32 v10, 16, v221
v_mfma_f32_16x16x32_bf16 v[64:67], v[76:79], v[120:123], v[64:67]
v_and_b32 v11, 0xffff0000, v221
v_lshlrev_b32 v220, 16, v222
v_mfma_f32_16x16x32_bf16 v[60:63], a[96:99], v[124:127], v[60:63]
v_and_b32 v221, 0xffff0000, v222
v_lshlrev_b32 v222, 16, v223
v_mfma_f32_16x16x32_bf16 v[64:67], a[100:103], v[124:127], v[64:67]
v_and_b32 v223, 0xffff0000, v223
v_fmac_f32 v220, v8, v250
v_mfma_f32_16x16x32_bf16 v[64:67], a[96:99], v[128:131], v[64:67]
s_add_u32 m0, s27, 63360
v_fmac_f32 v221, v9, v250
v_fmac_f32 v222, v10, v250
v_mfma_f32_16x16x32_bf16 v[44:47], a[104:107], v[172:175], v[44:47]
buffer_load_dwordx4 v228, s[60:63], s26 offen lds
s_add_u32 s26, s26, 221184
v_mfma_f32_16x16x32_bf16 v[44:47], v[140:143], a[168:171], v[44:47]
ds_read2_b32 a[48:49], v237 offset0:24 offset1:25
v_fmac_f32 v223, v11, v250
v_mfma_f32_16x16x32_bf16 v[48:51], a[108:111], v[172:175], v[48:51]
ds_read2_b32 a[50:51], v237 offset0:32 offset1:33
v_lshlrev_b32 v8, 16, v224
v_mfma_f32_16x16x32_bf16 v[48:51], v[140:143], a[172:175], v[48:51]
s_waitcnt lgkmcnt(9)
ds_read_b128 v[108:111], v246 offset:8192
ds_read2_b32 v[76:77], v234 offset0:16 offset1:17
v_mfma_f32_16x16x32_bf16 v[52:55], v[140:143], v[172:175], v[52:55]
ds_read2_b32 a[52:53], v237 offset0:16 offset1:17
v_and_b32 v9, 0xffff0000, v224
v_mfma_f32_16x16x32_bf16 v[48:51], a[104:107], v[176:179], v[48:51]
ds_read2_b32 v[78:79], v234 offset0:18 offset1:19
v_lshlrev_b32 v10, 16, v225
v_mfma_f32_16x16x32_bf16 v[48:51], v[144:147], a[168:171], v[48:51]
s_waitcnt lgkmcnt(9)
ds_read2_b32 a[54:55], v237 offset0:24 offset1:25
v_and_b32 v11, 0xffff0000, v225
v_mfma_f32_16x16x32_bf16 v[52:55], a[108:111], v[176:179], v[52:55]
s_add_u32 m0, s27, 76032
ds_read_b128 v[112:115], v246 offset:12288
v_lshlrev_b32 v224, 16, v226
v_mfma_f32_16x16x32_bf16 v[52:55], v[144:147], a[172:175], v[52:55]
buffer_load_dwordx4 v228, s[60:63], s26 offen lds
s_add_u32 s26, s26, 73728
v_mfma_f32_16x16x32_bf16 v[56:59], v[140:143], v[176:179], v[56:59]
ds_read2_b32 v[80:81], v235 offset0:16 offset1:17
v_and_b32 v225, 0xffff0000, v226
v_mfma_f32_16x16x32_bf16 v[56:59], v[144:147], v[172:175], v[56:59]
FPAD2:
s_cbranch_execz FPAD_ret
ds_read2_b32 a[56:57], v237 offset0:8 offset1:9
v_lshlrev_b32 v226, 16, v227
v_mfma_f32_16x16x32_bf16 v[60:63], v[144:147], v[176:179], v[60:63]
s_waitcnt lgkmcnt(9)
ds_read2_b32 v[82:83], v235 offset0:18 offset1:19
ds_read2_b32 a[58:59], v237 offset0:16 offset1:17
v_mfma_f32_16x16x32_bf16 v[52:55], a[104:107], v[180:183], v[52:55]
ds_read_b128 v[116:119], v246 offset:16384
v_and_b32 v227, 0xffff0000, v227
v_mfma_f32_16x16x32_bf16 v[56:59], a[108:111], v[180:183], v[56:59]
ds_read_b128 v[120:123], v246 offset:20480
v_fmac_f32 v224, v8, v250
v_mfma_f32_16x16x32_bf16 v[60:63], v[140:143], v[180:183], v[60:63]
s_waitcnt lgkmcnt(9)
ds_read2_b32 a[60:61], v237 offset0:0 offset1:1
ds_read_b128 v[124:127], v246 offset:24576
v_mfma_f32_16x16x32_bf16 v[64:67], v[144:147], v[180:183], v[64:67]
s_add_u32 m0, s27, 80256
ds_read2_b32 a[62:63], v237 offset0:8 offset1:9
v_fmac_f32 v225, v9, v250
v_mfma_f32_16x16x32_bf16 v[56:59], a[104:107], v[184:187], v[56:59]
buffer_load_dwordx4 v228, s[60:63], s26 offen lds
s_add_u32 s26, s26, 221184
v_mfma_f32_16x16x32_bf16 v[60:63], a[108:111], v[184:187], v[60:63]
ds_read_b128 v[128:131], v246 offset:28672
v_fmac_f32 v226, v10, v250
v_mfma_f32_16x16x32_bf16 v[64:67], v[140:143], v[184:187], v[64:67]
s_waitcnt lgkmcnt(9)
v_fmac_f32 v227, v11, v250
s_and_b32 s65, s2, 7
v_mfma_f32_16x16x32_bf16 v[60:63], a[104:107], v[188:191], v[60:63]
s_mul_i32 s65, s65, 8320
s_add_u32 s65, s65, 45481984
v_mfma_f32_16x16x32_bf16 v[64:67], a[108:111], v[188:191], v[64:67]
s_lshl_b32 s15, s2, 5
s_add_u32 s15, s15, 45481984
v_mfma_f32_16x16x32_bf16 v[64:67], a[104:107], v[192:195], v[64:67]
v_mfma_f32_16x16x32_bf16 v[44:47], a[112:115], v[108:111], v[44:47]
v_mfma_f32_16x16x32_bf16 v[44:47], v[76:79], a[176:179], v[44:47]
s_add_u32 m0, s27, 84480
v_mfma_f32_16x16x32_bf16 v[48:51], a[116:119], v[108:111], v[48:51]
buffer_load_dwordx4 v228, s[60:63], s26 offen lds
s_add_u32 s26, s26, 73728
v_mfma_f32_16x16x32_bf16 v[48:51], v[76:79], a[180:183], v[48:51]
ds_read_b128 v[172:175], v247 offset:8192
v_mfma_f32_16x16x32_bf16 v[52:55], v[76:79], v[108:111], v[52:55]
v_mfma_f32_16x16x32_bf16 v[48:51], a[112:115], v[112:115], v[48:51]
s_waitcnt lgkmcnt(8)
v_mfma_f32_16x16x32_bf16 v[48:51], v[80:83], a[176:179], v[48:51]
ds_read2_b32 v[140:141], v234 offset0:0 offset1:1
v_mfma_f32_16x16x32_bf16 v[52:55], a[116:119], v[112:115], v[52:55]
v_mfma_f32_16x16x32_bf16 v[52:55], v[80:83], a[180:183], v[52:55]
v_mfma_f32_16x16x32_bf16 v[56:59], v[76:79], v[112:115], v[56:59]
s_add_u32 m0, s27, 88704
ds_read2_b32 v[142:143], v234 offset0:2 offset1:3
v_mfma_f32_16x16x32_bf16 v[56:59], v[80:83], v[108:111], v[56:59]
buffer_load_dwordx4 v228, s[60:63], s26 offen lds
s_add_u32 s26, s26, 221184
v_mfma_f32_16x16x32_bf16 v[60:63], v[80:83], v[112:115], v[60:63]
s_waitcnt lgkmcnt(8)
v_mfma_f32_16x16x32_bf16 v[52:55], a[112:115], v[116:119], v[52:55]
ds_read_b128 v[176:179], v247 offset:12288
v_mfma_f32_16x16x32_bf16 v[56:59], a[116:119], v[116:119], v[56:59]
v_mfma_f32_16x16x32_bf16 v[60:63], v[76:79], v[116:119], v[60:63]
v_mfma_f32_16x16x32_bf16 v[64:67], v[80:83], v[116:119], v[64:67]
s_waitcnt lgkmcnt(8)
ds_read2_b32 v[144:145], v235 offset0:0 offset1:1
v_mfma_f32_16x16x32_bf16 v[56:59], a[112:115], v[120:123], v[56:59]
v_mfma_f32_16x16x32_bf16 v[60:63], a[116:119], v[120:123], v[60:63]
s_add_u32 m0, s27, 92928
ds_read2_b32 v[146:147], v235 offset0:2 offset1:3
v_mfma_f32_16x16x32_bf16 v[64:67], v[76:79], v[120:123], v[64:67]
s_waitcnt lgkmcnt(8)
buffer_load_dwordx4 v228, s[60:63], s26 offen lds
s_add_u32 s26, s26, 73728
v_mfma_f32_16x16x32_bf16 v[60:63], a[112:115], v[124:127], v[60:63]
v_mfma_f32_16x16x32_bf16 v[64:67], a[116:119], v[124:127], v[64:67]
s_waitcnt lgkmcnt(6)
ds_read_b128 v[180:183], v247 offset:16384
v_mfma_f32_16x16x32_bf16 v[64:67], a[112:115], v[128:131], v[64:67]
v_mfma_f32_16x16x32_bf16 v[52:55], v[84:87], a[32:35], v[52:55]
v_mfma_f32_16x16x32_bf16 v[56:59], v[84:87], a[36:39], v[56:59]
ds_read_b128 v[184:187], v247 offset:20480
v_mfma_f32_16x16x32_bf16 v[60:63], v[84:87], a[40:43], v[60:63]
v_mfma_f32_16x16x32_bf16 v[64:67], v[84:87], a[44:47], v[64:67]
s_add_u32 m0, s27, 97152
ds_read_b128 v[188:191], v247 offset:24576
v_mfma_f32_16x16x32_bf16 v[60:63], v[92:95], a[32:35], v[60:63]
buffer_load_dwordx4 v228, s[60:63], s26 offen lds
s_add_u32 s26, s26, 221184
v_mfma_f32_16x16x32_bf16 v[64:67], v[92:95], a[36:39], v[64:67]
v_mfma_f32_16x16x32_bf16 v[52:55], v[148:151], a[48:51], v[52:55]
ds_read_b128 v[192:195], v247 offset:28672
v_mfma_f32_16x16x32_bf16 v[56:59], v[148:151], a[52:55], v[56:59]
v_mfma_f32_16x16x32_bf16 v[60:63], v[148:151], a[56:59], v[60:63]
v_mfma_f32_16x16x32_bf16 v[64:67], v[148:151], a[60:63], v[64:67]
v_mfma_f32_16x16x32_bf16 v[60:63], v[156:159], a[48:51], v[60:63]
v_mfma_f32_16x16x32_bf16 v[64:67], v[156:159], a[52:55], v[64:67]
s_waitcnt lgkmcnt(9)
s_add_u32 m0, s27, 109824
v_mfma_f32_16x16x32_bf16 v[44:47], a[120:123], v[172:175], v[44:47]
s_waitcnt lgkmcnt(7)
buffer_load_dwordx4 v228, s[60:63], s26 offen lds
s_add_u32 s26, s26, 73728
v_mfma_f32_16x16x32_bf16 v[44:47], v[140:143], a[184:187], v[44:47]
s_waitcnt lgkmcnt(6)
v_mfma_f32_16x16x32_bf16 v[48:51], a[120:123], v[176:179], v[48:51]
v_mfma_f32_16x16x32_bf16 v[48:51], a[124:127], v[172:175], v[48:51]
v_mfma_f32_16x16x32_bf16 v[48:51], v[140:143], a[188:191], v[48:51]
s_waitcnt lgkmcnt(4)
v_mfma_f32_16x16x32_bf16 v[48:51], v[144:147], a[184:187], v[48:51]
s_waitcnt lgkmcnt(3)
v_mfma_f32_16x16x32_bf16 v[52:55], a[120:123], v[180:183], v[52:55]
s_waitcnt lgkmcnt(0)
v_mfma_f32_16x16x32_bf16 v[52:55], a[124:127], v[176:179], v[52:55]
s_add_u32 m0, s27, 114048
v_mfma_f32_16x16x32_bf16 v[52:55], v[140:143], v[172:175], v[52:55]
buffer_load_dwordx4 v228, s[60:63], s26 offen lds
s_add_u32 s26, s26, 221184
v_mfma_f32_16x16x32_bf16 v[52:55], v[144:147], a[188:191], v[52:55]
v_add_f32 v44, v44, v204
v_add_f32 v45, v45, v205
v_mfma_f32_16x16x32_bf16 v[56:59], a[120:123], v[184:187], v[56:59]
v_add_f32 v46, v46, v206
v_add_f32 v47, v47, v207
v_mfma_f32_16x16x32_bf16 v[56:59], a[124:127], v[180:183], v[56:59]
v_cvt_pk_bf16_f32 v44, v44, v46
v_cvt_pk_bf16_f32 v45, v45, v47
v_mfma_f32_16x16x32_bf16 v[56:59], v[140:143], v[176:179], v[56:59]
ds_write2st64_b32 v252, v44, v45 offset0:2 offset1:10
v_mfma_f32_16x16x32_bf16 v[56:59], v[144:147], v[172:175], v[56:59]
v_add_f32 v48, v48, v208
v_add_f32 v49, v49, v209
v_mfma_f32_16x16x32_bf16 v[60:63], a[120:123], v[188:191], v[60:63]
v_add_f32 v50, v50, v210
v_add_f32 v51, v51, v211
v_mfma_f32_16x16x32_bf16 v[60:63], a[124:127], v[184:187], v[60:63]
v_cvt_pk_bf16_f32 v48, v48, v50
v_cvt_pk_bf16_f32 v49, v49, v51
v_mfma_f32_16x16x32_bf16 v[60:63], v[140:143], v[180:183], v[60:63]
ds_write2st64_b32 v252, v48, v49 offset0:3 offset1:11
v_mfma_f32_16x16x32_bf16 v[60:63], v[144:147], v[176:179], v[60:63]
v_add_f32 v52, v52, v212
v_add_f32 v53, v53, v213
v_mfma_f32_16x16x32_bf16 v[64:67], a[120:123], v[192:195], v[64:67]
v_add_f32 v54, v54, v214
v_add_f32 v55, v55, v215
v_mfma_f32_16x16x32_bf16 v[64:67], a[124:127], v[188:191], v[64:67]
v_cvt_pk_bf16_f32 v52, v52, v54
v_cvt_pk_bf16_f32 v53, v53, v55
v_mfma_f32_16x16x32_bf16 v[64:67], v[140:143], v[184:187], v[64:67]
ds_write2st64_b32 v252, v52, v53 offset0:4 offset1:12
v_mfma_f32_16x16x32_bf16 v[64:67], v[144:147], v[180:183], v[64:67]
v_add_f32 v56, v56, v216
v_add_f32 v57, v57, v217
v_add_f32 v58, v58, v218
v_add_f32 v59, v59, v219
v_cvt_pk_bf16_f32 v56, v56, v58
v_cvt_pk_bf16_f32 v57, v57, v59
ds_write2st64_b32 v252, v56, v57 offset0:5 offset1:13
s_nop 7
v_add_f32 v60, v60, v220
v_add_f32 v61, v61, v221
v_add_f32 v62, v62, v222
v_add_f32 v63, v63, v223
v_cvt_pk_bf16_f32 v60, v60, v62
v_cvt_pk_bf16_f32 v61, v61, v63
ds_write2st64_b32 v252, v60, v61 offset0:6 offset1:14
v_add_f32 v64, v64, v224
v_add_f32 v65, v65, v225
v_add_f32 v66, v66, v226
v_add_f32 v67, v67, v227
v_cvt_pk_bf16_f32 v64, v64, v66
v_cvt_pk_bf16_f32 v65, v65, v67
ds_write2st64_b32 v252, v64, v65 offset0:7 offset1:15
s_waitcnt lgkmcnt(0)
s_barrier
ds_read_b64_tr_b16 v[72:73], v253 offset:512
ds_read_b64_tr_b16 v[74:75], v253 offset:2560
ds_read_b64_tr_b16 v[76:77], v253 offset:1024
ds_read_b64_tr_b16 v[78:79], v253 offset:3072
ds_read_b64_tr_b16 v[80:81], v253 offset:1536
ds_read_b64_tr_b16 v[82:83], v253 offset:3584
s_waitcnt lgkmcnt(4)
s_add_u32 s51, s51, 4096
buffer_store_dwordx4 v[72:75], v4, s[8:11], s51 offen sc1
s_waitcnt lgkmcnt(2)
s_add_u32 s51, s51, 4096
buffer_store_dwordx4 v[76:79], v4, s[8:11], s51 offen sc1
s_waitcnt lgkmcnt(0)
s_add_u32 s51, s51, 4096
buffer_store_dwordx4 v[80:83], v4, s[8:11], s51 offen sc1
v_mov_b32 v212, s12
s_branch L3_start
LF_help:
v_lshrrev_b32 v1, 6, v0
v_and_b32 v2, 63, v0
s_mov_b32 s10, 268435456
v_readfirstlane_b32 s3, v1
s_mov_b32 s11, 0x20000
v_lshlrev_b32 v210, 4, v0
v_mov_b32 v251, 0
s_lshl_b32 s34, s3, 10
s_mov_b32 s62, 5308416
s_mov_b32 s63, 0x20000
s_add_u32 s32, s32, T_w-LF_pc
s_addc_u32 s33, s33, 0
s_lshl_b32 s15, s2, 5
s_add_u32 s15, s15, 47054848
s_mul_i32 s13, s2, 18560
s_add_u32 s13, s13, 53489664
s_sub_u32 s6, s2, 144
s_lshl_b32 s6, s6, 2
s_add_u32 s6, s6, s3
s_lshl_b32 s6, s6, 7
s_add_u32 s7, s6, 64
s_mov_b32 s70, 5308416
s_mov_b32 s71, 0x20000
v_mov_b32 v253, s6
global_load_dword v253, v253, s[32:33]
s_add_u32 s46, s8, 44449792
s_addc_u32 s47, s9, 0
s_load_dword s12, s[46:47], 0
s_mov_b32 s60, s36
s_mov_b32 s61, s37
s_mov_b32 s68, s40
s_mov_b32 s69, s41
v_mul_u32_u24 v5, 2368, v3
v_add_u32 v5, 135168, v5
v_lshl_add_u32 v216, v4, 5, v5
v_lshl_add_u32 v217, v4, 3, v5
v_bfe_u32 v3, v2, 2, 2
v_mul_u32_u24 v3, 2368, v3
v_lshrrev_b32 v4, 4, v0
v_lshl_add_u32 v3, v4, 5, v3
v_and_b32 v4, 3, v2
v_lshl_add_u32 v3, v4, 3, v3
v_add_u32 v218, 135168, v3
v_cmp_gt_u32 vcc, 128, v0
v_mov_b32 v211, 0x40000000
s_nop 0
v_cndmask_b32 v211, v211, v210, vcc
v_lshrrev_b32 v8, 3, v0
v_mul_u32_u24 v8, 9216, v8
v_and_b32 v9, 7, v0
v_lshl_add_u32 v8, v9, 4, v8
v_and_b32 v9, 16, v0
v_lshlrev_b32 v9, 1, v9
v_and_or_b32 v9, v0, 64, v9
v_xor_b32 v8, v8, v9
v_add_u32 v9, 0, v0
v_mul_u32_u24 v9, 3641, v9
v_lshrrev_b32 v9, 13, v9
v_and_b32 v9, 64, v9
v_xor_b32 v220, v9, v210
v_add_u32 v9, 256, v0
v_mul_u32_u24 v9, 3641, v9
v_lshrrev_b32 v9, 13, v9
v_and_b32 v9, 64, v9
v_xor_b32 v221, v9, v210
v_add_u32 v9, 512, v0
v_mul_u32_u24 v9, 3641, v9
v_lshrrev_b32 v9, 13, v9
v_and_b32 v9, 64, v9
v_xor_b32 v222, v9, v210
v_add_u32 v9, 768, v0
v_mul_u32_u24 v9, 3641, v9
v_lshrrev_b32 v9, 13, v9
v_and_b32 v9, 64, v9
v_xor_b32 v223, v9, v210
v_add_u32 v9, 1024, v0
v_mul_u32_u24 v9, 3641, v9
v_lshrrev_b32 v9, 13, v9
v_and_b32 v9, 64, v9
v_xor_b32 v224, v9, v210
v_add_u32 v9, 1280, v0
v_mul_u32_u24 v9, 3641, v9
v_lshrrev_b32 v9, 13, v9
v_and_b32 v9, 64, v9
v_xor_b32 v225, v9, v210
v_add_u32 v9, 1536, v0
v_mul_u32_u24 v9, 3641, v9
v_lshrrev_b32 v9, 13, v9
v_and_b32 v9, 64, v9
v_xor_b32 v226, v9, v210
v_add_u32 v9, 1792, v0
v_mul_u32_u24 v9, 3641, v9
v_lshrrev_b32 v9, 13, v9
v_and_b32 v9, 64, v9
v_xor_b32 v227, v9, v210
v_add_u32 v9, 2048, v0
v_mul_u32_u24 v9, 3641, v9
v_lshrrev_b32 v9, 13, v9
v_and_b32 v9, 64, v9
v_xor_b32 v228, v9, v210
v_and_b32 v5, 3, v2
v_lshlrev_b32 v4, 4, v2
v_and_b32 v15, 15, v2
v_lshlrev_b32 v15, 1, v15
v_lshrrev_b32 v11, 4, v2
v_cmp_gt_u32 s[96:97], 16, v2
v_lshlrev_b32 v10, 3, v11
v_bfe_u32 v9, v2, 2, 2
v_add_u32 v10, v10, v9
v_lshlrev_b32 v10, 7, v10
v_lshl_add_u32 v10, v5, 3, v10
s_lshl_b32 s7, s3, 5
s_add_u32 s7, s7, 0
v_add_u32 v10, s7, v10
v_and_b32 v9, 24, v2
v_lshlrev_b32 v9, 2, v9
v_xor_b32 v10, v10, v9
v_add_u32 v9, 49152, v10
v_mov_b32 v200, 0x3f803f80
v_mov_b32 v201, 0x3f803f80
v_mov_b32 v202, 0x3f803f80
v_mov_b32 v203, 0x3f803f80
v_lshrrev_b32 v7, 2, v2
v_mul_u32_u24 v7, 1152, v7
s_lshl_b32 s7, s3, 5
v_lshl_add_u32 v6, v5, 3, v7
v_add_u32 v6, s7, v6
s_lshl_b32 s7, s3, 8
v_lshl_add_u32 v7, v5, 4, v7
v_add_u32 v7, s7, v7
v_and_b32 v14, 8, v2
v_lshlrev_b32 v14, 3, v14
s_and_b32 s7, s5, 1
s_lshl_b32 s7, s7, 15
v_lshl_add_u32 v3, v0, 7, s7
v_min_u32 v254, L3_codeend-L3_start-4, v3
s_sub_u32 s52, s32, T_w-L3_start
s_subb_u32 s53, s33, 0
s_mov_b32 s50, 9216
s_mov_b32 s51, 0x20000
s_mov_b32 s48, s38
s_mov_b32 s49, s39
s_waitcnt vmcnt(1)
v_lshlrev_b32 v122, 16, v112
v_and_b32 v123, 0xffff0000, v112
v_lshlrev_b32 v124, 16, v113
v_and_b32 v125, 0xffff0000, v113
v_lshlrev_b32 v126, 16, v114
v_and_b32 v127, 0xffff0000, v114
v_lshlrev_b32 v128, 16, v115
v_and_b32 v129, 0xffff0000, v115
v_lshlrev_b32 v130, 16, v116
v_and_b32 v131, 0xffff0000, v116
v_lshlrev_b32 v132, 16, v117
v_and_b32 v133, 0xffff0000, v117
v_lshlrev_b32 v134, 16, v118
v_and_b32 v135, 0xffff0000, v118
v_lshlrev_b32 v136, 16, v119
v_and_b32 v137, 0xffff0000, v119
v_lshlrev_b32 v138, 16, v120
v_and_b32 v139, 0xffff0000, v120
v_pk_mul_f32 v[144:145], v[122:123], v[122:123]
v_pk_add_f32 v[140:141], v[122:123], v[124:125]
v_pk_fma_f32 v[144:145], v[124:125], v[124:125], v[144:145]
v_pk_add_f32 v[140:141], v[140:141], v[126:127]
v_pk_fma_f32 v[144:145], v[126:127], v[126:127], v[144:145]
v_pk_add_f32 v[140:141], v[140:141], v[128:129]
v_pk_fma_f32 v[144:145], v[128:129], v[128:129], v[144:145]
v_pk_add_f32 v[140:141], v[140:141], v[130:131]
v_pk_fma_f32 v[144:145], v[130:131], v[130:131], v[144:145]
v_pk_add_f32 v[140:141], v[140:141], v[132:133]
v_pk_fma_f32 v[144:145], v[132:133], v[132:133], v[144:145]
v_pk_add_f32 v[140:141], v[140:141], v[134:135]
v_pk_fma_f32 v[144:145], v[134:135], v[134:135], v[144:145]
v_pk_add_f32 v[140:141], v[140:141], v[136:137]
v_pk_fma_f32 v[144:145], v[136:137], v[136:137], v[144:145]
v_pk_add_f32 v[140:141], v[140:141], v[138:139]
v_pk_fma_f32 v[144:145], v[138:139], v[138:139], v[144:145]
v_add_f32 v140, v140, v141
v_add_f32 v144, v144, v145
s_nop 0
v_add_f32 v140, v140, v140 row_ror:8
v_add_f32 v144, v144, v144 row_ror:8
s_nop 0
v_add_f32 v140, v140, v140 row_ror:4
v_add_f32 v144, v144, v144 row_ror:4
s_nop 0
v_add_f32 v140, v140, v140 row_ror:2
v_add_f32 v144, v144, v144 row_ror:2
s_nop 0
v_add_f32 v140, v140, v140 row_ror:1
v_add_f32 v144, v144, v144 row_ror:1
v_mov_b32 v141, v140
v_mov_b32 v145, v144
s_nop 0
v_permlane16_swap_b32 v140, v141
v_permlane16_swap_b32 v144, v145
v_add_f32 v140, v140, v141
v_add_f32 v144, v144, v145
v_mul_f32 v140, 0x3ae38e39, v140
v_mul_f32 v144, 0x3ae38e39, v144
v_fma_f32 v144, -v140, v140, v144
v_max_f32 v144, 0, v144
v_cvt_pk_bf16_f32 v144, v144, v140
v_and_b32 v140, 0xffff0000, v144
v_lshlrev_b32 v144, 16, v144
v_add_f32 v144, 0x3727c5ac, v144
v_cvt_pk_bf16_f32 v144, v144, v144
v_lshlrev_b32 v144, 16, v144
v_sqrt_f32 v144, v144
v_pk_add_f32 v[148:149], v[122:123], v[140:141] op_sel_hi:[1,0] neg_lo:[0,1] neg_hi:[0,1]
v_cvt_pk_bf16_f32 v144, v144, v144
v_lshlrev_b32 v144, 16, v144
v_rcp_f32 v144, v144
v_pk_add_f32 v[150:151], v[124:125], v[140:141] op_sel_hi:[1,0] neg_lo:[0,1] neg_hi:[0,1]
v_pk_add_f32 v[152:153], v[126:127], v[140:141] op_sel_hi:[1,0] neg_lo:[0,1] neg_hi:[0,1]
v_pk_add_f32 v[154:155], v[128:129], v[140:141] op_sel_hi:[1,0] neg_lo:[0,1] neg_hi:[0,1]
v_pk_add_f32 v[156:157], v[130:131], v[140:141] op_sel_hi:[1,0] neg_lo:[0,1] neg_hi:[0,1]
v_pk_add_f32 v[158:159], v[132:133], v[140:141] op_sel_hi:[1,0] neg_lo:[0,1] neg_hi:[0,1]
v_pk_add_f32 v[160:161], v[134:135], v[140:141] op_sel_hi:[1,0] neg_lo:[0,1] neg_hi:[0,1]
v_pk_add_f32 v[162:163], v[136:137], v[140:141] op_sel_hi:[1,0] neg_lo:[0,1] neg_hi:[0,1]
v_pk_add_f32 v[164:165], v[138:139], v[140:141] op_sel_hi:[1,0] neg_lo:[0,1] neg_hi:[0,1]
v_cvt_pk_bf16_f32 v149, v148, v149
v_cvt_pk_bf16_f32 v151, v150, v151
v_cvt_pk_bf16_f32 v153, v152, v153
v_cvt_pk_bf16_f32 v155, v154, v155
v_cvt_pk_bf16_f32 v157, v156, v157
v_cvt_pk_bf16_f32 v159, v158, v159
v_cvt_pk_bf16_f32 v161, v160, v161
v_cvt_pk_bf16_f32 v163, v162, v163
v_cvt_pk_bf16_f32 v165, v164, v165
v_lshlrev_b32 v148, 16, v149
v_and_b32 v149, 0xffff0000, v149
v_lshlrev_b32 v150, 16, v151
v_and_b32 v151, 0xffff0000, v151
v_lshlrev_b32 v152, 16, v153
v_and_b32 v153, 0xffff0000, v153
v_lshlrev_b32 v154, 16, v155
v_and_b32 v155, 0xffff0000, v155
v_lshlrev_b32 v156, 16, v157
v_and_b32 v157, 0xffff0000, v157
v_lshlrev_b32 v158, 16, v159
v_and_b32 v159, 0xffff0000, v159
v_lshlrev_b32 v160, 16, v161
v_and_b32 v161, 0xffff0000, v161
v_lshlrev_b32 v162, 16, v163
v_and_b32 v163, 0xffff0000, v163
v_lshlrev_b32 v164, 16, v165
v_and_b32 v165, 0xffff0000, v165
v_pk_mul_f32 v[148:149], v[148:149], v[144:145] op_sel_hi:[1,0]
v_pk_mul_f32 v[150:151], v[150:151], v[144:145] op_sel_hi:[1,0]
v_pk_mul_f32 v[152:153], v[152:153], v[144:145] op_sel_hi:[1,0]
v_pk_mul_f32 v[154:155], v[154:155], v[144:145] op_sel_hi:[1,0]
v_pk_mul_f32 v[156:157], v[156:157], v[144:145] op_sel_hi:[1,0]
v_pk_mul_f32 v[158:159], v[158:159], v[144:145] op_sel_hi:[1,0]
v_pk_mul_f32 v[160:161], v[160:161], v[144:145] op_sel_hi:[1,0]
v_pk_mul_f32 v[162:163], v[162:163], v[144:145] op_sel_hi:[1,0]
v_pk_mul_f32 v[164:165], v[164:165], v[144:145] op_sel_hi:[1,0]
v_cvt_pk_bf16_f32 v148, v148, v122
v_cvt_pk_bf16_f32 v149, v149, v123
v_cvt_pk_bf16_f32 v150, v150, v124
v_cvt_pk_bf16_f32 v151, v151, v125
ds_write_b128 v216, v[148:151] offset:0
v_cvt_pk_bf16_f32 v152, v152, v126
v_cvt_pk_bf16_f32 v153, v153, v127
v_cvt_pk_bf16_f32 v154, v154, v128
v_cvt_pk_bf16_f32 v155, v155, v129
ds_write_b128 v216, v[152:155] offset:16
v_cvt_pk_bf16_f32 v156, v156, v130
v_cvt_pk_bf16_f32 v157, v157, v131
v_cvt_pk_bf16_f32 v158, v158, v132
v_cvt_pk_bf16_f32 v159, v159, v133
ds_write_b128 v216, v[156:159] offset:1024
v_cvt_pk_bf16_f32 v160, v160, v134
v_cvt_pk_bf16_f32 v161, v161, v135
v_cvt_pk_bf16_f32 v162, v162, v136
v_cvt_pk_bf16_f32 v163, v163, v137
ds_write_b128 v216, v[160:163] offset:1040
v_cvt_pk_bf16_f32 v164, v164, v138
v_cvt_pk_bf16_f32 v165, v165, v139
ds_write_b64 v217, v[164:165] offset:2048
s_waitcnt lgkmcnt(0)
s_barrier
ds_read_b64_tr_b16 v[176:177], v218 offset:0
ds_read_b64_tr_b16 v[178:179], v218 offset:9472
ds_read_b64_tr_b16 v[180:181], v218 offset:512
ds_read_b64_tr_b16 v[182:183], v218 offset:9984
ds_read_b64_tr_b16 v[184:185], v218 offset:1024
ds_read_b64_tr_b16 v[186:187], v218 offset:10496
ds_read_b64_tr_b16 v[188:189], v218 offset:1536
ds_read_b64_tr_b16 v[190:191], v218 offset:11008
ds_read_b64_tr_b16 v[192:193], v218 offset:2048
ds_read_b64_tr_b16 v[194:195], v218 offset:11520
s_mul_i32 s12, s12, 0x9e3779b1
s_add_u32 s12, s12, 0x7f4a7c15
v_mov_b32 v212, s12
s_waitcnt lgkmcnt(8)
buffer_store_dwordx4 v[176:179], v210, s[8:11], s13 offen sc1
s_add_u32 s13, s13, 4096
s_waitcnt lgkmcnt(6)
buffer_store_dwordx4 v[180:183], v210, s[8:11], s13 offen sc1
s_add_u32 s13, s13, 4096
s_waitcnt lgkmcnt(4)
buffer_store_dwordx4 v[184:187], v210, s[8:11], s13 offen sc1
s_add_u32 s13, s13, 4096
s_waitcnt lgkmcnt(2)
buffer_store_dwordx4 v[188:191], v210, s[8:11], s13 offen sc1
s_add_u32 s13, s13, 4096
s_waitcnt lgkmcnt(0)
buffer_store_dwordx4 v[192:195], v211, s[8:11], s13 offen sc1
s_add_u32 s7, s6, 64
s_load_dwordx16 s[16:31], s[32:33], s6
s_load_dwordx16 s[72:87], s[32:33], s7
s_waitcnt lgkmcnt(0)
s_add_u32 s7, s17, 0
s_and_b32 s7, s7, 0xc0
s_add_u32 s7, s7, 24576
v_add_u32 v232, s7, v7
v_xor_b32 v232, v232, v14
s_add_u32 s7, s17, 64
s_and_b32 s7, s7, 0xc0
s_add_u32 s7, s7, 24576
v_add_u32 v233, s7, v7
v_xor_b32 v233, v233, v14
s_add_u32 s7, s17, 128
s_and_b32 s7, s7, 0xc0
s_add_u32 s7, s7, 24576
v_add_u32 v234, s7, v7
v_xor_b32 v234, v234, v14
s_add_u32 s7, s17, 192
s_and_b32 s7, s7, 0xc0
s_add_u32 s7, s7, 24576
v_add_u32 v235, s7, v7
v_xor_b32 v235, v235, v14
v_add_u32 v236, 25600, v6
v_xor_b32 v236, v236, v14
s_waitcnt vmcnt(0)
v_mul_u32_u24 v213, 8320, v0
s_barrier
s_cmp_lg_u32 s3, 0
s_cbranch_scc1 LF_pub2
s_mov_b64 exec, 255
buffer_store_dword v212, v213, s[8:11], s15 offen sc1
s_mov_b64 exec, -1
LF_pub2:
s_bitcmp0_b32 s17, 2
s_cbranch_scc1 LF_nopf2
global_load_dword v254, v254, s[52:53]
LF_nopf2:
s_bitcmp1_b32 s17, 0
s_cbranch_scc1 LF_H
s_bitcmp0_b32 s17, 1
s_cbranch_scc1 LF_L1
s_add_u32 m0, s34, 73728
s_nop 0
buffer_load_dwordx4 v8, s[60:63], s24 offen lds
s_add_u32 s24, s24, 294912
s_add_u32 m0, s34, 77824
s_nop 0
buffer_load_dwordx4 v8, s[60:63], s24 offen lds
s_add_u32 s24, s24, 294912
s_add_u32 m0, s34, 81920
s_nop 0
buffer_load_dwordx4 v8, s[60:63], s24 offen lds
s_add_u32 s24, s24, 294912
s_add_u32 m0, s34, 86016
s_nop 0
buffer_load_dwordx4 v8, s[60:63], s24 offen lds
s_add_u32 s24, s24, 294912
s_add_u32 m0, s34, 90112
s_nop 0
buffer_load_dwordx4 v8, s[60:63], s24 offen lds
s_add_u32 s24, s24, 294912
s_add_u32 m0, s34, 94208
s_nop 0
buffer_load_dwordx4 v8, s[60:63], s24 offen lds
s_add_u32 s24, s24, 294912
s_and_b32 s7, s25, 0xffff
buffer_load_ushort v175, v15, s[48:51], s7 offen
LF_L1:
s_add_u32 m0, s34, 0
s_nop 0
buffer_load_dwordx4 v8, s[60:63], s85 offen lds
s_add_u32 s85, s85, 294912
s_add_u32 m0, s34, 4096
s_nop 0
buffer_load_dwordx4 v8, s[60:63], s85 offen lds
s_add_u32 s85, s85, 294912
s_add_u32 m0, s34, 8192
s_nop 0
buffer_load_dwordx4 v8, s[60:63], s85 offen lds
s_add_u32 s85, s85, 294912
s_add_u32 m0, s34, 12288
s_nop 0
buffer_load_dwordx4 v8, s[60:63], s85 offen lds
s_add_u32 s85, s85, 294912
s_add_u32 m0, s34, 16384
s_nop 0
buffer_load_dwordx4 v8, s[60:63], s85 offen lds
s_add_u32 s85, s85, 294912
s_add_u32 m0, s34, 20480
s_nop 0
buffer_load_dwordx4 v8, s[60:63], s85 offen lds
s_add_u32 s85, s85, 294912
s_and_b32 s7, s86, 0xffff
buffer_load_ushort v172, v15, s[48:51], s7 offen
s_add_u32 m0, s34, 24576
s_nop 0
buffer_load_dwordx4 v8, s[60:63], s18 offen lds
s_add_u32 s18, s18, 294912
s_add_u32 m0, s34, 28672
s_nop 0
buffer_load_dwordx4 v8, s[60:63], s18 offen lds
s_add_u32 s18, s18, 294912
s_add_u32 m0, s34, 32768
s_nop 0
buffer_load_dwordx4 v8, s[60:63], s18 offen lds
s_add_u32 s18, s18, 294912
s_add_u32 m0, s34, 36864
s_nop 0
buffer_load_dwordx4 v8, s[60:63], s18 offen lds
s_add_u32 s18, s18, 294912
s_add_u32 m0, s34, 40960
s_nop 0
buffer_load_dwordx4 v8, s[60:63], s18 offen lds
s_add_u32 s18, s18, 294912
s_add_u32 m0, s34, 45056
s_nop 0
buffer_load_dwordx4 v8, s[60:63], s18 offen lds
s_add_u32 s18, s18, 294912
s_and_b32 s7, s19, 0xffff
buffer_load_ushort v173, v15, s[48:51], s7 offen
s_add_u32 m0, s34, 49152
s_nop 0
buffer_load_dwordx4 v8, s[60:63], s21 offen lds
s_add_u32 s21, s21, 294912
s_add_u32 m0, s34, 53248
s_nop 0
buffer_load_dwordx4 v8, s[60:63], s21 offen lds
s_add_u32 s21, s21, 294912
s_add_u32 m0, s34, 57344
s_nop 0
buffer_load_dwordx4 v8, s[60:63], s21 offen lds
s_add_u32 s21, s21, 294912
s_add_u32 m0, s34, 61440
s_nop 0
buffer_load_dwordx4 v8, s[60:63], s21 offen lds
s_add_u32 s21, s21, 294912
s_add_u32 m0, s34, 65536
s_nop 0
buffer_load_dwordx4 v8, s[60:63], s21 offen lds
s_add_u32 s21, s21, 294912
s_add_u32 m0, s34, 69632
s_nop 0
buffer_load_dwordx4 v8, s[60:63], s21 offen lds
s_add_u32 s21, s21, 294912
s_and_b32 s7, s22, 0xffff
buffer_load_ushort v174, v15, s[48:51], s7 offen
s_waitcnt vmcnt(14)
s_barrier
s_bitcmp0_b32 s17, 1
s_cbranch_scc1 LF_L2
ds_read_b64_tr_b16 v[88:89], v9 offset:24576
ds_read_b64_tr_b16 v[90:91], v9 offset:25088
ds_read_b64_tr_b16 v[92:93], v9 offset:28672
ds_read_b64_tr_b16 v[94:95], v9 offset:29184
ds_read_b64_tr_b16 v[96:97], v9 offset:32768
ds_read_b64_tr_b16 v[98:99], v9 offset:33280
ds_read_b64_tr_b16 v[100:101], v9 offset:36864
ds_read_b64_tr_b16 v[102:103], v9 offset:37376
ds_read_b64_tr_b16 v[104:105], v9 offset:40960
ds_read_b64_tr_b16 v[106:107], v9 offset:41472
ds_read_b64_tr_b16 v[108:109], v9 offset:45056
ds_read_b64_tr_b16 v[110:111], v9 offset:45568
s_waitcnt lgkmcnt(10)
v_mfma_f32_16x16x32_bf16 v[204:207], v[200:203], v[88:91], 0
s_waitcnt lgkmcnt(8)
v_mfma_f32_16x16x32_bf16 v[204:207], v[200:203], v[92:95], v[204:207]
s_waitcnt lgkmcnt(6)
v_mfma_f32_16x16x32_bf16 v[204:207], v[200:203], v[96:99], v[204:207]
s_waitcnt lgkmcnt(4)
v_mfma_f32_16x16x32_bf16 v[204:207], v[200:203], v[100:103], v[204:207]
s_waitcnt lgkmcnt(2)
v_mfma_f32_16x16x32_bf16 v[204:207], v[200:203], v[104:107], v[204:207]
s_waitcnt lgkmcnt(0)
v_mfma_f32_16x16x32_bf16 v[204:207], v[200:203], v[108:111], v[204:207]
s_lshr_b32 s7, s25, 16
s_add_u32 s14, s7, 1
v_cmp_eq_u32 vcc, s14, v11
s_cmp_eq_u32 s7, 0
s_cselect_b32 s14, 0xffff, 0
s_or_b32 vcc_lo, vcc_lo, s14
v_mov_b32 v169, 0
v_mov_b32 v170, 0
v_mov_b32 v171, 0
v_cvt_pk_bf16_f32 v3, v204, v204
v_and_b32 v3, 0xffff0000, v3
v_sub_f32 v3, v204, v3
v_cvt_pk_bf16_f32 v168, v204, v3
v_cndmask_b32 v168, v168, v175, s[96:97]
s_mov_b64 exec, vcc
buffer_store_dwordx4 v[168:171], v4, s[8:11], s26 offen sc1
s_mov_b64 exec, -1
LF_L2:
ds_read_b64_tr_b16 v[16:17], v10 offset:0
ds_read_b64_tr_b16 v[18:19], v10 offset:512
ds_read_b64_tr_b16 v[20:21], v10 offset:4096
ds_read_b64_tr_b16 v[22:23], v10 offset:4608
ds_read_b64_tr_b16 v[24:25], v10 offset:8192
ds_read_b64_tr_b16 v[26:27], v10 offset:8704
ds_read_b64_tr_b16 v[28:29], v10 offset:12288
ds_read_b64_tr_b16 v[30:31], v10 offset:12800
ds_read_b64_tr_b16 v[32:33], v10 offset:16384
ds_read_b64_tr_b16 v[34:35], v10 offset:16896
ds_read_b64_tr_b16 v[36:37], v10 offset:20480
ds_read_b64_tr_b16 v[38:39], v10 offset:20992
s_waitcnt lgkmcnt(10)
v_mfma_f32_16x16x32_bf16 v[204:207], v[200:203], v[16:19], 0
s_waitcnt lgkmcnt(8)
v_mfma_f32_16x16x32_bf16 v[204:207], v[200:203], v[20:23], v[204:207]
s_waitcnt lgkmcnt(6)
v_mfma_f32_16x16x32_bf16 v[204:207], v[200:203], v[24:27], v[204:207]
s_waitcnt lgkmcnt(4)
v_mfma_f32_16x16x32_bf16 v[204:207], v[200:203], v[28:31], v[204:207]
s_waitcnt lgkmcnt(2)
v_mfma_f32_16x16x32_bf16 v[204:207], v[200:203], v[32:35], v[204:207]
s_waitcnt lgkmcnt(0)
v_mfma_f32_16x16x32_bf16 v[204:207], v[200:203], v[36:39], v[204:207]
s_lshr_b32 s7, s86, 16
s_add_u32 s14, s7, 1
v_cmp_eq_u32 vcc, s14, v11
s_cmp_eq_u32 s7, 0
s_cselect_b32 s14, 0xffff, 0
s_or_b32 vcc_lo, vcc_lo, s14
v_mov_b32 v157, 0
v_mov_b32 v158, 0
v_mov_b32 v159, 0
v_cvt_pk_bf16_f32 v3, v204, v204
v_and_b32 v3, 0xffff0000, v3
v_sub_f32 v3, v204, v3
v_cvt_pk_bf16_f32 v156, v204, v3
v_cndmask_b32 v156, v156, v172, s[96:97]
s_mov_b64 exec, vcc
buffer_store_dwordx4 v[156:159], v4, s[8:11], s87 offen sc1
s_mov_b64 exec, -1
s_waitcnt vmcnt(8)
s_barrier
ds_read_b64_tr_b16 v[40:41], v10 offset:24576
ds_read_b64_tr_b16 v[42:43], v10 offset:25088
ds_read_b64_tr_b16 v[44:45], v10 offset:28672
ds_read_b64_tr_b16 v[46:47], v10 offset:29184
ds_read_b64_tr_b16 v[48:49], v10 offset:32768
ds_read_b64_tr_b16 v[50:51], v10 offset:33280
ds_read_b64_tr_b16 v[52:53], v10 offset:36864
ds_read_b64_tr_b16 v[54:55], v10 offset:37376
ds_read_b64_tr_b16 v[56:57], v10 offset:40960
ds_read_b64_tr_b16 v[58:59], v10 offset:41472
ds_read_b64_tr_b16 v[60:61], v10 offset:45056
ds_read_b64_tr_b16 v[62:63], v10 offset:45568
s_waitcnt lgkmcnt(10)
v_mfma_f32_16x16x32_bf16 v[204:207], v[200:203], v[40:43], 0
s_waitcnt lgkmcnt(8)
v_mfma_f32_16x16x32_bf16 v[204:207], v[200:203], v[44:47], v[204:207]
s_waitcnt lgkmcnt(6)
v_mfma_f32_16x16x32_bf16 v[204:207], v[200:203], v[48:51], v[204:207]
s_waitcnt lgkmcnt(4)
v_mfma_f32_16x16x32_bf16 v[204:207], v[200:203], v[52:55], v[204:207]
s_waitcnt lgkmcnt(2)
v_mfma_f32_16x16x32_bf16 v[204:207], v[200:203], v[56:59], v[204:207]
s_waitcnt lgkmcnt(0)
v_mfma_f32_16x16x32_bf16 v[204:207], v[200:203], v[60:63], v[204:207]
s_lshr_b32 s7, s19, 16
s_add_u32 s14, s7, 1
v_cmp_eq_u32 vcc, s14, v11
s_cmp_eq_u32 s7, 0
s_cselect_b32 s14, 0xffff, 0
s_or_b32 vcc_lo, vcc_lo, s14
v_mov_b32 v161, 0
v_mov_b32 v162, 0
v_mov_b32 v163, 0
v_cvt_pk_bf16_f32 v3, v204, v204
v_and_b32 v3, 0xffff0000, v3
v_sub_f32 v3, v204, v3
v_cvt_pk_bf16_f32 v160, v204, v3
v_cndmask_b32 v160, v160, v173, s[96:97]
s_mov_b64 exec, vcc
buffer_store_dwordx4 v[160:163], v4, s[8:11], s20 offen sc1
s_mov_b64 exec, -1
s_waitcnt vmcnt(2)
s_barrier
ds_read_b64_tr_b16 v[64:65], v9 offset:0
ds_read_b64_tr_b16 v[66:67], v9 offset:512
ds_read_b64_tr_b16 v[68:69], v9 offset:4096
ds_read_b64_tr_b16 v[70:71], v9 offset:4608
ds_read_b64_tr_b16 v[72:73], v9 offset:8192
ds_read_b64_tr_b16 v[74:75], v9 offset:8704
ds_read_b64_tr_b16 v[76:77], v9 offset:12288
ds_read_b64_tr_b16 v[78:79], v9 offset:12800
ds_read_b64_tr_b16 v[80:81], v9 offset:16384
ds_read_b64_tr_b16 v[82:83], v9 offset:16896
ds_read_b64_tr_b16 v[84:85], v9 offset:20480
ds_read_b64_tr_b16 v[86:87], v9 offset:20992
s_waitcnt lgkmcnt(10)
v_mfma_f32_16x16x32_bf16 v[204:207], v[200:203], v[64:67], 0
s_waitcnt lgkmcnt(8)
v_mfma_f32_16x16x32_bf16 v[204:207], v[200:203], v[68:71], v[204:207]
s_waitcnt lgkmcnt(6)
v_mfma_f32_16x16x32_bf16 v[204:207], v[200:203], v[72:75], v[204:207]
s_waitcnt lgkmcnt(4)
v_mfma_f32_16x16x32_bf16 v[204:207], v[200:203], v[76:79], v[204:207]
s_waitcnt lgkmcnt(2)
v_mfma_f32_16x16x32_bf16 v[204:207], v[200:203], v[80:83], v[204:207]
s_waitcnt lgkmcnt(0)
v_mfma_f32_16x16x32_bf16 v[204:207], v[200:203], v[84:87], v[204:207]
s_lshr_b32 s7, s22, 16
s_add_u32 s14, s7, 1
v_cmp_eq_u32 vcc, s14, v11
s_cmp_eq_u32 s7, 0
s_cselect_b32 s14, 0xffff, 0
s_or_b32 vcc_lo, vcc_lo, s14
v_mov_b32 v165, 0
v_mov_b32 v166, 0
v_mov_b32 v167, 0
v_cvt_pk_bf16_f32 v3, v204, v204
v_and_b32 v3, 0xffff0000, v3
v_sub_f32 v3, v204, v3
v_cvt_pk_bf16_f32 v164, v204, v3
v_cndmask_b32 v164, v164, v174, s[96:97]
s_mov_b64 exec, vcc
buffer_store_dwordx4 v[164:167], v4, s[8:11], s23 offen sc1
s_mov_b64 exec, -1
s_branch LF_v5
LF_H:
s_add_u32 m0, s34, 24576
s_nop 0
buffer_load_dwordx4 v220, s[68:71], s16 offen nt lds
s_add_u32 s16, s16, 4096
s_add_u32 m0, s34, 28672
s_nop 0
buffer_load_dwordx4 v221, s[68:71], s16 offen nt lds
s_add_u32 s16, s16, 4096
s_add_u32 m0, s34, 32768
s_nop 0
buffer_load_dwordx4 v222, s[68:71], s16 offen nt lds
s_add_u32 s16, s16, 4096
s_add_u32 m0, s34, 36864
s_nop 0
buffer_load_dwordx4 v223, s[68:71], s16 offen nt lds
s_add_u32 s16, s16, 4096
s_add_u32 m0, s34, 40960
s_nop 0
buffer_load_dwordx4 v224, s[68:71], s16 offen nt lds
s_add_u32 s16, s16, 4096
s_add_u32 m0, s34, 45056
s_nop 0
buffer_load_dwordx4 v225, s[68:71], s16 offen nt lds
s_add_u32 s16, s16, 4096
s_add_u32 m0, s34, 49152
s_nop 0
buffer_load_dwordx4 v226, s[68:71], s16 offen nt lds
s_add_u32 s16, s16, 4096
s_add_u32 m0, s34, 53248
s_nop 0
buffer_load_dwordx4 v227, s[68:71], s16 offen nt lds
s_add_u32 s16, s16, 4096
s_add_u32 m0, s34, 57344
s_nop 0
buffer_load_dwordx4 v228, s[68:71], s16 offen nt lds
s_add_u32 s16, s16, 4096
s_add_u32 m0, s34, 61440
s_nop 0
buffer_load_dwordx4 v220, s[68:71], s16 offen nt lds
s_add_u32 s16, s16, 4096
s_add_u32 m0, s34, 65536
s_nop 0
buffer_load_dwordx4 v221, s[68:71], s16 offen nt lds
s_add_u32 s16, s16, 4096
s_add_u32 m0, s34, 69632
s_nop 0
buffer_load_dwordx4 v222, s[68:71], s16 offen nt lds
s_add_u32 s16, s16, 4096
s_add_u32 m0, s34, 73728
s_nop 0
buffer_load_dwordx4 v223, s[68:71], s16 offen nt lds
s_add_u32 s16, s16, 4096
s_add_u32 m0, s34, 77824
s_nop 0
buffer_load_dwordx4 v224, s[68:71], s16 offen nt lds
s_add_u32 s16, s16, 4096
s_add_u32 m0, s34, 81920
s_nop 0
buffer_load_dwordx4 v225, s[68:71], s16 offen nt lds
s_add_u32 s16, s16, 4096
s_add_u32 m0, s34, 86016
s_nop 0
buffer_load_dwordx4 v226, s[68:71], s16 offen nt lds
s_add_u32 s16, s16, 4096
s_add_u32 m0, s34, 90112
s_nop 0
buffer_load_dwordx4 v227, s[68:71], s16 offen nt lds
s_add_u32 s16, s16, 4096
s_add_u32 m0, s34, 94208
s_nop 0
buffer_load_dwordx4 v228, s[68:71], s16 offen nt lds
s_add_u32 s16, s16, 4096
s_add_u32 m0, s34, 98304
s_nop 0
buffer_load_dwordx4 v220, s[68:71], s16 offen nt lds
s_add_u32 s16, s16, 4096
s_add_u32 m0, s34, 102400
s_nop 0
buffer_load_dwordx4 v221, s[68:71], s16 offen nt lds
s_add_u32 s16, s16, 4096
s_add_u32 m0, s34, 106496
s_nop 0
buffer_load_dwordx4 v222, s[68:71], s16 offen nt lds
s_add_u32 s16, s16, 4096
s_add_u32 m0, s34, 110592
s_nop 0
buffer_load_dwordx4 v223, s[68:71], s16 offen nt lds
s_add_u32 s16, s16, 4096
s_add_u32 m0, s34, 114688
s_nop 0
buffer_load_dwordx4 v224, s[68:71], s16 offen nt lds
s_add_u32 s16, s16, 4096
s_add_u32 m0, s34, 118784
s_nop 0
buffer_load_dwordx4 v225, s[68:71], s16 offen nt lds
s_add_u32 s16, s16, 4096
s_add_u32 m0, s34, 122880
s_nop 0
buffer_load_dwordx4 v226, s[68:71], s16 offen nt lds
s_add_u32 s16, s16, 4096
s_add_u32 m0, s34, 126976
s_nop 0
buffer_load_dwordx4 v227, s[68:71], s16 offen nt lds
s_add_u32 s16, s16, 4096
s_add_u32 m0, s34, 131072
s_nop 0
buffer_load_dwordx4 v228, s[68:71], s16 offen nt lds
s_add_u32 s16, s16, 4096
s_waitcnt vmcnt(18)
s_barrier
ds_read_b64_tr_b16 v[40:41], v232 offset:0
ds_read_b64_tr_b16 v[42:43], v232 offset:18432
ds_read_b64_tr_b16 v[44:45], v232 offset:8
ds_read_b64_tr_b16 v[46:47], v232 offset:18440
ds_read_b64_tr_b16 v[48:49], v233 offset:0
ds_read_b64_tr_b16 v[50:51], v233 offset:18432
ds_read_b64_tr_b16 v[52:53], v233 offset:8
ds_read_b64_tr_b16 v[54:55], v233 offset:18440
ds_read_b64_tr_b16 v[56:57], v234 offset:0
ds_read_b64_tr_b16 v[58:59], v234 offset:18432
ds_read_b64_tr_b16 v[60:61], v234 offset:8
ds_read_b64_tr_b16 v[62:63], v234 offset:18440
ds_read_b64_tr_b16 v[64:65], v235 offset:0
ds_read_b64_tr_b16 v[66:67], v235 offset:18432
s_waitcnt lgkmcnt(12)
ds_read_b64_tr_b16 v[68:69], v235 offset:8
ds_read_b64_tr_b16 v[70:71], v235 offset:18440
s_waitcnt lgkmcnt(12)
ds_read_b64_tr_b16 v[72:73], v236 offset:0
ds_read_b64_tr_b16 v[74:75], v236 offset:18432
v_add_u32 v232, 36864, v232
v_add_u32 v233, 36864, v233
v_add_u32 v234, 36864, v234
v_add_u32 v235, 36864, v235
v_add_u32 v236, 36864, v236
buffer_store_dwordx4 v[40:43], v4, s[8:11], s18 offen sc1
buffer_store_dwordx4 v[44:47], v4, s[8:11], s19 offen sc1
s_waitcnt lgkmcnt(12)
buffer_store_dwordx4 v[48:51], v4, s[8:11], s20 offen sc1
s_waitcnt lgkmcnt(10)
buffer_store_dwordx4 v[52:55], v4, s[8:11], s21 offen sc1
s_waitcnt lgkmcnt(8)
buffer_store_dwordx4 v[56:59], v4, s[8:11], s22 offen sc1
s_waitcnt lgkmcnt(6)
buffer_store_dwordx4 v[60:63], v4, s[8:11], s23 offen sc1
s_waitcnt lgkmcnt(4)
buffer_store_dwordx4 v[64:67], v4, s[8:11], s24 offen sc1
s_waitcnt lgkmcnt(2)
buffer_store_dwordx4 v[68:71], v4, s[8:11], s25 offen sc1
s_waitcnt lgkmcnt(0)
buffer_store_dwordx4 v[72:75], v4, s[8:11], s26 offen sc1
s_waitcnt vmcnt(18)
s_barrier
ds_read_b64_tr_b16 v[76:77], v232 offset:0
ds_read_b64_tr_b16 v[78:79], v232 offset:18432
ds_read_b64_tr_b16 v[80:81], v232 offset:8
ds_read_b64_tr_b16 v[82:83], v232 offset:18440
ds_read_b64_tr_b16 v[84:85], v233 offset:0
ds_read_b64_tr_b16 v[86:87], v233 offset:18432
ds_read_b64_tr_b16 v[88:89], v233 offset:8
ds_read_b64_tr_b16 v[90:91], v233 offset:18440
ds_read_b64_tr_b16 v[92:93], v234 offset:0
ds_read_b64_tr_b16 v[94:95], v234 offset:18432
ds_read_b64_tr_b16 v[96:97], v234 offset:8
ds_read_b64_tr_b16 v[98:99], v234 offset:18440
ds_read_b64_tr_b16 v[100:101], v235 offset:0
ds_read_b64_tr_b16 v[102:103], v235 offset:18432
s_waitcnt lgkmcnt(12)
ds_read_b64_tr_b16 v[104:105], v235 offset:8
ds_read_b64_tr_b16 v[106:107], v235 offset:18440
s_waitcnt lgkmcnt(12)
ds_read_b64_tr_b16 v[108:109], v236 offset:0
ds_read_b64_tr_b16 v[110:111], v236 offset:18432
v_add_u32 v232, 36864, v232
v_add_u32 v233, 36864, v233
v_add_u32 v234, 36864, v234
v_add_u32 v235, 36864, v235
v_add_u32 v236, 36864, v236
buffer_store_dwordx4 v[76:79], v4, s[8:11], s27 offen sc1
buffer_store_dwordx4 v[80:83], v4, s[8:11], s28 offen sc1
s_waitcnt lgkmcnt(12)
buffer_store_dwordx4 v[84:87], v4, s[8:11], s29 offen sc1
s_waitcnt lgkmcnt(10)
buffer_store_dwordx4 v[88:91], v4, s[8:11], s30 offen sc1
s_waitcnt lgkmcnt(8)
buffer_store_dwordx4 v[92:95], v4, s[8:11], s31 offen sc1
s_waitcnt lgkmcnt(6)
buffer_store_dwordx4 v[96:99], v4, s[8:11], s72 offen sc1
s_waitcnt lgkmcnt(4)
buffer_store_dwordx4 v[100:103], v4, s[8:11], s73 offen sc1
s_waitcnt lgkmcnt(2)
buffer_store_dwordx4 v[104:107], v4, s[8:11], s74 offen sc1
s_waitcnt lgkmcnt(0)
buffer_store_dwordx4 v[108:111], v4, s[8:11], s75 offen sc1
s_waitcnt vmcnt(18)
s_barrier
ds_read_b64_tr_b16 v[112:113], v232 offset:0
ds_read_b64_tr_b16 v[114:115], v232 offset:18432
ds_read_b64_tr_b16 v[116:117], v232 offset:8
ds_read_b64_tr_b16 v[118:119], v232 offset:18440
ds_read_b64_tr_b16 v[120:121], v233 offset:0
ds_read_b64_tr_b16 v[122:123], v233 offset:18432
ds_read_b64_tr_b16 v[124:125], v233 offset:8
ds_read_b64_tr_b16 v[126:127], v233 offset:18440
ds_read_b64_tr_b16 v[128:129], v234 offset:0
ds_read_b64_tr_b16 v[130:131], v234 offset:18432
ds_read_b64_tr_b16 v[132:133], v234 offset:8
ds_read_b64_tr_b16 v[134:135], v234 offset:18440
ds_read_b64_tr_b16 v[136:137], v235 offset:0
ds_read_b64_tr_b16 v[138:139], v235 offset:18432
s_waitcnt lgkmcnt(12)
ds_read_b64_tr_b16 v[140:141], v235 offset:8
ds_read_b64_tr_b16 v[142:143], v235 offset:18440
s_waitcnt lgkmcnt(12)
ds_read_b64_tr_b16 v[144:145], v236 offset:0
ds_read_b64_tr_b16 v[146:147], v236 offset:18432
buffer_store_dwordx4 v[112:115], v4, s[8:11], s76 offen sc1
buffer_store_dwordx4 v[116:119], v4, s[8:11], s77 offen sc1
s_waitcnt lgkmcnt(12)
buffer_store_dwordx4 v[120:123], v4, s[8:11], s78 offen sc1
s_waitcnt lgkmcnt(10)
buffer_store_dwordx4 v[124:127], v4, s[8:11], s79 offen sc1
s_waitcnt lgkmcnt(8)
buffer_store_dwordx4 v[128:131], v4, s[8:11], s80 offen sc1
s_waitcnt lgkmcnt(6)
buffer_store_dwordx4 v[132:135], v4, s[8:11], s81 offen sc1
s_waitcnt lgkmcnt(4)
buffer_store_dwordx4 v[136:139], v4, s[8:11], s82 offen sc1
s_waitcnt lgkmcnt(2)
buffer_store_dwordx4 v[140:143], v4, s[8:11], s83 offen sc1
s_waitcnt lgkmcnt(0)
buffer_store_dwordx4 v[144:147], v4, s[8:11], s84 offen sc1
LF_v5:
s_and_b32 s65, s2, 7
s_mul_i32 s65, s65, 8320
s_add_u32 s65, s65, 45481984
s_lshl_b32 s15, s2, 5
s_add_u32 s15, s15, 45481984
s_barrier
s_branch L3_start
LF_codeend:
.p2align 12
L3_start:
s_mov_b32 s20, s3
s_and_b32 s50, s2, 7
s_lshr_b32 s51, s2, 3
s_lshr_b32 s22, s50, 1
s_and_b32 s23, s51, 3
s_lshl_b32 s24, s22, 2
s_add_u32 s24, s24, s23
s_mul_i32 s25, s24, 356352
s_add_u32 s25, s25, 2359296
s_mul_i32 s26, s20, 1056
v_min_u32 v214, 143, v0
v_lshlrev_b32 v214, 5, v214
v_min_u32 v215, 111, v0
v_lshlrev_b32 v215, 5, v215
v_add_u32 v215, 4608, v215
v_lshlrev_b32 v2, 4, v0
v_and_b32 v0, 63, v0
v_lshlrev_b32 v1, 4, v0
s_mov_b32 s60, s36
s_mov_b32 s61, s37
s_and_b32 s87, s23, 1
s_lshl_b32 s85, s87, 6
s_mul_i32 s86, s24, 576
s_add_u32 s84, s86, s85
v_and_b32 v8, 16, v0
v_lshrrev_b32 v8, 2, v8
v_and_b32 v9, 32, v0
v_lshrrev_b32 v9, 1, v9
v_add3_u32 v8, v8, v9, s20
v_mul_u32_u24 v8, 9216, v8
v_and_b32 v9, 0xf0, v1
v_add_u32 v240, v8, v9
s_cmp_lt_u32 s2, 144
s_cbranch_scc1 L3_pre
s_add_u32 m0, s26, 8448
s_nop 0
buffer_load_dwordx4 v240, s[60:63], s84 offen  lds
s_add_u32 s84, s84, 73728
s_add_u32 m0, s26, 12672
s_nop 0
buffer_load_dwordx4 v240, s[60:63], s84 offen  lds
s_add_u32 s84, s84, 221184
s_add_u32 m0, s26, 16896
s_nop 0
buffer_load_dwordx4 v240, s[60:63], s84 offen  lds
s_add_u32 s84, s84, 73728
s_add_u32 m0, s26, 21120
s_nop 0
buffer_load_dwordx4 v240, s[60:63], s84 offen  lds
s_add_u32 s84, s84, 221184
s_add_u32 m0, s26, 25344
s_nop 0
buffer_load_dwordx4 v240, s[60:63], s84 offen  lds
s_add_u32 s84, s84, 73728
s_add_u32 m0, s26, 29568
s_nop 0
buffer_load_dwordx4 v240, s[60:63], s84 offen  lds
s_add_u32 s84, s84, 221184
s_add_u32 m0, s26, 42240
s_nop 0
buffer_load_dwordx4 v240, s[60:63], s84 offen  lds
s_add_u32 s84, s84, 73728
s_add_u32 m0, s26, 46464
s_nop 0
buffer_load_dwordx4 v240, s[60:63], s84 offen  lds
s_add_u32 s84, s84, 221184
s_add_u32 m0, s26, 50688
s_nop 0
buffer_load_dwordx4 v240, s[60:63], s84 offen  lds
s_add_u32 s84, s84, 73728
s_add_u32 m0, s26, 54912
s_nop 0
buffer_load_dwordx4 v240, s[60:63], s84 offen  lds
s_add_u32 s84, s84, 221184
s_add_u32 m0, s26, 59136
s_nop 0
buffer_load_dwordx4 v240, s[60:63], s84 offen  lds
s_add_u32 s84, s84, 73728
s_add_u32 m0, s26, 63360
s_nop 0
buffer_load_dwordx4 v240, s[60:63], s84 offen  lds
s_add_u32 s84, s84, 221184
s_add_u32 m0, s26, 76032
s_nop 0
buffer_load_dwordx4 v240, s[60:63], s84 offen  lds
s_add_u32 s84, s84, 73728
s_add_u32 m0, s26, 80256
s_nop 0
buffer_load_dwordx4 v240, s[60:63], s84 offen  lds
s_add_u32 s84, s84, 221184
s_add_u32 m0, s26, 84480
s_nop 0
buffer_load_dwordx4 v240, s[60:63], s84 offen  lds
s_add_u32 s84, s84, 73728
s_add_u32 m0, s26, 88704
s_nop 0
buffer_load_dwordx4 v240, s[60:63], s84 offen  lds
s_add_u32 s84, s84, 221184
s_add_u32 m0, s26, 92928
s_nop 0
buffer_load_dwordx4 v240, s[60:63], s84 offen  lds
s_add_u32 s84, s84, 73728
s_add_u32 m0, s26, 97152
s_nop 0
buffer_load_dwordx4 v240, s[60:63], s84 offen  lds
s_add_u32 s84, s84, 221184
s_add_u32 m0, s26, 109824
s_nop 0
buffer_load_dwordx4 v240, s[60:63], s84 offen  lds
s_add_u32 s84, s84, 73728
s_add_u32 m0, s26, 114048
s_nop 0
buffer_load_dwordx4 v240, s[60:63], s84 offen  lds
s_add_u32 s84, s84, 221184
s_branch L3_pre2
L3_pre:
s_add_u32 s84, s84, 2949120
L3_pre2:
s_and_b32 s50, s50, 1
s_lshr_b32 s51, s51, 2
s_sub_u32 s51, 7, s51
s_lshl_b32 s51, s51, 1
s_add_u32 s21, s50, s51
s_add_u32 s64, s65, 524288
s_cmp_lt_u32 s21, 4
s_cselect_b32 s64, s64, s65
v_and_b32 v8, 15, v0
v_lshrrev_b32 v9, 4, v0
v_mul_u32_u24 v3, 33024, v9
v_lshl_add_u32 v3, v8, 4, v3
v_add_u32 v255, 16512, v3
s_lshl_b32 s35, s21, 2
s_add_u32 s35, s35, s20
s_lshl_b32 s35, s35, 5
s_lshl_b32 s27, s35, 3
s_add_u32 s27, s27, 50606080
v_bfe_u32 v10, v0, 2, 3
v_mul_u32_u24 v12, 1056, v10
v_and_b32 v10, 3, v0
v_lshlrev_b32 v244, 3, v10
v_and_b32 v10, 32, v0
v_lshl_add_u32 v244, v10, 4, v244
v_add_u32 v12, v12, v244
v_mul_u32_u24 v184, 16512, v9
v_lshl_add_u32 v184, v8, 4, v184
v_cmp_gt_u32 s[40:41], 16, v0
v_mov_b32 v185, 0x40000000
s_mul_i32 s37, s24, 148608
s_add_u32 s37, s37, s27
v_cndmask_b32 v185, v185, v184, s[40:41]
v_lshlrev_b32 v186, 4, v8
v_lshl_add_u32 v186, v9, 2, v186
v_lshlrev_b32 v187, 9, v8
s_lshl_b32 s39, s35, 7
s_add_u32 s39, s39, 44957696
s_lshl_b32 s50, s24, 8
s_add_u32 s46, s39, s50
s_lshl_b32 s47, s21, 6
s_add_u32 s47, s47, s20
s_lshl_b32 s47, s47, 7
s_add_u32 s47, s47, 39583744
s_lshl_b32 s32, s24, 9
s_add_u32 s32, s32, s47
s_mov_b32 s67, 0x3f803f80
s_add_u32 s38, s12, 1
s_add_u32 s4, s12, 2
s_add_u32 s5, s12, 3
s_add_u32 s6, s12, 4
s_add_u32 s7, s12, 5
v_cmp_eq_u32 vcc, 0, v0
v_mov_b32 v4, 0x40000000
s_nop 0
v_cndmask_b32 v4, v4, 0, vcc
s_waitcnt lgkmcnt(0)
s_mov_b32 s66, s15
v_mul_u32_u24 v213, 8320, v0
s_waitcnt vmcnt(20)
s_cmp_ge_u32 s2, 144
s_cbranch_scc1 L3_pubh
s_waitcnt vmcnt(0)
L3_pubh:
s_barrier
s_cmp_lg_u32 s20, 0
s_cbranch_scc1 L3_pubd
s_mov_b64 exec, 255
buffer_store_dword v212, v213, s[8:11], s66 offen sc1
s_mov_b64 exec, -1
L3_pubd:
s_add_u32 m0, s26, 0
s_nop 0
buffer_load_dwordx4 v240, s[60:63], s84 offen  lds
s_add_u32 s84, s84, 73728
s_add_u32 m0, s26, 4224
s_nop 0
buffer_load_dwordx4 v240, s[60:63], s84 offen  lds
s_add_u32 s84, s84, 221184
s_add_u32 m0, s26, 33792
s_nop 0
buffer_load_dwordx4 v240, s[60:63], s84 offen  lds
s_add_u32 s84, s84, 73728
s_add_u32 m0, s26, 38016
s_nop 0
buffer_load_dwordx4 v240, s[60:63], s84 offen  lds
s_add_u32 s84, s84, 221184
s_add_u32 m0, s26, 67584
s_nop 0
buffer_load_dwordx4 v240, s[60:63], s84 offen  lds
s_add_u32 s84, s84, 73728
s_add_u32 m0, s26, 71808
s_nop 0
buffer_load_dwordx4 v240, s[60:63], s84 offen  lds
s_add_u32 s84, s84, 221184
s_add_u32 m0, s26, 101376
s_nop 0
buffer_load_dwordx4 v240, s[60:63], s84 offen  lds
s_add_u32 s84, s84, 73728
s_add_u32 m0, s26, 105600
s_nop 0
buffer_load_dwordx4 v240, s[60:63], s84 offen  lds
s_add_u32 s84, s84, 221184
s_add_u32 m0, s26, 118272
s_nop 0
buffer_load_dwordx4 v240, s[60:63], s84 offen  lds
s_add_u32 s84, s84, 73728
s_add_u32 m0, s26, 122496
s_nop 0
buffer_load_dwordx4 v240, s[60:63], s84 offen  lds
s_add_u32 s84, s84, 221184
s_add_u32 m0, s26, 126720
s_nop 0
buffer_load_dwordx4 v240, s[60:63], s84 offen  lds
s_add_u32 s84, s84, 73728
s_add_u32 m0, s26, 130944
s_nop 0
buffer_load_dwordx4 v240, s[60:63], s84 offen  lds
s_add_u32 s84, s84, 221184
s_add_u32 m0, s26, 135168
s_nop 0
buffer_load_dwordx4 v240, s[60:63], s84 offen  lds
s_add_u32 s84, s84, 73728
s_add_u32 m0, s26, 139392
s_nop 0
buffer_load_dwordx4 v240, s[60:63], s84 offen  lds
s_add_u32 s84, s84, 221184
s_add_u32 m0, s26, 143616
s_nop 0
buffer_load_dwordx4 v240, s[60:63], s84 offen  lds
s_add_u32 s84, s84, 73728
s_add_u32 m0, s26, 147840
s_nop 0
buffer_load_dwordx4 v240, s[60:63], s84 offen  lds
s_add_u32 s84, s84, 221184
s_mov_b64 exec, 0
s_cmp_eq_u32 s20, 0
s_cbranch_scc1 PADW0
s_cmp_eq_u32 s20, 1
s_cbranch_scc1 PADW1
s_cmp_eq_u32 s20, 2
s_cbranch_scc1 PADW2
s_branch PADW3
PAD_ret:
s_mov_b64 exec, -1
s_cmp_lt_u32 s2, 144
s_cbranch_scc1 L3_gok
s_mov_b32 s52, 0
L3_g:
s_sleep 2
buffer_load_dword v213, v251, s[8:11], s64 offen offset:32 sc1
s_waitcnt vmcnt(0)
v_cmp_ne_u32 vcc, v212, v213
s_cbranch_vccz L3_gok
s_add_u32 s52, s52, 1
s_cmp_lt_u32 s52, 0x40000
s_cbranch_scc1 L3_g
L3_gok:
s_mov_b32 s52, 0
buffer_load_dword v213, v214, s[8:11], s64 offen sc1
v_and_b32 v245, 16, v0
v_lshrrev_b32 v245, 2, v245
v_and_or_b32 v245, v0, 8, v245
v_and_b32 v246, 32, v0
v_lshrrev_b32 v246, 1, v246
v_add_u32 v245, v245, v246
v_add_u32 v246, s20, v245
v_mul_u32_u24 v246, 9216, v246
v_and_b32 v247, 0x70, v1
v_add_u32 v241, v246, v247
s_and_b32 s50, s20, 2
s_lshl_b32 s50, s50, 4
s_and_b32 s51, s20, 1
s_add_u32 s50, s50, s51
v_and_b32 v246, 4, v0
v_lshrrev_b32 v246, 1, v246
v_add3_u32 v246, v246, v245, s50
v_mul_u32_u24 v246, 9216, v246
v_and_b32 v247, 0x30, v1
v_add_u32 v242, v246, v247
s_xor_b32 s87, s87, 1
s_lshl_b32 s87, s87, 9
s_add_u32 s87, s87, s86
s_add_u32 s86, s86, s85
s_add_u32 s85, s86, 256
s_add_u32 s86, s86, 384
s_nop 0
v_and_b32 v245, 16, v0
v_lshl_add_u32 v244, v245, 3, v244
v_bfe_u32 v245, v0, 2, 2
v_mul_u32_u24 v245, 1056, v245
v_add_u32 v13, v244, v245
v_bfe_u32 v245, v0, 2, 1
v_mul_u32_u24 v245, 1056, v245
v_and_b32 v246, 8, v0
v_lshl_add_u32 v245, v246, 3, v245
v_add_u32 v243, v244, v245
v_mov_b32 v11, v1
s_mov_b32 s12, s44
s_mov_b32 s13, s45
s_mov_b32 s14, 2359296
s_mov_b32 s15, 0x20000
s_mov_b32 s16, s42
s_mov_b32 s17, s43
s_mov_b32 s18, 1152
s_mov_b32 s19, 0x20000
s_lshl_b32 s50, s21, 4
s_lshl_b32 s51, s22, 2
s_add_u32 s50, s50, s51
s_add_u32 s51, s23, 0
s_and_b32 s51, s51, 3
s_add_u32 s51, s51, s50
s_lshl_b32 s51, s51, 2
s_add_u32 s51, s51, s20
s_mul_i32 s28, s51, 18432
s_add_u32 s28, s28, 13369344
s_add_u32 s51, s23, 1
s_and_b32 s51, s51, 3
s_add_u32 s51, s51, s50
s_lshl_b32 s51, s51, 2
s_add_u32 s51, s51, s20
s_mul_i32 s29, s51, 18432
s_add_u32 s29, s29, 13369344
s_add_u32 s51, s23, 2
s_and_b32 s51, s51, 3
s_add_u32 s51, s51, s50
s_lshl_b32 s51, s51, 2
s_add_u32 s51, s51, s20
s_mul_i32 s30, s51, 18432
s_add_u32 s30, s30, 13369344
s_add_u32 s51, s23, 3
s_and_b32 s51, s51, 3
s_add_u32 s51, s51, s50
s_lshl_b32 s51, s51, 2
s_add_u32 s51, s51, s20
s_mul_i32 s31, s51, 18432
s_add_u32 s31, s31, 13369344
s_lshl_b32 s33, s50, 2
s_add_u32 s33, s33, s20
s_lshl_b32 s33, s33, 7
s_add_u32 s33, s33, 39583744
s_lshl_b32 s50, s21, 4
s_add_u32 s50, s50, s23
s_lshl_b32 s50, s50, 2
s_add_u32 s50, s50, s20
s_lshl_b32 s34, s50, 7
s_add_u32 s34, s34, 39583744
s_lshl_b32 s50, s21, 2
s_add_u32 s50, s50, s23
s_lshl_b32 s50, s50, 2
s_lshl_b32 s48, s20, 11
s_add_u32 s48, s48, 32243712
s_add_u32 s51, s22, 1
s_and_b32 s51, s51, 3
s_add_u32 s51, s51, s50
s_mul_i32 s51, s51, 24576
s_add_u32 s51, s51, 0
s_add_u32 s53, s51, s48
s_add_u32 s51, s22, 2
s_and_b32 s51, s51, 3
s_add_u32 s51, s51, s50
s_mul_i32 s51, s51, 24576
s_add_u32 s51, s51, 8192
s_add_u32 s54, s51, s48
s_add_u32 s51, s22, 3
s_and_b32 s51, s51, 3
s_add_u32 s51, s51, s50
s_mul_i32 s51, s51, 24576
s_add_u32 s51, s51, 16384
s_add_u32 s55, s51, s48
s_add_u32 s51, s22, s50
s_mul_i32 s51, s51, 24576
s_add_u32 s56, s51, s48
s_add_u32 s51, s50, s20
s_lshl_b32 s58, s51, 12
s_add_u32 s58, s58, 38535168
s_lshl_b32 s51, s22, 10
s_add_u32 s57, s58, s51
s_mov_b32 s48, 0x3f80
s_mov_b32 s49, 0x3f800000
v_and_b32 v10, 3, v0
v_lshlrev_b32 v5, 9, v10
v_min_u32 v15, 2, v10
v_add3_u32 v15, v15, 1, s22
v_and_b32 v15, 3, v15
v_lshlrev_b32 v15, 11, v15
s_mov_b32 s88, 0
v_lshlrev_b32 v9, 4, v9
L3_p2:
s_waitcnt vmcnt(0)
v_cmp_ne_u32 vcc, v212, v213
s_cbranch_vccz L3_p2ok
s_sleep 1
buffer_load_dword v213, v214, s[8:11], s64 offen sc1
s_add_u32 s52, s52, 1
s_cmp_lt_u32 s52, 0x40000
s_cbranch_scc1 L3_p2
s_waitcnt vmcnt(0)
L3_p2ok:
s_barrier
buffer_load_dwordx4 a[0:3], v3, s[8:11], s27 offen sc1
buffer_load_dwordx4 a[4:7], v255, s[8:11], s27 offen sc1
s_add_u32 s27, s27, 132096
buffer_load_dwordx4 a[8:11], v3, s[8:11], s27 offen sc1
buffer_load_dwordx4 a[12:15], v255, s[8:11], s27 offen sc1
s_add_u32 s27, s27, 132096
buffer_load_dwordx4 a[16:19], v3, s[8:11], s27 offen sc1
buffer_load_dwordx4 a[20:23], v255, s[8:11], s27 offen sc1
s_add_u32 s27, s27, 132096
buffer_load_dwordx4 a[24:27], v3, s[8:11], s27 offen sc1
buffer_load_dwordx4 a[28:31], v255, s[8:11], s27 offen sc1
s_add_u32 s27, s27, 132096
buffer_load_dwordx4 v[168:171], v184, s[8:11], s37 offen sc1
s_add_u32 s37, s37, 66048
buffer_load_dwordx4 v[172:175], v184, s[8:11], s37 offen sc1
s_add_u32 s37, s37, 66048
buffer_load_dwordx4 v[176:179], v185, s[8:11], s37 offen sc1
buffer_load_dwordx4 a[32:35], v3, s[8:11], s27 offen sc1
buffer_load_dwordx4 a[36:39], v255, s[8:11], s27 offen sc1
s_add_u32 s27, s27, 132096
s_barrier
ds_read_b64_tr_b16 a[144:145], v12 offset:8448
ds_read_b64_tr_b16 a[146:147], v12 offset:8704
ds_read_b64_tr_b16 a[148:149], v12 offset:8480
ds_read_b64_tr_b16 a[150:151], v12 offset:8736
ds_read_b64_tr_b16 a[152:153], v12 offset:8512
ds_read_b64_tr_b16 a[154:155], v12 offset:8768
ds_read_b64_tr_b16 a[156:157], v12 offset:8544
ds_read_b64_tr_b16 a[158:159], v12 offset:8800
ds_read_b64_tr_b16 a[160:161], v12 offset:8576
ds_read_b64_tr_b16 a[162:163], v12 offset:8832
s_waitcnt vmcnt(11)
v_accvgpr_read_b32 v253, a2
v_accvgpr_read_b32 v254, a3
v_accvgpr_mov_b32 a2, a4
v_accvgpr_mov_b32 a3, a5
v_accvgpr_write_b32 a4, v253
v_accvgpr_write_b32 a5, v254
s_nop 1
s_waitcnt lgkmcnt(8)
v_mfma_f32_16x16x32_bf16 v[24:27], a[144:147], a[0:3], 0
ds_read_b64_tr_b16 a[164:165], v12 offset:8608
ds_read_b64_tr_b16 a[166:167], v12 offset:8864
v_mfma_f32_16x16x32_bf16 v[28:31], a[144:147], a[4:7], 0
s_waitcnt lgkmcnt(8)
buffer_load_dwordx4 a[40:43], v3, s[8:11], s27 offen sc1
v_mfma_f32_16x16x32_bf16 v[32:35], a[148:151], a[0:3], 0
ds_read_b64_tr_b16 a[168:169], v12 offset:8640
ds_read_b64_tr_b16 a[170:171], v12 offset:8896
v_mfma_f32_16x16x32_bf16 v[36:39], a[148:151], a[4:7], 0
s_waitcnt lgkmcnt(8)
buffer_load_dwordx4 a[44:47], v255, s[8:11], s27 offen sc1
v_mfma_f32_16x16x32_bf16 v[40:43], a[152:155], a[0:3], 0
s_add_u32 s27, s27, 132096
ds_read_b64_tr_b16 a[172:173], v12 offset:8672
v_mfma_f32_16x16x32_bf16 v[44:47], a[152:155], a[4:7], 0
s_waitcnt lgkmcnt(7)
ds_read_b64_tr_b16 a[174:175], v12 offset:8928
v_mfma_f32_16x16x32_bf16 v[48:51], a[156:159], a[0:3], 0
ds_read_b64_tr_b16 a[144:145], v12 offset:16896
ds_read_b64_tr_b16 a[146:147], v12 offset:17152
v_mfma_f32_16x16x32_bf16 v[52:55], a[156:159], a[4:7], 0
s_waitcnt lgkmcnt(8)
buffer_load_dwordx4 a[48:51], v3, s[8:11], s27 offen sc1
v_mfma_f32_16x16x32_bf16 v[56:59], a[160:163], a[0:3], 0
ds_read_b64_tr_b16 a[148:149], v12 offset:16928
s_waitcnt vmcnt(12)
v_accvgpr_read_b32 v253, a10
v_accvgpr_read_b32 v254, a11
v_mfma_f32_16x16x32_bf16 v[60:63], a[160:163], a[4:7], 0
s_waitcnt lgkmcnt(7)
ds_read_b64_tr_b16 a[150:151], v12 offset:17184
v_accvgpr_mov_b32 a10, a12
v_accvgpr_mov_b32 a11, a13
v_mfma_f32_16x16x32_bf16 v[64:67], a[164:167], a[0:3], 0
ds_read_b64_tr_b16 a[152:153], v12 offset:16960
ds_read_b64_tr_b16 a[154:155], v12 offset:17216
v_mfma_f32_16x16x32_bf16 v[68:71], a[164:167], a[4:7], 0
s_waitcnt lgkmcnt(8)
buffer_load_dwordx4 a[52:55], v255, s[8:11], s27 offen sc1
v_mfma_f32_16x16x32_bf16 v[72:75], a[168:171], a[0:3], 0
s_add_u32 s27, s27, 132096
ds_read_b64_tr_b16 a[156:157], v12 offset:16992
v_accvgpr_write_b32 a12, v253
v_accvgpr_write_b32 a13, v254
v_mfma_f32_16x16x32_bf16 v[76:79], a[168:171], a[4:7], 0
s_waitcnt lgkmcnt(7)
ds_read_b64_tr_b16 a[158:159], v12 offset:17248
v_mfma_f32_16x16x32_bf16 v[80:83], a[172:175], a[0:3], 0
ds_read_b64_tr_b16 a[160:161], v12 offset:17024
ds_read_b64_tr_b16 a[162:163], v12 offset:17280
v_mfma_f32_16x16x32_bf16 v[84:87], a[172:175], a[4:7], 0
s_waitcnt lgkmcnt(8)
buffer_load_dwordx4 a[56:59], v3, s[8:11], s27 offen sc1
v_mfma_f32_16x16x32_bf16 v[24:27], a[144:147], a[8:11], v[24:27]
ds_read_b64_tr_b16 a[164:165], v12 offset:17056
v_mfma_f32_16x16x32_bf16 v[28:31], a[144:147], a[12:15], v[28:31]
s_waitcnt lgkmcnt(7)
ds_read_b64_tr_b16 a[166:167], v12 offset:17312
v_mfma_f32_16x16x32_bf16 v[32:35], a[148:151], a[8:11], v[32:35]
ds_read_b64_tr_b16 a[168:169], v12 offset:17088
ds_read_b64_tr_b16 a[170:171], v12 offset:17344
v_mfma_f32_16x16x32_bf16 v[36:39], a[148:151], a[12:15], v[36:39]
s_waitcnt lgkmcnt(8)
buffer_load_dwordx4 a[60:63], v255, s[8:11], s27 offen sc1
v_mfma_f32_16x16x32_bf16 v[40:43], a[152:155], a[8:11], v[40:43]
s_add_u32 s27, s27, 132096
ds_read_b64_tr_b16 a[172:173], v12 offset:17120
v_mfma_f32_16x16x32_bf16 v[44:47], a[152:155], a[12:15], v[44:47]
s_waitcnt lgkmcnt(7)
ds_read_b64_tr_b16 a[174:175], v12 offset:17376
v_mfma_f32_16x16x32_bf16 v[48:51], a[156:159], a[8:11], v[48:51]
s_barrier
ds_read_b64_tr_b16 a[144:145], v12 offset:25344
ds_read_b64_tr_b16 a[146:147], v12 offset:25600
v_mfma_f32_16x16x32_bf16 v[52:55], a[156:159], a[12:15], v[52:55]
s_waitcnt lgkmcnt(8)
buffer_load_dwordx4 a[64:67], v3, s[8:11], s27 offen sc1
v_mfma_f32_16x16x32_bf16 v[56:59], a[160:163], a[8:11], v[56:59]
ds_read_b64_tr_b16 a[148:149], v12 offset:25376
s_waitcnt vmcnt(14)
v_accvgpr_read_b32 v253, a18
v_accvgpr_read_b32 v254, a19
v_mfma_f32_16x16x32_bf16 v[60:63], a[160:163], a[12:15], v[60:63]
s_waitcnt lgkmcnt(7)
ds_read_b64_tr_b16 a[150:151], v12 offset:25632
v_accvgpr_mov_b32 a18, a20
v_accvgpr_mov_b32 a19, a21
v_mfma_f32_16x16x32_bf16 v[64:67], a[164:167], a[8:11], v[64:67]
ds_read_b64_tr_b16 a[152:153], v12 offset:25408
ds_read_b64_tr_b16 a[154:155], v12 offset:25664
v_mfma_f32_16x16x32_bf16 v[68:71], a[164:167], a[12:15], v[68:71]
s_waitcnt lgkmcnt(8)
buffer_load_dwordx4 a[68:71], v255, s[8:11], s27 offen sc1
v_mfma_f32_16x16x32_bf16 v[72:75], a[168:171], a[8:11], v[72:75]
s_add_u32 s27, s27, 132096
ds_read_b64_tr_b16 a[156:157], v12 offset:25440
v_accvgpr_write_b32 a20, v253
v_accvgpr_write_b32 a21, v254
v_mfma_f32_16x16x32_bf16 v[76:79], a[168:171], a[12:15], v[76:79]
s_waitcnt lgkmcnt(7)
s_waitcnt vmcnt(10)
v_dot2_f32_bf16 v188, v168, s67, 0
v_dot2_f32_bf16 v189, v168, v168, 0
v_dot2_f32_bf16 v190, v170, s67, 0
v_dot2_f32_bf16 v191, v170, v170, 0
v_dot2_f32_bf16 v188, v169, s67, v188
v_dot2_f32_bf16 v189, v169, v169, v189
v_dot2_f32_bf16 v190, v171, s67, v190
v_dot2_f32_bf16 v191, v171, v171, v191
v_dot2_f32_bf16 v188, v172, s67, v188
v_dot2_f32_bf16 v189, v172, v172, v189
v_dot2_f32_bf16 v190, v174, s67, v190
v_dot2_f32_bf16 v191, v174, v174, v191
v_dot2_f32_bf16 v188, v173, s67, v188
v_dot2_f32_bf16 v189, v173, v173, v189
v_dot2_f32_bf16 v190, v175, s67, v190
v_dot2_f32_bf16 v191, v175, v175, v191
v_dot2_f32_bf16 v188, v176, s67, v188
v_dot2_f32_bf16 v189, v176, v176, v189
v_dot2_f32_bf16 v190, v178, s67, v190
v_dot2_f32_bf16 v191, v178, v178, v191
v_dot2_f32_bf16 v188, v177, s67, v188
v_dot2_f32_bf16 v189, v177, v177, v189
v_dot2_f32_bf16 v190, v179, s67, v190
v_dot2_f32_bf16 v191, v179, v179, v191
s_nop 2
v_permlane16_swap_b32 v188, v189
v_permlane16_swap_b32 v190, v191
v_add_f32 v188, v188, v189
v_add_f32 v190, v190, v191
s_nop 1
v_permlane32_swap_b32 v188, v190
v_add_f32 v188, v188, v190
buffer_store_dword v188, v186, s[8:11], s46 offen sc1
ds_read_b64_tr_b16 a[158:159], v12 offset:25696
v_mfma_f32_16x16x32_bf16 v[80:83], a[172:175], a[8:11], v[80:83]
ds_read_b64_tr_b16 a[160:161], v12 offset:25472
v_mfma_f32_16x16x32_bf16 v[84:87], a[172:175], a[12:15], v[84:87]
s_waitcnt lgkmcnt(7)
ds_read_b64_tr_b16 a[162:163], v12 offset:25728
v_mfma_f32_16x16x32_bf16 v[24:27], a[144:147], a[16:19], v[24:27]
ds_read_b64_tr_b16 a[164:165], v12 offset:25504
ds_read_b64_tr_b16 a[166:167], v12 offset:25760
v_mfma_f32_16x16x32_bf16 v[28:31], a[144:147], a[20:23], v[28:31]
s_waitcnt lgkmcnt(8)
buffer_load_dwordx4 a[72:75], v3, s[8:11], s27 offen sc1
v_mfma_f32_16x16x32_bf16 v[32:35], a[148:151], a[16:19], v[32:35]
ds_read_b64_tr_b16 a[168:169], v12 offset:25536
v_mfma_f32_16x16x32_bf16 v[36:39], a[148:151], a[20:23], v[36:39]
s_waitcnt lgkmcnt(7)
ds_read_b64_tr_b16 a[170:171], v12 offset:25792
v_mfma_f32_16x16x32_bf16 v[40:43], a[152:155], a[16:19], v[40:43]
ds_read_b64_tr_b16 a[172:173], v12 offset:25568
ds_read_b64_tr_b16 a[174:175], v12 offset:25824
v_mfma_f32_16x16x32_bf16 v[44:47], a[152:155], a[20:23], v[44:47]
s_waitcnt lgkmcnt(8)
buffer_load_dwordx4 a[76:79], v255, s[8:11], s27 offen sc1
v_mfma_f32_16x16x32_bf16 v[48:51], a[156:159], a[16:19], v[48:51]
s_add_u32 s27, s27, 132096
ds_read_b64_tr_b16 a[144:145], v12 offset:42240
v_accvgpr_read_b32 v253, a26
v_accvgpr_read_b32 v254, a27
v_mfma_f32_16x16x32_bf16 v[52:55], a[156:159], a[20:23], v[52:55]
s_waitcnt lgkmcnt(7)
ds_read_b64_tr_b16 a[146:147], v12 offset:42496
v_accvgpr_mov_b32 a26, a28
v_accvgpr_mov_b32 a27, a29
v_mfma_f32_16x16x32_bf16 v[56:59], a[160:163], a[16:19], v[56:59]
ds_read_b64_tr_b16 a[148:149], v12 offset:42272
ds_read_b64_tr_b16 a[150:151], v12 offset:42528
v_mfma_f32_16x16x32_bf16 v[60:63], a[160:163], a[20:23], v[60:63]
s_waitcnt lgkmcnt(8)
buffer_load_dwordx4 a[80:83], v3, s[8:11], s27 offen sc1
v_mfma_f32_16x16x32_bf16 v[64:67], a[164:167], a[16:19], v[64:67]
ds_read_b64_tr_b16 a[152:153], v12 offset:42304
v_accvgpr_write_b32 a28, v253
v_accvgpr_write_b32 a29, v254
v_mfma_f32_16x16x32_bf16 v[68:71], a[164:167], a[20:23], v[68:71]
s_waitcnt lgkmcnt(7)
ds_read_b64_tr_b16 a[154:155], v12 offset:42560
v_mfma_f32_16x16x32_bf16 v[72:75], a[168:171], a[16:19], v[72:75]
ds_read_b64_tr_b16 a[156:157], v12 offset:42336
ds_read_b64_tr_b16 a[158:159], v12 offset:42592
v_mfma_f32_16x16x32_bf16 v[76:79], a[168:171], a[20:23], v[76:79]
s_waitcnt lgkmcnt(8)
buffer_load_dwordx4 a[84:87], v255, s[8:11], s27 offen sc1
v_mfma_f32_16x16x32_bf16 v[80:83], a[172:175], a[16:19], v[80:83]
s_add_u32 s27, s27, 132096
ds_read_b64_tr_b16 a[160:161], v12 offset:42368
v_mfma_f32_16x16x32_bf16 v[84:87], a[172:175], a[20:23], v[84:87]
s_waitcnt lgkmcnt(7)
ds_read_b64_tr_b16 a[162:163], v12 offset:42624
v_mfma_f32_16x16x32_bf16 v[24:27], a[144:147], a[24:27], v[24:27]
ds_read_b64_tr_b16 a[164:165], v12 offset:42400
ds_read_b64_tr_b16 a[166:167], v12 offset:42656
v_mfma_f32_16x16x32_bf16 v[28:31], a[144:147], a[28:31], v[28:31]
s_waitcnt lgkmcnt(8)
buffer_load_dwordx4 a[88:91], v3, s[8:11], s27 offen sc1
v_mfma_f32_16x16x32_bf16 v[32:35], a[148:151], a[24:27], v[32:35]
ds_read_b64_tr_b16 a[168:169], v12 offset:42432
v_mfma_f32_16x16x32_bf16 v[36:39], a[148:151], a[28:31], v[36:39]
PADW0:
PAD0:
s_cbranch_execz PAD1
s_waitcnt lgkmcnt(7)
ds_read_b64_tr_b16 a[170:171], v12 offset:42688
v_mfma_f32_16x16x32_bf16 v[40:43], a[152:155], a[24:27], v[40:43]
ds_read_b64_tr_b16 a[172:173], v12 offset:42464
ds_read_b64_tr_b16 a[174:175], v12 offset:42720
v_mfma_f32_16x16x32_bf16 v[44:47], a[152:155], a[28:31], v[44:47]
s_waitcnt lgkmcnt(8)
buffer_load_dwordx4 a[92:95], v255, s[8:11], s27 offen sc1
v_mfma_f32_16x16x32_bf16 v[48:51], a[156:159], a[24:27], v[48:51]
s_add_u32 s27, s27, 132096
s_barrier
ds_read_b64_tr_b16 a[144:145], v12 offset:50688
s_waitcnt vmcnt(15)
v_accvgpr_read_b32 v253, a34
v_accvgpr_read_b32 v254, a35
v_mfma_f32_16x16x32_bf16 v[52:55], a[156:159], a[28:31], v[52:55]
s_waitcnt lgkmcnt(7)
ds_read_b64_tr_b16 a[146:147], v12 offset:50944
v_accvgpr_mov_b32 a34, a36
v_accvgpr_mov_b32 a35, a37
v_mfma_f32_16x16x32_bf16 v[56:59], a[160:163], a[24:27], v[56:59]
ds_read_b64_tr_b16 a[148:149], v12 offset:50720
ds_read_b64_tr_b16 a[150:151], v12 offset:50976
v_mfma_f32_16x16x32_bf16 v[60:63], a[160:163], a[28:31], v[60:63]
s_waitcnt lgkmcnt(8)
buffer_load_dwordx4 a[96:99], v3, s[8:11], s27 offen sc1
v_mfma_f32_16x16x32_bf16 v[64:67], a[164:167], a[24:27], v[64:67]
ds_read_b64_tr_b16 a[152:153], v12 offset:50752
v_accvgpr_write_b32 a36, v253
v_accvgpr_write_b32 a37, v254
v_mfma_f32_16x16x32_bf16 v[68:71], a[164:167], a[28:31], v[68:71]
s_waitcnt lgkmcnt(7)
ds_read_b64_tr_b16 a[154:155], v12 offset:51008
v_mfma_f32_16x16x32_bf16 v[72:75], a[168:171], a[24:27], v[72:75]
ds_read_b64_tr_b16 a[156:157], v12 offset:50784
ds_read_b64_tr_b16 a[158:159], v12 offset:51040
v_mfma_f32_16x16x32_bf16 v[76:79], a[168:171], a[28:31], v[76:79]
s_waitcnt lgkmcnt(8)
buffer_load_dwordx4 a[100:103], v255, s[8:11], s27 offen sc1
v_mfma_f32_16x16x32_bf16 v[80:83], a[172:175], a[24:27], v[80:83]
s_add_u32 s27, s27, 132096
ds_read_b64_tr_b16 a[160:161], v12 offset:50816
v_mfma_f32_16x16x32_bf16 v[84:87], a[172:175], a[28:31], v[84:87]
s_waitcnt lgkmcnt(7)
ds_read_b64_tr_b16 a[162:163], v12 offset:51072
v_mfma_f32_16x16x32_bf16 v[24:27], a[144:147], a[32:35], v[24:27]
ds_read_b64_tr_b16 a[164:165], v12 offset:50848
ds_read_b64_tr_b16 a[166:167], v12 offset:51104
v_mfma_f32_16x16x32_bf16 v[28:31], a[144:147], a[36:39], v[28:31]
s_waitcnt lgkmcnt(8)
buffer_load_dwordx4 a[104:107], v3, s[8:11], s27 offen sc1
v_mfma_f32_16x16x32_bf16 v[32:35], a[148:151], a[32:35], v[32:35]
ds_read_b64_tr_b16 a[168:169], v12 offset:50880
v_mfma_f32_16x16x32_bf16 v[36:39], a[148:151], a[36:39], v[36:39]
s_waitcnt lgkmcnt(7)
ds_read_b64_tr_b16 a[170:171], v12 offset:51136
v_mfma_f32_16x16x32_bf16 v[40:43], a[152:155], a[32:35], v[40:43]
ds_read_b64_tr_b16 a[172:173], v12 offset:50912
ds_read_b64_tr_b16 a[174:175], v12 offset:51168
v_mfma_f32_16x16x32_bf16 v[44:47], a[152:155], a[36:39], v[44:47]
s_waitcnt lgkmcnt(8)
buffer_load_dwordx4 a[108:111], v255, s[8:11], s27 offen sc1
v_mfma_f32_16x16x32_bf16 v[48:51], a[156:159], a[32:35], v[48:51]
s_add_u32 s27, s27, 132096
ds_read_b64_tr_b16 a[144:145], v12 offset:59136
s_waitcnt vmcnt(17)
v_accvgpr_read_b32 v253, a42
v_accvgpr_read_b32 v254, a43
v_mfma_f32_16x16x32_bf16 v[52:55], a[156:159], a[36:39], v[52:55]
s_waitcnt lgkmcnt(7)
ds_read_b64_tr_b16 a[146:147], v12 offset:59392
v_accvgpr_mov_b32 a42, a44
v_accvgpr_mov_b32 a43, a45
v_mfma_f32_16x16x32_bf16 v[56:59], a[160:163], a[32:35], v[56:59]
ds_read_b64_tr_b16 a[148:149], v12 offset:59168
ds_read_b64_tr_b16 a[150:151], v12 offset:59424
v_mfma_f32_16x16x32_bf16 v[60:63], a[160:163], a[36:39], v[60:63]
s_waitcnt lgkmcnt(8)
buffer_load_dwordx4 a[112:115], v3, s[8:11], s27 offen sc1
v_mfma_f32_16x16x32_bf16 v[64:67], a[164:167], a[32:35], v[64:67]
ds_read_b64_tr_b16 a[152:153], v12 offset:59200
v_accvgpr_write_b32 a44, v253
v_accvgpr_write_b32 a45, v254
v_mfma_f32_16x16x32_bf16 v[68:71], a[164:167], a[36:39], v[68:71]
s_waitcnt lgkmcnt(7)
ds_read_b64_tr_b16 a[154:155], v12 offset:59456
v_mfma_f32_16x16x32_bf16 v[72:75], a[168:171], a[32:35], v[72:75]
ds_read_b64_tr_b16 a[156:157], v12 offset:59232
ds_read_b64_tr_b16 a[158:159], v12 offset:59488
v_mfma_f32_16x16x32_bf16 v[76:79], a[168:171], a[36:39], v[76:79]
s_waitcnt lgkmcnt(8)
buffer_load_dwordx4 a[116:119], v255, s[8:11], s27 offen sc1
v_mfma_f32_16x16x32_bf16 v[80:83], a[172:175], a[32:35], v[80:83]
s_add_u32 s27, s27, 132096
ds_read_b64_tr_b16 a[160:161], v12 offset:59264
v_mfma_f32_16x16x32_bf16 v[84:87], a[172:175], a[36:39], v[84:87]
s_waitcnt lgkmcnt(7)
ds_read_b64_tr_b16 a[162:163], v12 offset:59520
v_mfma_f32_16x16x32_bf16 v[24:27], a[144:147], a[40:43], v[24:27]
ds_read_b64_tr_b16 a[164:165], v12 offset:59296
ds_read_b64_tr_b16 a[166:167], v12 offset:59552
v_mfma_f32_16x16x32_bf16 v[28:31], a[144:147], a[44:47], v[28:31]
s_waitcnt lgkmcnt(8)
buffer_load_dwordx4 a[120:123], v3, s[8:11], s27 offen sc1
v_mfma_f32_16x16x32_bf16 v[32:35], a[148:151], a[40:43], v[32:35]
ds_read_b64_tr_b16 a[168:169], v12 offset:59328
v_mfma_f32_16x16x32_bf16 v[36:39], a[148:151], a[44:47], v[36:39]
s_waitcnt lgkmcnt(7)
ds_read_b64_tr_b16 a[170:171], v12 offset:59584
v_mfma_f32_16x16x32_bf16 v[40:43], a[152:155], a[40:43], v[40:43]
s_waitcnt vmcnt(13)
v_mov_b32 v14, s38
buffer_store_dword v14, v4, s[8:11], s32 offen sc1
ds_read_b64_tr_b16 a[172:173], v12 offset:59360
ds_read_b64_tr_b16 a[174:175], v12 offset:59616
v_mfma_f32_16x16x32_bf16 v[44:47], a[152:155], a[44:47], v[44:47]
s_waitcnt lgkmcnt(8)
buffer_load_dwordx4 a[124:127], v255, s[8:11], s27 offen sc1
v_mfma_f32_16x16x32_bf16 v[48:51], a[156:159], a[40:43], v[48:51]
s_add_u32 s27, s27, 132096
s_barrier
v_add_u32 v12, 65536, v12
ds_read_b64_tr_b16 a[144:145], v12 offset:10496
v_accvgpr_read_b32 v253, a50
v_accvgpr_read_b32 v254, a51
v_mfma_f32_16x16x32_bf16 v[52:55], a[156:159], a[44:47], v[52:55]
s_waitcnt lgkmcnt(7)
ds_read_b64_tr_b16 a[146:147], v12 offset:10752
v_accvgpr_mov_b32 a50, a52
v_accvgpr_mov_b32 a51, a53
v_mfma_f32_16x16x32_bf16 v[56:59], a[160:163], a[40:43], v[56:59]
ds_read_b64_tr_b16 a[148:149], v12 offset:10528
ds_read_b64_tr_b16 a[150:151], v12 offset:10784
v_mfma_f32_16x16x32_bf16 v[60:63], a[160:163], a[44:47], v[60:63]
s_waitcnt lgkmcnt(8)
buffer_load_dwordx4 a[128:131], v3, s[8:11], s27 offen sc1
v_mfma_f32_16x16x32_bf16 v[64:67], a[164:167], a[40:43], v[64:67]
ds_read_b64_tr_b16 a[152:153], v12 offset:10560
v_accvgpr_write_b32 a52, v253
v_accvgpr_write_b32 a53, v254
v_mfma_f32_16x16x32_bf16 v[68:71], a[164:167], a[44:47], v[68:71]
s_waitcnt lgkmcnt(7)
ds_read_b64_tr_b16 a[154:155], v12 offset:10816
v_mfma_f32_16x16x32_bf16 v[72:75], a[168:171], a[40:43], v[72:75]
ds_read_b64_tr_b16 a[156:157], v12 offset:10592
ds_read_b64_tr_b16 a[158:159], v12 offset:10848
v_mfma_f32_16x16x32_bf16 v[76:79], a[168:171], a[44:47], v[76:79]
s_waitcnt lgkmcnt(8)
buffer_load_dwordx4 a[132:135], v255, s[8:11], s27 offen sc1
v_mfma_f32_16x16x32_bf16 v[80:83], a[172:175], a[40:43], v[80:83]
s_add_u32 s27, s27, 132096
ds_read_b64_tr_b16 a[160:161], v12 offset:10624
v_mfma_f32_16x16x32_bf16 v[84:87], a[172:175], a[44:47], v[84:87]
s_waitcnt lgkmcnt(7)
ds_read_b64_tr_b16 a[162:163], v12 offset:10880
v_mfma_f32_16x16x32_bf16 v[24:27], a[144:147], a[48:51], v[24:27]
ds_read_b64_tr_b16 a[164:165], v12 offset:10656
ds_read_b64_tr_b16 a[166:167], v12 offset:10912
v_mfma_f32_16x16x32_bf16 v[28:31], a[144:147], a[52:55], v[28:31]
s_waitcnt lgkmcnt(8)
buffer_load_dwordx4 a[136:139], v3, s[8:11], s27 offen sc1
v_mfma_f32_16x16x32_bf16 v[32:35], a[148:151], a[48:51], v[32:35]
ds_read_b64_tr_b16 a[168:169], v12 offset:10688
v_mfma_f32_16x16x32_bf16 v[36:39], a[148:151], a[52:55], v[36:39]
s_waitcnt lgkmcnt(7)
ds_read_b64_tr_b16 a[170:171], v12 offset:10944
v_mfma_f32_16x16x32_bf16 v[40:43], a[152:155], a[48:51], v[40:43]
ds_read_b64_tr_b16 a[172:173], v12 offset:10720
ds_read_b64_tr_b16 a[174:175], v12 offset:10976
v_mfma_f32_16x16x32_bf16 v[44:47], a[152:155], a[52:55], v[44:47]
s_waitcnt lgkmcnt(8)
buffer_load_dwordx4 a[140:143], v255, s[8:11], s27 offen sc1
v_mfma_f32_16x16x32_bf16 v[48:51], a[156:159], a[48:51], v[48:51]
s_add_u32 s27, s27, 132096
ds_read_b64_tr_b16 a[144:145], v12 offset:18944
v_accvgpr_read_b32 v253, a58
v_accvgpr_read_b32 v254, a59
v_mfma_f32_16x16x32_bf16 v[52:55], a[156:159], a[52:55], v[52:55]
s_waitcnt lgkmcnt(7)
ds_read_b64_tr_b16 a[146:147], v12 offset:19200
v_accvgpr_mov_b32 a58, a60
v_accvgpr_mov_b32 a59, a61
v_mfma_f32_16x16x32_bf16 v[56:59], a[160:163], a[48:51], v[56:59]
s_add_u32 m0, s26, 8448
ds_read_b64_tr_b16 a[148:149], v12 offset:18976
ds_read_b64_tr_b16 a[150:151], v12 offset:19232
v_mfma_f32_16x16x32_bf16 v[60:63], a[160:163], a[52:55], v[60:63]
s_waitcnt lgkmcnt(8)
buffer_load_dwordx4 v241, s[60:63], s85 offen  lds
v_mfma_f32_16x16x32_bf16 v[64:67], a[164:167], a[48:51], v[64:67]
s_add_u32 s85, s85, 294912
ds_read_b64_tr_b16 a[152:153], v12 offset:19008
v_accvgpr_write_b32 a60, v253
v_accvgpr_write_b32 a61, v254
v_mfma_f32_16x16x32_bf16 v[68:71], a[164:167], a[52:55], v[68:71]
s_waitcnt lgkmcnt(7)
ds_read_b64_tr_b16 a[154:155], v12 offset:19264
v_mfma_f32_16x16x32_bf16 v[72:75], a[168:171], a[48:51], v[72:75]
s_add_u32 m0, s26, 12672
ds_read_b64_tr_b16 a[156:157], v12 offset:19040
ds_read_b64_tr_b16 a[158:159], v12 offset:19296
v_mfma_f32_16x16x32_bf16 v[76:79], a[168:171], a[52:55], v[76:79]
s_waitcnt lgkmcnt(8)
buffer_load_dwordx4 v242, s[60:63], s87 offen  lds
v_mfma_f32_16x16x32_bf16 v[80:83], a[172:175], a[48:51], v[80:83]
s_add_u32 s87, s87, 589824
ds_read_b64_tr_b16 a[160:161], v12 offset:19072
v_mfma_f32_16x16x32_bf16 v[84:87], a[172:175], a[52:55], v[84:87]
s_waitcnt lgkmcnt(7)
ds_read_b64_tr_b16 a[162:163], v12 offset:19328
v_mfma_f32_16x16x32_bf16 v[24:27], a[144:147], a[56:59], v[24:27]
s_add_u32 m0, s26, 16896
ds_read_b64_tr_b16 a[164:165], v12 offset:19104
ds_read_b64_tr_b16 a[166:167], v12 offset:19360
v_mfma_f32_16x16x32_bf16 v[28:31], a[144:147], a[60:63], v[28:31]
s_waitcnt lgkmcnt(8)
buffer_load_dwordx4 v241, s[60:63], s85 offen  lds
v_mfma_f32_16x16x32_bf16 v[32:35], a[148:151], a[56:59], v[32:35]
s_add_u32 s85, s85, 294912
ds_read_b64_tr_b16 a[168:169], v12 offset:19136
v_mfma_f32_16x16x32_bf16 v[36:39], a[148:151], a[60:63], v[36:39]
s_waitcnt lgkmcnt(7)
ds_read_b64_tr_b16 a[170:171], v12 offset:19392
v_mfma_f32_16x16x32_bf16 v[40:43], a[152:155], a[56:59], v[40:43]
ds_read_b64_tr_b16 a[172:173], v12 offset:19168
v_mfma_f32_16x16x32_bf16 v[44:47], a[152:155], a[60:63], v[44:47]
s_waitcnt lgkmcnt(7)
ds_read_b64_tr_b16 a[174:175], v12 offset:19424
v_mfma_f32_16x16x32_bf16 v[48:51], a[156:159], a[56:59], v[48:51]
s_barrier
ds_read_b64_tr_b16 a[144:145], v12 offset:27392
v_accvgpr_read_b32 v253, a66
v_accvgpr_read_b32 v254, a67
v_mfma_f32_16x16x32_bf16 v[52:55], a[156:159], a[60:63], v[52:55]
s_waitcnt lgkmcnt(7)
ds_read_b64_tr_b16 a[146:147], v12 offset:27648
v_accvgpr_mov_b32 a66, a68
v_accvgpr_mov_b32 a67, a69
v_mfma_f32_16x16x32_bf16 v[56:59], a[160:163], a[56:59], v[56:59]
ds_read_b64_tr_b16 a[148:149], v12 offset:27424
v_accvgpr_write_b32 a68, v253
v_accvgpr_write_b32 a69, v254
v_mfma_f32_16x16x32_bf16 v[60:63], a[160:163], a[60:63], v[60:63]
s_waitcnt lgkmcnt(7)
ds_read_b64_tr_b16 a[150:151], v12 offset:27680
v_mfma_f32_16x16x32_bf16 v[64:67], a[164:167], a[56:59], v[64:67]
ds_read_b64_tr_b16 a[152:153], v12 offset:27456
v_mfma_f32_16x16x32_bf16 v[68:71], a[164:167], a[60:63], v[68:71]
s_waitcnt lgkmcnt(7)
ds_read_b64_tr_b16 a[154:155], v12 offset:27712
v_mfma_f32_16x16x32_bf16 v[72:75], a[168:171], a[56:59], v[72:75]
ds_read_b64_tr_b16 a[156:157], v12 offset:27488
v_mfma_f32_16x16x32_bf16 v[76:79], a[168:171], a[60:63], v[76:79]
s_waitcnt lgkmcnt(7)
ds_read_b64_tr_b16 a[158:159], v12 offset:27744
v_mfma_f32_16x16x32_bf16 v[80:83], a[172:175], a[56:59], v[80:83]
ds_read_b64_tr_b16 a[160:161], v12 offset:27520
v_mfma_f32_16x16x32_bf16 v[84:87], a[172:175], a[60:63], v[84:87]
s_waitcnt lgkmcnt(7)
ds_read_b64_tr_b16 a[162:163], v12 offset:27776
v_mfma_f32_16x16x32_bf16 v[24:27], a[144:147], a[64:67], v[24:27]
ds_read_b64_tr_b16 a[164:165], v12 offset:27552
v_mfma_f32_16x16x32_bf16 v[28:31], a[144:147], a[68:71], v[28:31]
s_waitcnt lgkmcnt(7)
ds_read_b64_tr_b16 a[166:167], v12 offset:27808
v_mfma_f32_16x16x32_bf16 v[32:35], a[148:151], a[64:67], v[32:35]
ds_read_b64_tr_b16 a[168:169], v12 offset:27584
v_mfma_f32_16x16x32_bf16 v[36:39], a[148:151], a[68:71], v[36:39]
s_waitcnt lgkmcnt(7)
ds_read_b64_tr_b16 a[170:171], v12 offset:27840
v_mfma_f32_16x16x32_bf16 v[40:43], a[152:155], a[64:67], v[40:43]
ds_read_b64_tr_b16 a[172:173], v12 offset:27616
v_mfma_f32_16x16x32_bf16 v[44:47], a[152:155], a[68:71], v[44:47]
s_waitcnt lgkmcnt(7)
ds_read_b64_tr_b16 a[174:175], v12 offset:27872
v_mfma_f32_16x16x32_bf16 v[48:51], a[156:159], a[64:67], v[48:51]
ds_read_b64_tr_b16 a[144:145], v12 offset:44288
s_waitcnt vmcnt(20)
v_accvgpr_read_b32 v253, a74
v_accvgpr_read_b32 v254, a75
v_mfma_f32_16x16x32_bf16 v[52:55], a[156:159], a[68:71], v[52:55]
s_waitcnt lgkmcnt(7)
ds_read_b64_tr_b16 a[146:147], v12 offset:44544
v_accvgpr_mov_b32 a74, a76
v_accvgpr_mov_b32 a75, a77
v_mfma_f32_16x16x32_bf16 v[56:59], a[160:163], a[64:67], v[56:59]
ds_read_b64_tr_b16 a[148:149], v12 offset:44320
v_accvgpr_write_b32 a76, v253
v_accvgpr_write_b32 a77, v254
v_mfma_f32_16x16x32_bf16 v[60:63], a[160:163], a[68:71], v[60:63]
s_waitcnt lgkmcnt(7)
buffer_load_dword v213, v215, s[8:11], s65 offen sc1
ds_read_b64_tr_b16 a[150:151], v12 offset:44576
v_mfma_f32_16x16x32_bf16 v[64:67], a[164:167], a[64:67], v[64:67]
ds_read_b64_tr_b16 a[152:153], v12 offset:44352
v_mfma_f32_16x16x32_bf16 v[68:71], a[164:167], a[68:71], v[68:71]
s_waitcnt lgkmcnt(7)
ds_read_b64_tr_b16 a[154:155], v12 offset:44608
v_mfma_f32_16x16x32_bf16 v[72:75], a[168:171], a[64:67], v[72:75]
ds_read_b64_tr_b16 a[156:157], v12 offset:44384
v_mfma_f32_16x16x32_bf16 v[76:79], a[168:171], a[68:71], v[76:79]
s_waitcnt lgkmcnt(7)
ds_read_b64_tr_b16 a[158:159], v12 offset:44640
v_mfma_f32_16x16x32_bf16 v[80:83], a[172:175], a[64:67], v[80:83]
ds_read_b64_tr_b16 a[160:161], v12 offset:44416
v_mfma_f32_16x16x32_bf16 v[84:87], a[172:175], a[68:71], v[84:87]
s_waitcnt lgkmcnt(7)
ds_read_b64_tr_b16 a[162:163], v12 offset:44672
v_mfma_f32_16x16x32_bf16 v[24:27], a[144:147], a[72:75], v[24:27]
ds_read_b64_tr_b16 a[164:165], v12 offset:44448
v_mfma_f32_16x16x32_bf16 v[28:31], a[144:147], a[76:79], v[28:31]
s_waitcnt lgkmcnt(7)
ds_read_b64_tr_b16 a[166:167], v12 offset:44704
v_mfma_f32_16x16x32_bf16 v[32:35], a[148:151], a[72:75], v[32:35]
ds_read_b64_tr_b16 a[168:169], v12 offset:44480
v_mfma_f32_16x16x32_bf16 v[36:39], a[148:151], a[76:79], v[36:39]
s_waitcnt lgkmcnt(7)
ds_read_b64_tr_b16 a[170:171], v12 offset:44736
v_mfma_f32_16x16x32_bf16 v[40:43], a[152:155], a[72:75], v[40:43]
ds_read_b64_tr_b16 a[172:173], v12 offset:44512
v_mfma_f32_16x16x32_bf16 v[44:47], a[152:155], a[76:79], v[44:47]
s_waitcnt lgkmcnt(7)
ds_read_b64_tr_b16 a[174:175], v12 offset:44768
v_mfma_f32_16x16x32_bf16 v[48:51], a[156:159], a[72:75], v[48:51]
s_barrier
v_add_u32 v12, 4294901760, v12
ds_read_b64_tr_b16 a[144:145], v12 offset:0
s_waitcnt vmcnt(19)
v_accvgpr_read_b32 v253, a82
v_accvgpr_read_b32 v254, a83
v_mfma_f32_16x16x32_bf16 v[52:55], a[156:159], a[76:79], v[52:55]
s_waitcnt lgkmcnt(7)
ds_read_b64_tr_b16 a[146:147], v12 offset:256
v_accvgpr_mov_b32 a82, a84
v_accvgpr_mov_b32 a83, a85
v_mfma_f32_16x16x32_bf16 v[56:59], a[160:163], a[72:75], v[56:59]
ds_read_b64_tr_b16 a[148:149], v12 offset:32
v_accvgpr_write_b32 a84, v253
v_accvgpr_write_b32 a85, v254
v_mfma_f32_16x16x32_bf16 v[60:63], a[160:163], a[76:79], v[60:63]
s_waitcnt lgkmcnt(7)
ds_read_b64_tr_b16 a[150:151], v12 offset:288
v_mfma_f32_16x16x32_bf16 v[64:67], a[164:167], a[72:75], v[64:67]
buffer_load_dword v7, v187, s[8:11], s47 offen sc1
ds_read_b64_tr_b16 a[152:153], v12 offset:64
v_mfma_f32_16x16x32_bf16 v[68:71], a[164:167], a[76:79], v[68:71]
s_waitcnt lgkmcnt(7)
ds_read_b64_tr_b16 a[154:155], v12 offset:320
v_mfma_f32_16x16x32_bf16 v[72:75], a[168:171], a[72:75], v[72:75]
ds_read_b64_tr_b16 a[156:157], v12 offset:96
v_mfma_f32_16x16x32_bf16 v[76:79], a[168:171], a[76:79], v[76:79]
s_waitcnt lgkmcnt(7)
ds_read_b64_tr_b16 a[158:159], v12 offset:352
v_mfma_f32_16x16x32_bf16 v[80:83], a[172:175], a[72:75], v[80:83]
ds_read_b64_tr_b16 a[160:161], v12 offset:128
v_mfma_f32_16x16x32_bf16 v[84:87], a[172:175], a[76:79], v[84:87]
s_waitcnt lgkmcnt(7)
ds_read_b64_tr_b16 a[162:163], v12 offset:384
v_mfma_f32_16x16x32_bf16 v[24:27], a[144:147], a[80:83], v[24:27]
ds_read_b64_tr_b16 a[164:165], v12 offset:160
v_mfma_f32_16x16x32_bf16 v[28:31], a[144:147], a[84:87], v[28:31]
s_waitcnt lgkmcnt(7)
ds_read_b64_tr_b16 a[166:167], v12 offset:416
v_mfma_f32_16x16x32_bf16 v[32:35], a[148:151], a[80:83], v[32:35]
ds_read_b64_tr_b16 a[168:169], v12 offset:192
v_mfma_f32_16x16x32_bf16 v[36:39], a[148:151], a[84:87], v[36:39]
s_waitcnt lgkmcnt(7)
ds_read_b64_tr_b16 a[170:171], v12 offset:448
v_mfma_f32_16x16x32_bf16 v[40:43], a[152:155], a[80:83], v[40:43]
ds_read_b64_tr_b16 a[172:173], v12 offset:224
v_mfma_f32_16x16x32_bf16 v[44:47], a[152:155], a[84:87], v[44:47]
s_waitcnt lgkmcnt(7)
ds_read_b64_tr_b16 a[174:175], v12 offset:480
v_mfma_f32_16x16x32_bf16 v[48:51], a[156:159], a[80:83], v[48:51]
ds_read_b64_tr_b16 a[144:145], v12 offset:33792
s_waitcnt vmcnt(18)
v_accvgpr_read_b32 v253, a90
v_accvgpr_read_b32 v254, a91
v_mfma_f32_16x16x32_bf16 v[52:55], a[156:159], a[84:87], v[52:55]
s_waitcnt lgkmcnt(7)
ds_read_b64_tr_b16 a[146:147], v12 offset:34048
v_accvgpr_mov_b32 a90, a92
v_accvgpr_mov_b32 a91, a93
v_mfma_f32_16x16x32_bf16 v[56:59], a[160:163], a[80:83], v[56:59]
ds_read_b64_tr_b16 a[148:149], v12 offset:33824
v_accvgpr_write_b32 a92, v253
v_accvgpr_write_b32 a93, v254
v_mfma_f32_16x16x32_bf16 v[60:63], a[160:163], a[84:87], v[60:63]
s_waitcnt lgkmcnt(7)
ds_read_b64_tr_b16 a[150:151], v12 offset:34080
v_mfma_f32_16x16x32_bf16 v[64:67], a[164:167], a[80:83], v[64:67]
ds_read_b64_tr_b16 a[152:153], v12 offset:33856
v_mfma_f32_16x16x32_bf16 v[68:71], a[164:167], a[84:87], v[68:71]
s_waitcnt lgkmcnt(7)
ds_read_b64_tr_b16 a[154:155], v12 offset:34112
v_mfma_f32_16x16x32_bf16 v[72:75], a[168:171], a[80:83], v[72:75]
ds_read_b64_tr_b16 a[156:157], v12 offset:33888
v_mfma_f32_16x16x32_bf16 v[76:79], a[168:171], a[84:87], v[76:79]
s_waitcnt lgkmcnt(7)
ds_read_b64_tr_b16 a[158:159], v12 offset:34144
v_mfma_f32_16x16x32_bf16 v[80:83], a[172:175], a[80:83], v[80:83]
ds_read_b64_tr_b16 a[160:161], v12 offset:33920
v_mfma_f32_16x16x32_bf16 v[84:87], a[172:175], a[84:87], v[84:87]
s_waitcnt lgkmcnt(7)
ds_read_b64_tr_b16 a[162:163], v12 offset:34176
v_mfma_f32_16x16x32_bf16 v[24:27], a[144:147], a[88:91], v[24:27]
ds_read_b64_tr_b16 a[164:165], v12 offset:33952
v_mfma_f32_16x16x32_bf16 v[28:31], a[144:147], a[92:95], v[28:31]
s_waitcnt lgkmcnt(7)
ds_read_b64_tr_b16 a[166:167], v12 offset:34208
v_mfma_f32_16x16x32_bf16 v[32:35], a[148:151], a[88:91], v[32:35]
ds_read_b64_tr_b16 a[168:169], v12 offset:33984
v_mfma_f32_16x16x32_bf16 v[36:39], a[148:151], a[92:95], v[36:39]
s_waitcnt lgkmcnt(7)
ds_read_b64_tr_b16 a[170:171], v12 offset:34240
v_mfma_f32_16x16x32_bf16 v[40:43], a[152:155], a[88:91], v[40:43]
s_waitcnt vmcnt(1)
v_cmp_ne_u32 vcc, v212, v213
s_cbranch_vccnz L3_f2
L3_f2_ret:
ds_read_b64_tr_b16 a[172:173], v12 offset:34016
v_mfma_f32_16x16x32_bf16 v[44:47], a[152:155], a[92:95], v[44:47]
s_waitcnt lgkmcnt(7)
ds_read_b64_tr_b16 a[174:175], v12 offset:34272
v_mfma_f32_16x16x32_bf16 v[48:51], a[156:159], a[88:91], v[48:51]
s_barrier
v_add_u32 v12, 65536, v12
ds_read_b64_tr_b16 a[144:145], v12 offset:2048
v_accvgpr_read_b32 v253, a98
v_accvgpr_read_b32 v254, a99
v_mfma_f32_16x16x32_bf16 v[52:55], a[156:159], a[92:95], v[52:55]
s_waitcnt lgkmcnt(7)
ds_read_b64_tr_b16 a[146:147], v12 offset:2304
v_accvgpr_mov_b32 a98, a100
v_accvgpr_mov_b32 a99, a101
v_mfma_f32_16x16x32_bf16 v[56:59], a[160:163], a[88:91], v[56:59]
s_add_u32 m0, s26, 21120
ds_read_b64_tr_b16 a[148:149], v12 offset:2080
ds_read_b64_tr_b16 a[150:151], v12 offset:2336
v_mfma_f32_16x16x32_bf16 v[60:63], a[160:163], a[92:95], v[60:63]
s_waitcnt lgkmcnt(8)
buffer_load_dwordx4 v2, s[8:11], s25 offen sc1 lds
v_mfma_f32_16x16x32_bf16 v[64:67], a[164:167], a[88:91], v[64:67]
s_add_u32 s25, s25, 4096
ds_read_b64_tr_b16 a[152:153], v12 offset:2112
v_accvgpr_write_b32 a100, v253
v_accvgpr_write_b32 a101, v254
v_mfma_f32_16x16x32_bf16 v[68:71], a[164:167], a[92:95], v[68:71]
s_waitcnt lgkmcnt(7)
ds_read_b64_tr_b16 a[154:155], v12 offset:2368
v_mfma_f32_16x16x32_bf16 v[72:75], a[168:171], a[88:91], v[72:75]
s_add_u32 m0, s26, 25344
ds_read_b64_tr_b16 a[156:157], v12 offset:2144
ds_read_b64_tr_b16 a[158:159], v12 offset:2400
v_mfma_f32_16x16x32_bf16 v[76:79], a[168:171], a[92:95], v[76:79]
s_waitcnt lgkmcnt(8)
buffer_load_dwordx4 v2, s[8:11], s25 offen sc1 lds
v_mfma_f32_16x16x32_bf16 v[80:83], a[172:175], a[88:91], v[80:83]
s_add_u32 s25, s25, 4096
ds_read_b64_tr_b16 a[160:161], v12 offset:2176
v_mfma_f32_16x16x32_bf16 v[84:87], a[172:175], a[92:95], v[84:87]
s_waitcnt lgkmcnt(7)
ds_read_b64_tr_b16 a[162:163], v12 offset:2432
v_mfma_f32_16x16x32_bf16 v[24:27], a[144:147], a[96:99], v[24:27]
s_add_u32 m0, s26, 29568
ds_read_b64_tr_b16 a[164:165], v12 offset:2208
ds_read_b64_tr_b16 a[166:167], v12 offset:2464
v_mfma_f32_16x16x32_bf16 v[28:31], a[144:147], a[100:103], v[28:31]
s_waitcnt lgkmcnt(8)
buffer_load_dwordx4 v241, s[60:63], s85 offen  lds
v_mfma_f32_16x16x32_bf16 v[32:35], a[148:151], a[96:99], v[32:35]
s_add_u32 s85, s85, 294912
ds_read_b64_tr_b16 a[168:169], v12 offset:2240
v_mfma_f32_16x16x32_bf16 v[36:39], a[148:151], a[100:103], v[36:39]
s_waitcnt lgkmcnt(7)
ds_read_b64_tr_b16 a[170:171], v12 offset:2496
v_mfma_f32_16x16x32_bf16 v[40:43], a[152:155], a[96:99], v[40:43]
s_add_u32 m0, s26, 42240
ds_read_b64_tr_b16 a[172:173], v12 offset:2272
ds_read_b64_tr_b16 a[174:175], v12 offset:2528
v_mfma_f32_16x16x32_bf16 v[44:47], a[152:155], a[100:103], v[44:47]
s_waitcnt lgkmcnt(8)
buffer_load_dwordx4 v242, s[60:63], s87 offen  lds
v_mfma_f32_16x16x32_bf16 v[48:51], a[156:159], a[96:99], v[48:51]
s_add_u32 s87, s87, 589824
ds_read_b64_tr_b16 a[144:145], v12 offset:35840
v_accvgpr_read_b32 v253, a106
v_accvgpr_read_b32 v254, a107
v_mfma_f32_16x16x32_bf16 v[52:55], a[156:159], a[100:103], v[52:55]
s_waitcnt lgkmcnt(7)
s_waitcnt vmcnt(4)
v_subrev_u32 v7, s38, v7
v_cmp_lt_u32 vcc, 4, v7
s_cbranch_vccnz L3_poll0
L3_poll0_ret:
ds_read_b64_tr_b16 a[146:147], v12 offset:36096
v_mfma_f32_16x16x32_bf16 v[56:59], a[160:163], a[96:99], v[56:59]
ds_read_b64_tr_b16 a[148:149], v12 offset:35872
ds_read_b64_tr_b16 a[150:151], v12 offset:36128
v_mfma_f32_16x16x32_bf16 v[60:63], a[160:163], a[100:103], v[60:63]
s_waitcnt lgkmcnt(8)
buffer_load_dwordx4 v[168:171], v1, s[8:11], s39 offen offset:0 sc1
v_mfma_f32_16x16x32_bf16 v[64:67], a[164:167], a[96:99], v[64:67]
ds_read_b64_tr_b16 a[152:153], v12 offset:35904
v_accvgpr_mov_b32 a106, a108
v_accvgpr_mov_b32 a107, a109
v_mfma_f32_16x16x32_bf16 v[68:71], a[164:167], a[100:103], v[68:71]
s_waitcnt lgkmcnt(7)
ds_read_b64_tr_b16 a[154:155], v12 offset:36160
v_accvgpr_write_b32 a108, v253
v_accvgpr_write_b32 a109, v254
v_mfma_f32_16x16x32_bf16 v[72:75], a[168:171], a[96:99], v[72:75]
ds_read_b64_tr_b16 a[156:157], v12 offset:35936
ds_read_b64_tr_b16 a[158:159], v12 offset:36192
v_mfma_f32_16x16x32_bf16 v[76:79], a[168:171], a[100:103], v[76:79]
s_waitcnt lgkmcnt(8)
buffer_load_dwordx4 v[172:175], v1, s[8:11], s39 offen offset:1024 sc1
v_mfma_f32_16x16x32_bf16 v[80:83], a[172:175], a[96:99], v[80:83]
ds_read_b64_tr_b16 a[160:161], v12 offset:35968
v_mfma_f32_16x16x32_bf16 v[84:87], a[172:175], a[100:103], v[84:87]
s_waitcnt lgkmcnt(7)
ds_read_b64_tr_b16 a[162:163], v12 offset:36224
v_mfma_f32_16x16x32_bf16 v[24:27], a[144:147], a[104:107], v[24:27]
ds_read_b64_tr_b16 a[164:165], v12 offset:36000
ds_read_b64_tr_b16 a[166:167], v12 offset:36256
v_mfma_f32_16x16x32_bf16 v[28:31], a[144:147], a[108:111], v[28:31]
s_waitcnt lgkmcnt(8)
buffer_load_dwordx4 v[176:179], v1, s[8:11], s39 offen offset:2048 sc1
v_mfma_f32_16x16x32_bf16 v[32:35], a[148:151], a[104:107], v[32:35]
ds_read_b64_tr_b16 a[168:169], v12 offset:36032
v_mfma_f32_16x16x32_bf16 v[36:39], a[148:151], a[108:111], v[36:39]
s_waitcnt lgkmcnt(7)
ds_read_b64_tr_b16 a[170:171], v12 offset:36288
v_mfma_f32_16x16x32_bf16 v[40:43], a[152:155], a[104:107], v[40:43]
ds_read_b64_tr_b16 a[172:173], v12 offset:36064
ds_read_b64_tr_b16 a[174:175], v12 offset:36320
v_mfma_f32_16x16x32_bf16 v[44:47], a[152:155], a[108:111], v[44:47]
s_waitcnt lgkmcnt(8)
buffer_load_dwordx4 v[180:183], v1, s[8:11], s39 offen offset:3072 sc1
v_mfma_f32_16x16x32_bf16 v[48:51], a[156:159], a[104:107], v[48:51]
s_barrier
ds_read_b64_tr_b16 a[144:145], v12 offset:52736
v_accvgpr_read_b32 v253, a114
v_accvgpr_read_b32 v254, a115
v_mfma_f32_16x16x32_bf16 v[52:55], a[156:159], a[108:111], v[52:55]
s_waitcnt lgkmcnt(7)
ds_read_b64_tr_b16 a[146:147], v12 offset:52992
v_accvgpr_mov_b32 a114, a116
v_accvgpr_mov_b32 a115, a117
v_mfma_f32_16x16x32_bf16 v[56:59], a[160:163], a[104:107], v[56:59]
s_add_u32 m0, s26, 46464
ds_read_b64_tr_b16 a[148:149], v12 offset:52768
ds_read_b64_tr_b16 a[150:151], v12 offset:53024
v_mfma_f32_16x16x32_bf16 v[60:63], a[160:163], a[108:111], v[60:63]
s_waitcnt lgkmcnt(8)
buffer_load_dwordx4 v241, s[60:63], s85 offen  lds
v_mfma_f32_16x16x32_bf16 v[64:67], a[164:167], a[104:107], v[64:67]
s_add_u32 s85, s85, 294912
ds_read_b64_tr_b16 a[152:153], v12 offset:52800
v_accvgpr_write_b32 a116, v253
v_accvgpr_write_b32 a117, v254
v_mfma_f32_16x16x32_bf16 v[68:71], a[164:167], a[108:111], v[68:71]
s_waitcnt lgkmcnt(7)
ds_read_b64_tr_b16 a[154:155], v12 offset:53056
v_mfma_f32_16x16x32_bf16 v[72:75], a[168:171], a[104:107], v[72:75]
s_add_u32 m0, s26, 50688
ds_read_b64_tr_b16 a[156:157], v12 offset:52832
ds_read_b64_tr_b16 a[158:159], v12 offset:53088
v_mfma_f32_16x16x32_bf16 v[76:79], a[168:171], a[108:111], v[76:79]
s_waitcnt lgkmcnt(8)
buffer_load_dwordx4 v241, s[60:63], s85 offen  lds
v_mfma_f32_16x16x32_bf16 v[80:83], a[172:175], a[104:107], v[80:83]
s_add_u32 s85, s85, 294912
ds_read_b64_tr_b16 a[160:161], v12 offset:52864
v_mfma_f32_16x16x32_bf16 v[84:87], a[172:175], a[108:111], v[84:87]
s_waitcnt lgkmcnt(7)
ds_read_b64_tr_b16 a[162:163], v12 offset:53120
v_mfma_f32_16x16x32_bf16 v[24:27], a[144:147], a[112:115], v[24:27]
PAD1:
s_cbranch_execz PAD_ret
s_add_u32 m0, s26, 54912
ds_read_b64_tr_b16 a[164:165], v12 offset:52896
ds_read_b64_tr_b16 a[166:167], v12 offset:53152
v_mfma_f32_16x16x32_bf16 v[28:31], a[144:147], a[116:119], v[28:31]
s_waitcnt lgkmcnt(8)
buffer_load_dwordx4 v242, s[60:63], s87 offen  lds
v_mfma_f32_16x16x32_bf16 v[32:35], a[148:151], a[112:115], v[32:35]
s_add_u32 s87, s87, 589824
ds_read_b64_tr_b16 a[168:169], v12 offset:52928
v_mfma_f32_16x16x32_bf16 v[36:39], a[148:151], a[116:119], v[36:39]
s_waitcnt lgkmcnt(7)
ds_read_b64_tr_b16 a[170:171], v12 offset:53184
v_mfma_f32_16x16x32_bf16 v[40:43], a[152:155], a[112:115], v[40:43]
s_add_u32 m0, s26, 59136
ds_read_b64_tr_b16 a[172:173], v12 offset:52960
ds_read_b64_tr_b16 a[174:175], v12 offset:53216
v_mfma_f32_16x16x32_bf16 v[44:47], a[152:155], a[116:119], v[44:47]
s_waitcnt lgkmcnt(8)
buffer_load_dwordx4 v241, s[60:63], s85 offen  lds
v_mfma_f32_16x16x32_bf16 v[48:51], a[156:159], a[112:115], v[48:51]
s_add_u32 s85, s85, 294912
ds_read_b64_tr_b16 a[144:145], v12 offset:61184
v_accvgpr_read_b32 v253, a122
v_accvgpr_read_b32 v254, a123
v_mfma_f32_16x16x32_bf16 v[52:55], a[156:159], a[116:119], v[52:55]
s_waitcnt lgkmcnt(7)
ds_read_b64_tr_b16 a[146:147], v12 offset:61440
v_accvgpr_mov_b32 a122, a124
v_accvgpr_mov_b32 a123, a125
v_mfma_f32_16x16x32_bf16 v[56:59], a[160:163], a[112:115], v[56:59]
s_add_u32 m0, s26, 63360
ds_read_b64_tr_b16 a[148:149], v12 offset:61216
ds_read_b64_tr_b16 a[150:151], v12 offset:61472
v_mfma_f32_16x16x32_bf16 v[60:63], a[160:163], a[116:119], v[60:63]
s_waitcnt lgkmcnt(8)
buffer_load_dwordx4 v241, s[60:63], s85 offen  lds
v_mfma_f32_16x16x32_bf16 v[64:67], a[164:167], a[112:115], v[64:67]
s_add_u32 s85, s85, 294912
ds_read_b64_tr_b16 a[152:153], v12 offset:61248
v_accvgpr_write_b32 a124, v253
v_accvgpr_write_b32 a125, v254
v_mfma_f32_16x16x32_bf16 v[68:71], a[164:167], a[116:119], v[68:71]
s_waitcnt lgkmcnt(7)
ds_read_b64_tr_b16 a[154:155], v12 offset:61504
v_mfma_f32_16x16x32_bf16 v[72:75], a[168:171], a[112:115], v[72:75]
s_add_u32 m0, s26, 76032
ds_read_b64_tr_b16 a[156:157], v12 offset:61280
ds_read_b64_tr_b16 a[158:159], v12 offset:61536
v_mfma_f32_16x16x32_bf16 v[76:79], a[168:171], a[116:119], v[76:79]
s_waitcnt lgkmcnt(8)
buffer_load_dwordx4 v242, s[60:63], s87 offen  lds
v_mfma_f32_16x16x32_bf16 v[80:83], a[172:175], a[112:115], v[80:83]
s_add_u32 s87, s87, 589824
ds_read_b64_tr_b16 a[160:161], v12 offset:61312
v_mfma_f32_16x16x32_bf16 v[84:87], a[172:175], a[116:119], v[84:87]
s_waitcnt lgkmcnt(7)
ds_read_b64_tr_b16 a[162:163], v12 offset:61568
v_mfma_f32_16x16x32_bf16 v[24:27], a[144:147], a[120:123], v[24:27]
s_add_u32 m0, s26, 80256
ds_read_b64_tr_b16 a[164:165], v12 offset:61344
ds_read_b64_tr_b16 a[166:167], v12 offset:61600
v_mfma_f32_16x16x32_bf16 v[28:31], a[144:147], a[124:127], v[28:31]
s_waitcnt lgkmcnt(8)
buffer_load_dwordx4 v241, s[60:63], s85 offen  lds
v_mfma_f32_16x16x32_bf16 v[32:35], a[148:151], a[120:123], v[32:35]
s_add_u32 s85, s85, 294912
ds_read_b64_tr_b16 a[168:169], v12 offset:61376
v_mfma_f32_16x16x32_bf16 v[36:39], a[148:151], a[124:127], v[36:39]
s_waitcnt lgkmcnt(7)
ds_read_b64_tr_b16 a[170:171], v12 offset:61632
v_mfma_f32_16x16x32_bf16 v[40:43], a[152:155], a[120:123], v[40:43]
s_add_u32 m0, s26, 84480
ds_read_b64_tr_b16 a[172:173], v12 offset:61408
ds_read_b64_tr_b16 a[174:175], v12 offset:61664
v_mfma_f32_16x16x32_bf16 v[44:47], a[152:155], a[124:127], v[44:47]
s_waitcnt lgkmcnt(8)
buffer_load_dwordx4 v241, s[60:63], s85 offen  lds
v_mfma_f32_16x16x32_bf16 v[48:51], a[156:159], a[120:123], v[48:51]
s_add_u32 s85, s85, 294912
s_barrier
v_add_u32 v12, 65536, v12
ds_read_b64_tr_b16 a[144:145], v12 offset:4096
v_accvgpr_read_b32 v253, a130
v_accvgpr_read_b32 v254, a131
v_mfma_f32_16x16x32_bf16 v[52:55], a[156:159], a[124:127], v[52:55]
s_waitcnt lgkmcnt(7)
ds_read_b64_tr_b16 a[146:147], v12 offset:4352
v_accvgpr_mov_b32 a130, a132
v_accvgpr_mov_b32 a131, a133
v_mfma_f32_16x16x32_bf16 v[56:59], a[160:163], a[120:123], v[56:59]
s_add_u32 m0, s26, 88704
ds_read_b64_tr_b16 a[148:149], v12 offset:4128
ds_read_b64_tr_b16 a[150:151], v12 offset:4384
v_mfma_f32_16x16x32_bf16 v[60:63], a[160:163], a[124:127], v[60:63]
s_waitcnt lgkmcnt(8)
buffer_load_dwordx4 v242, s[60:63], s87 offen  lds
v_mfma_f32_16x16x32_bf16 v[64:67], a[164:167], a[120:123], v[64:67]
s_add_u32 s87, s87, 589824
ds_read_b64_tr_b16 a[152:153], v12 offset:4160
v_accvgpr_write_b32 a132, v253
v_accvgpr_write_b32 a133, v254
v_mfma_f32_16x16x32_bf16 v[68:71], a[164:167], a[124:127], v[68:71]
s_waitcnt lgkmcnt(7)
ds_read_b64_tr_b16 a[154:155], v12 offset:4416
v_mfma_f32_16x16x32_bf16 v[72:75], a[168:171], a[120:123], v[72:75]
s_add_u32 m0, s26, 92928
ds_read_b64_tr_b16 a[156:157], v12 offset:4192
ds_read_b64_tr_b16 a[158:159], v12 offset:4448
v_mfma_f32_16x16x32_bf16 v[76:79], a[168:171], a[124:127], v[76:79]
s_waitcnt lgkmcnt(8)
buffer_load_dwordx4 v241, s[60:63], s85 offen  lds
v_mfma_f32_16x16x32_bf16 v[80:83], a[172:175], a[120:123], v[80:83]
s_add_u32 s85, s85, 294912
ds_read_b64_tr_b16 a[160:161], v12 offset:4224
v_mfma_f32_16x16x32_bf16 v[84:87], a[172:175], a[124:127], v[84:87]
s_waitcnt lgkmcnt(7)
ds_read_b64_tr_b16 a[162:163], v12 offset:4480
v_mfma_f32_16x16x32_bf16 v[24:27], a[144:147], a[128:131], v[24:27]
s_add_u32 m0, s26, 97152
ds_read_b64_tr_b16 a[164:165], v12 offset:4256
ds_read_b64_tr_b16 a[166:167], v12 offset:4512
v_mfma_f32_16x16x32_bf16 v[28:31], a[144:147], a[132:135], v[28:31]
s_waitcnt lgkmcnt(8)
buffer_load_dwordx4 v241, s[60:63], s85 offen  lds
v_mfma_f32_16x16x32_bf16 v[32:35], a[148:151], a[128:131], v[32:35]
s_add_u32 s85, s85, 294912
ds_read_b64_tr_b16 a[168:169], v12 offset:4288
v_mfma_f32_16x16x32_bf16 v[36:39], a[148:151], a[132:135], v[36:39]
s_waitcnt lgkmcnt(7)
ds_read_b64_tr_b16 a[170:171], v12 offset:4544
v_mfma_f32_16x16x32_bf16 v[40:43], a[152:155], a[128:131], v[40:43]
s_add_u32 m0, s26, 109824
ds_read_b64_tr_b16 a[172:173], v12 offset:4320
ds_read_b64_tr_b16 a[174:175], v12 offset:4576
v_mfma_f32_16x16x32_bf16 v[44:47], a[152:155], a[132:135], v[44:47]
s_waitcnt lgkmcnt(8)
buffer_load_dwordx4 v242, s[60:63], s87 offen  lds
v_mfma_f32_16x16x32_bf16 v[48:51], a[156:159], a[128:131], v[48:51]
s_add_u32 s87, s87, 589824
ds_read_b64_tr_b16 a[144:145], v12 offset:12544
v_accvgpr_read_b32 v253, a138
v_accvgpr_read_b32 v254, a139
v_mfma_f32_16x16x32_bf16 v[52:55], a[156:159], a[132:135], v[52:55]
s_waitcnt lgkmcnt(7)
ds_read_b64_tr_b16 a[146:147], v12 offset:12800
v_accvgpr_mov_b32 a138, a140
v_accvgpr_mov_b32 a139, a141
v_mfma_f32_16x16x32_bf16 v[56:59], a[160:163], a[128:131], v[56:59]
s_add_u32 m0, s26, 114048
ds_read_b64_tr_b16 a[148:149], v12 offset:12576
ds_read_b64_tr_b16 a[150:151], v12 offset:12832
v_mfma_f32_16x16x32_bf16 v[60:63], a[160:163], a[132:135], v[60:63]
s_waitcnt lgkmcnt(8)
buffer_load_dwordx4 v241, s[60:63], s85 offen  lds
v_mfma_f32_16x16x32_bf16 v[64:67], a[164:167], a[128:131], v[64:67]
s_add_u32 s85, s85, 294912
ds_read_b64_tr_b16 a[152:153], v12 offset:12608
v_accvgpr_write_b32 a140, v253
v_accvgpr_write_b32 a141, v254
v_mfma_f32_16x16x32_bf16 v[68:71], a[164:167], a[132:135], v[68:71]
s_waitcnt lgkmcnt(7)
ds_read_b64_tr_b16 a[154:155], v12 offset:12864
s_waitcnt vmcnt(13)
v_add_f32 v168, v168, v172
v_add_f32 v176, v176, v180
v_mfma_f32_16x16x32_bf16 v[72:75], a[168:171], a[128:131], v[72:75]
s_add_u32 m0, s26, 0
ds_read_b64_tr_b16 a[156:157], v12 offset:12640
ds_read_b64_tr_b16 a[158:159], v12 offset:12896
v_mfma_f32_16x16x32_bf16 v[76:79], a[168:171], a[132:135], v[76:79]
s_waitcnt lgkmcnt(8)
buffer_load_dwordx4 v241, s[60:63], s85 offen  lds
v_mfma_f32_16x16x32_bf16 v[80:83], a[172:175], a[128:131], v[80:83]
s_add_u32 s85, s85, 294912
ds_read_b64_tr_b16 a[160:161], v12 offset:12672
v_add_f32 v169, v169, v173
v_add_f32 v177, v177, v181
v_mfma_f32_16x16x32_bf16 v[84:87], a[172:175], a[132:135], v[84:87]
s_waitcnt lgkmcnt(7)
ds_read_b64_tr_b16 a[162:163], v12 offset:12928
v_add_f32 v170, v170, v174
v_add_f32 v178, v178, v182
v_mfma_f32_16x16x32_bf16 v[24:27], a[144:147], a[136:139], v[24:27]
s_add_u32 m0, s26, 4224
ds_read_b64_tr_b16 a[164:165], v12 offset:12704
ds_read_b64_tr_b16 a[166:167], v12 offset:12960
v_mfma_f32_16x16x32_bf16 v[28:31], a[144:147], a[140:143], v[28:31]
s_waitcnt lgkmcnt(8)
buffer_load_dwordx4 v242, s[60:63], s87 offen  lds
v_mfma_f32_16x16x32_bf16 v[32:35], a[148:151], a[136:139], v[32:35]
s_add_u32 s87, s87, 589824
ds_read_b64_tr_b16 a[168:169], v12 offset:12736
v_add_f32 v171, v171, v175
v_add_f32 v179, v179, v183
v_mfma_f32_16x16x32_bf16 v[36:39], a[148:151], a[140:143], v[36:39]
s_waitcnt lgkmcnt(7)
ds_read_b64_tr_b16 a[170:171], v12 offset:12992
v_add_f32 v168, v168, v176
v_add_f32 v169, v169, v177
v_mfma_f32_16x16x32_bf16 v[40:43], a[152:155], a[136:139], v[40:43]
s_add_u32 m0, s26, 33792
ds_read_b64_tr_b16 a[172:173], v12 offset:12768
ds_read_b64_tr_b16 a[174:175], v12 offset:13024
v_mfma_f32_16x16x32_bf16 v[44:47], a[152:155], a[140:143], v[44:47]
s_waitcnt lgkmcnt(8)
buffer_load_dwordx4 v241, s[60:63], s85 offen  lds
v_mfma_f32_16x16x32_bf16 v[48:51], a[156:159], a[136:139], v[48:51]
s_add_u32 s85, s85, 294912
s_barrier
ds_read_b64_tr_b16 a[144:145], v13 offset:8448
v_add_f32 v170, v170, v178
v_add_f32 v171, v171, v179
v_mfma_f32_16x16x32_bf16 v[52:55], a[156:159], a[140:143], v[52:55]
s_waitcnt lgkmcnt(7)
ds_read_b64_tr_b16 a[146:147], v13 offset:8704
v_mov_b32 v172, v168
v_mov_b32 v173, v169
v_mfma_f32_16x16x32_bf16 v[56:59], a[160:163], a[136:139], v[56:59]
s_add_u32 m0, s26, 38016
ds_read_b64_tr_b16 a[148:149], v13 offset:8480
ds_read_b64_tr_b16 a[150:151], v13 offset:8736
v_mfma_f32_16x16x32_bf16 v[60:63], a[160:163], a[140:143], v[60:63]
s_waitcnt lgkmcnt(8)
buffer_load_dwordx4 v241, s[60:63], s85 offen  lds
v_mfma_f32_16x16x32_bf16 v[64:67], a[164:167], a[136:139], v[64:67]
s_add_u32 s85, s85, 294912
ds_read_b64_tr_b16 a[152:153], v13 offset:8512
v_mov_b32 v174, v170
v_mov_b32 v175, v171
v_mfma_f32_16x16x32_bf16 v[68:71], a[164:167], a[140:143], v[68:71]
s_waitcnt lgkmcnt(7)
ds_read_b64_tr_b16 a[154:155], v13 offset:8768
v_permlane16_swap_b32 v168, v172
v_permlane16_swap_b32 v169, v173
v_mfma_f32_16x16x32_bf16 v[72:75], a[168:171], a[136:139], v[72:75]
s_add_u32 m0, s26, 67584
ds_read_b64_tr_b16 a[156:157], v13 offset:8544
ds_read_b64_tr_b16 a[158:159], v13 offset:8800
v_mfma_f32_16x16x32_bf16 v[76:79], a[168:171], a[140:143], v[76:79]
s_waitcnt lgkmcnt(8)
buffer_load_dwordx4 v242, s[60:63], s87 offen  lds
v_mfma_f32_16x16x32_bf16 v[80:83], a[172:175], a[136:139], v[80:83]
s_add_u32 s87, s87, 589824
ds_read_b64_tr_b16 a[160:161], v243 offset:12672
v_permlane16_swap_b32 v170, v174
v_permlane16_swap_b32 v171, v175
v_mfma_f32_16x16x32_bf16 v[84:87], a[172:175], a[140:143], v[84:87]
s_waitcnt lgkmcnt(7)
ds_read_b64_tr_b16 a[162:163], v243 offset:12928
v_add_f32 v168, v168, v172
v_add_f32 v169, v169, v173
v_mfma_f32_16x16x32_bf16 v[88:91], a[144:147], a[0:3], 0
s_add_u32 m0, s26, 71808
ds_read_b64_tr_b16 a[164:165], v243 offset:12704
ds_read_b64_tr_b16 a[166:167], v243 offset:12960
v_mfma_f32_16x16x32_bf16 v[92:95], a[144:147], a[4:7], 0
s_waitcnt lgkmcnt(8)
buffer_load_dwordx4 v241, s[60:63], s85 offen  lds
v_mfma_f32_16x16x32_bf16 v[96:99], a[148:151], a[0:3], 0
s_add_u32 s85, s85, 294912
ds_read_b64_tr_b16 a[168:169], v13 offset:16896
v_add_f32 v170, v170, v174
v_add_f32 v171, v171, v175
v_mfma_f32_16x16x32_bf16 v[100:103], a[148:151], a[4:7], 0
s_waitcnt lgkmcnt(7)
ds_read_b64_tr_b16 a[170:171], v13 offset:17152
v_mov_b32 v172, v168
v_mov_b32 v173, v169
v_mfma_f32_16x16x32_bf16 v[104:107], a[152:155], a[0:3], 0
s_add_u32 m0, s26, 101376
ds_read_b64_tr_b16 a[172:173], v13 offset:16928
ds_read_b64_tr_b16 a[174:175], v13 offset:17184
v_mfma_f32_16x16x32_bf16 v[108:111], a[152:155], a[4:7], 0
s_waitcnt lgkmcnt(8)
buffer_load_dwordx4 v241, s[60:63], s85 offen  lds
v_mfma_f32_16x16x32_bf16 v[112:115], a[156:159], a[0:3], 0
s_add_u32 s85, s85, 294912
ds_read_b64_tr_b16 a[144:145], v13 offset:16960
v_mov_b32 v174, v170
v_mov_b32 v175, v171
v_mfma_f32_16x16x32_bf16 v[116:119], a[156:159], a[4:7], 0
s_waitcnt lgkmcnt(7)
ds_read_b64_tr_b16 a[146:147], v13 offset:17216
v_permlane32_swap_b32 v168, v172
v_permlane32_swap_b32 v169, v173
v_mfma_f32_16x16x32_bf16 v[120:123], a[160:163], a[0:3], 0
s_add_u32 m0, s26, 105600
ds_read_b64_tr_b16 a[148:149], v13 offset:16992
ds_read_b64_tr_b16 a[150:151], v13 offset:17248
v_mfma_f32_16x16x32_bf16 v[124:127], a[160:163], a[4:7], 0
s_waitcnt lgkmcnt(8)
buffer_load_dwordx4 v242, s[60:63], s87 offen  lds
v_mfma_f32_16x16x32_bf16 v[128:131], a[164:167], a[0:3], 0
s_add_u32 s87, s87, 589824
ds_read_b64_tr_b16 a[152:153], v243 offset:14784
v_permlane32_swap_b32 v170, v174
v_permlane32_swap_b32 v171, v175
v_mfma_f32_16x16x32_bf16 v[132:135], a[164:167], a[4:7], 0
s_waitcnt lgkmcnt(7)
ds_read_b64_tr_b16 a[154:155], v243 offset:15040
v_add_f32 v168, v168, v172
v_add_f32 v169, v169, v173
v_mfma_f32_16x16x32_bf16 v[88:91], a[168:171], a[8:11], v[88:91]
s_add_u32 m0, s26, 118272
ds_read_b64_tr_b16 a[156:157], v243 offset:14816
ds_read_b64_tr_b16 a[158:159], v243 offset:15072
v_mfma_f32_16x16x32_bf16 v[92:95], a[168:171], a[12:15], v[92:95]
s_waitcnt lgkmcnt(8)
buffer_load_dwordx4 v241, s[60:63], s85 offen  lds
v_mfma_f32_16x16x32_bf16 v[96:99], a[172:175], a[8:11], v[96:99]
s_add_u32 s85, s85, 294912
ds_read_b128 a[160:163], v11 offset:21120
v_add_f32 v170, v170, v174
v_add_f32 v171, v171, v175
v_mfma_f32_16x16x32_bf16 v[100:103], a[172:175], a[12:15], v[100:103]
s_waitcnt lgkmcnt(7)
v_mul_f32 v168, 0x3ae38e39, v168
v_mul_f32 v170, 0x3ae38e39, v170
v_mfma_f32_16x16x32_bf16 v[104:107], a[144:147], a[8:11], v[104:107]
s_add_u32 m0, s26, 122496
ds_read_b128 a[164:167], v11 offset:22176
v_mul_f32 v169, 0x3ae38e39, v169
v_mul_f32 v171, 0x3ae38e39, v171
v_mfma_f32_16x16x32_bf16 v[108:111], a[144:147], a[12:15], v[108:111]
s_waitcnt lgkmcnt(6)
buffer_load_dwordx4 v2, s[8:11], s25 offen sc1 lds
v_mfma_f32_16x16x32_bf16 v[112:115], a[148:151], a[8:11], v[112:115]
s_add_u32 s25, s25, 4096
ds_read_b128 a[168:171], v11 offset:23232
v_fma_f32 v169, -v168, v168, v169
v_fma_f32 v171, -v170, v170, v171
v_mfma_f32_16x16x32_bf16 v[116:119], a[148:151], a[12:15], v[116:119]
s_waitcnt lgkmcnt(5)
v_max_f32 v169, 0, v169
v_max_f32 v171, 0, v171
v_mfma_f32_16x16x32_bf16 v[120:123], a[152:155], a[8:11], v[120:123]
s_add_u32 m0, s26, 126720
ds_read_b128 a[172:175], v11 offset:24288
v_cvt_pk_bf16_f32 v169, v169, v169
v_cvt_pk_bf16_f32 v171, v171, v171
v_mfma_f32_16x16x32_bf16 v[124:127], a[152:155], a[12:15], v[124:127]
s_waitcnt lgkmcnt(4)
buffer_load_dwordx4 v2, s[8:11], s25 offen sc1 lds
v_mfma_f32_16x16x32_bf16 v[128:131], a[156:159], a[8:11], v[128:131]
s_add_u32 s25, s25, 4096
s_waitcnt vmcnt(23)
s_barrier
ds_read_b128 a[144:147], v11 offset:25344
v_lshlrev_b32 v169, 16, v169
v_lshlrev_b32 v171, 16, v171
v_mfma_f32_16x16x32_bf16 v[132:135], a[156:159], a[12:15], v[132:135]
s_waitcnt lgkmcnt(4)
v_add_f32 v169, 0x3727c5ac, v169
v_add_f32 v171, 0x3727c5ac, v171
v_cvt_pk_bf16_f32 v169, v169, v169
v_cvt_pk_bf16_f32 v171, v171, v171
v_lshlrev_b32 v169, 16, v169
v_lshlrev_b32 v171, 16, v171
v_sqrt_f32 v169, v169
v_sqrt_f32 v171, v171
v_cvt_pk_bf16_f32 v172, v169, v169
v_cvt_pk_bf16_f32 v173, v171, v171
v_cvt_pk_bf16_f32 v16, -v168, -v168
v_cvt_pk_bf16_f32 v20, -v170, -v170
v_lshlrev_b32 v169, 16, v172
v_lshlrev_b32 v171, 16, v173
v_cndmask_b32 v16, v16, v172, s[40:41]
v_cndmask_b32 v20, v20, v173, s[40:41]
v_mul_f32 v169, v169, v169
v_mul_f32 v171, v171, v171
v_mov_b32 v17, 0
v_mov_b32 v21, 0
v_rcp_f32 v8, v169
v_rcp_f32 v6, v171
v_mov_b32 v18, 0
v_mov_b32 v22, 0
v_mov_b32 v19, 0
s_nop 1
v_mfma_f32_16x16x32_bf16 v[24:27], a[160:163], v[16:19], v[24:27]
s_add_u32 m0, s26, 130944
ds_read_b128 a[148:151], v11 offset:26400
v_mov_b32 v23, 0
s_nop 1
v_mfma_f32_16x16x32_bf16 v[28:31], a[160:163], v[20:23], v[28:31]
s_waitcnt lgkmcnt(4)
buffer_load_dwordx4 v2, s[8:11], s25 offen sc1 lds
v_mfma_f32_16x16x32_bf16 v[32:35], a[164:167], v[16:19], v[32:35]
s_add_u32 s25, s25, 4096
ds_read_b128 a[152:155], v11 offset:27456
v_mfma_f32_16x16x32_bf16 v[36:39], a[164:167], v[20:23], v[36:39]
s_waitcnt lgkmcnt(4)
v_mfma_f32_16x16x32_bf16 v[40:43], a[168:171], v[16:19], v[40:43]
s_add_u32 m0, s26, 135168
ds_read_b128 a[156:159], v11 offset:28512
v_mfma_f32_16x16x32_bf16 v[44:47], a[168:171], v[20:23], v[44:47]
s_waitcnt lgkmcnt(4)
buffer_load_dwordx4 v241, s[60:63], s86 offen  lds
v_mfma_f32_16x16x32_bf16 v[48:51], a[172:175], v[16:19], v[48:51]
s_add_u32 s86, s86, 294912
ds_read_b64_tr_b16 a[160:161], v13 offset:29568
v_mfma_f32_16x16x32_bf16 v[52:55], a[172:175], v[20:23], v[52:55]
s_waitcnt lgkmcnt(4)
ds_read_b64_tr_b16 a[162:163], v13 offset:29824
v_mfma_f32_16x16x32_bf16 v[56:59], a[144:147], v[16:19], v[56:59]
s_add_u32 m0, s26, 139392
ds_read_b64_tr_b16 a[164:165], v13 offset:29600
ds_read_b64_tr_b16 a[166:167], v13 offset:29856
v_mfma_f32_16x16x32_bf16 v[60:63], a[144:147], v[20:23], v[60:63]
s_waitcnt lgkmcnt(6)
buffer_load_dwordx4 v241, s[60:63], s86 offen  lds
v_mfma_f32_16x16x32_bf16 v[64:67], a[148:151], v[16:19], v[64:67]
s_add_u32 s86, s86, 294912
ds_read_b64_tr_b16 a[168:169], v13 offset:29632
v_mfma_f32_16x16x32_bf16 v[68:71], a[148:151], v[20:23], v[68:71]
s_waitcnt lgkmcnt(6)
ds_read_b64_tr_b16 a[170:171], v13 offset:29888
v_mfma_f32_16x16x32_bf16 v[72:75], a[152:155], v[16:19], v[72:75]
s_add_u32 m0, s26, 143616
ds_read_b64_tr_b16 a[172:173], v13 offset:29664
ds_read_b64_tr_b16 a[174:175], v13 offset:29920
v_mfma_f32_16x16x32_bf16 v[76:79], a[152:155], v[20:23], v[76:79]
s_waitcnt lgkmcnt(8)
buffer_load_dwordx4 v241, s[60:63], s86 offen  lds
v_mfma_f32_16x16x32_bf16 v[80:83], a[156:159], v[16:19], v[80:83]
s_add_u32 s86, s86, 294912
ds_read_b64_tr_b16 a[144:145], v243 offset:42240
v_mfma_f32_16x16x32_bf16 v[84:87], a[156:159], v[20:23], v[84:87]
s_waitcnt lgkmcnt(7)
ds_read_b64_tr_b16 a[146:147], v243 offset:42496
v_mfma_f32_16x16x32_bf16 v[88:91], a[160:163], a[16:19], v[88:91]
s_add_u32 m0, s26, 147840
ds_read_b64_tr_b16 a[148:149], v243 offset:42272
ds_read_b64_tr_b16 a[150:151], v243 offset:42528
v_mfma_f32_16x16x32_bf16 v[92:95], a[160:163], a[20:23], v[92:95]
s_waitcnt lgkmcnt(8)
buffer_load_dwordx4 v241, s[60:63], s86 offen  lds
v_mfma_f32_16x16x32_bf16 v[96:99], a[164:167], a[16:19], v[96:99]
s_add_u32 s86, s86, 294912
s_or_b32 s50, s2, s20
s_cmp_lg_u32 s50, 0
s_cbranch_scc1 L3_nobump
s_mov_b32 s50, 44449792
buffer_store_dword v212, v4, s[8:11], s50 offen sc1
L3_nobump:
ds_read_b64_tr_b16 a[152:153], v13 offset:46464
v_mfma_f32_16x16x32_bf16 v[100:103], a[164:167], a[20:23], v[100:103]
s_waitcnt lgkmcnt(7)
ds_read_b64_tr_b16 a[154:155], v13 offset:46720
v_mfma_f32_16x16x32_bf16 v[104:107], a[168:171], a[16:19], v[104:107]
ds_read_b64_tr_b16 a[156:157], v13 offset:46496
v_mul_f32 v24, v24, |v24|
v_mul_f32 v25, v25, |v25|
v_mfma_f32_16x16x32_bf16 v[108:111], a[168:171], a[20:23], v[108:111]
s_waitcnt lgkmcnt(7)
ds_read_b64_tr_b16 a[158:159], v13 offset:46752
v_mul_f32 v26, v26, |v26|
v_mul_f32 v27, v27, |v27|
v_mfma_f32_16x16x32_bf16 v[112:115], a[172:175], a[16:19], v[112:115]
ds_read_b64_tr_b16 a[160:161], v13 offset:46528
v_mul_f32 v32, v32, |v32|
v_mul_f32 v33, v33, |v33|
v_mfma_f32_16x16x32_bf16 v[116:119], a[172:175], a[20:23], v[116:119]
s_waitcnt lgkmcnt(7)
ds_read_b64_tr_b16 a[162:163], v13 offset:46784
v_mul_f32 v34, v34, |v34|
v_mul_f32 v35, v35, |v35|
v_mfma_f32_16x16x32_bf16 v[120:123], a[144:147], a[16:19], v[120:123]
ds_read_b64_tr_b16 a[164:165], v13 offset:46560
v_cvt_pk_bf16_f32 v24, v24, v25
v_cvt_pk_bf16_f32 v25, v26, v27
v_mfma_f32_16x16x32_bf16 v[124:127], a[144:147], a[20:23], v[124:127]
s_waitcnt lgkmcnt(7)
ds_read_b64_tr_b16 a[166:167], v13 offset:46816
v_cvt_pk_bf16_f32 v26, v32, v33
v_cvt_pk_bf16_f32 v27, v34, v35
v_mfma_f32_16x16x32_bf16 v[128:131], a[148:151], a[16:19], v[128:131]
ds_read_b64_tr_b16 a[168:169], v243 offset:44352
v_pk_max_i16 v24, v24, 0
v_pk_max_i16 v25, v25, 0
v_mfma_f32_16x16x32_bf16 v[132:135], a[148:151], a[20:23], v[132:135]
s_waitcnt lgkmcnt(7)
ds_read_b64_tr_b16 a[170:171], v243 offset:44608
v_pk_max_i16 v26, v26, 0
v_pk_max_i16 v27, v27, 0
v_mfma_f32_16x16x32_bf16 v[88:91], a[152:155], a[24:27], v[88:91]
ds_read_b64_tr_b16 a[172:173], v243 offset:44384
v_mul_f32 v28, v28, |v28|
v_mul_f32 v29, v29, |v29|
v_mfma_f32_16x16x32_bf16 v[92:95], a[152:155], a[28:31], v[92:95]
s_waitcnt lgkmcnt(7)
ds_read_b64_tr_b16 a[174:175], v243 offset:44640
v_mul_f32 v30, v30, |v30|
v_mul_f32 v31, v31, |v31|
v_mfma_f32_16x16x32_bf16 v[96:99], a[156:159], a[24:27], v[96:99]
s_waitcnt vmcnt(24)
s_barrier
ds_read_b64_tr_b16 a[144:145], v13 offset:50688
v_mul_f32 v36, v36, |v36|
v_mul_f32 v37, v37, |v37|
v_mfma_f32_16x16x32_bf16 v[100:103], a[156:159], a[28:31], v[100:103]
s_waitcnt lgkmcnt(7)
ds_read_b64_tr_b16 a[146:147], v13 offset:50944
v_mul_f32 v38, v38, |v38|
v_mul_f32 v39, v39, |v39|
v_mfma_f32_16x16x32_bf16 v[104:107], a[160:163], a[24:27], v[104:107]
s_add_u32 m0, s26, 8448
ds_read_b64_tr_b16 a[148:149], v13 offset:50720
ds_read_b64_tr_b16 a[150:151], v13 offset:50976
v_mfma_f32_16x16x32_bf16 v[108:111], a[160:163], a[28:31], v[108:111]
s_waitcnt lgkmcnt(8)
buffer_load_dwordx4 v241, s[60:63], s86 offen  lds
v_mfma_f32_16x16x32_bf16 v[112:115], a[164:167], a[24:27], v[112:115]
s_add_u32 s86, s86, 294912
ds_read_b64_tr_b16 a[152:153], v13 offset:50752
v_cvt_pk_bf16_f32 v28, v28, v29
v_cvt_pk_bf16_f32 v29, v30, v31
v_mfma_f32_16x16x32_bf16 v[116:119], a[164:167], a[28:31], v[116:119]
s_waitcnt lgkmcnt(7)
ds_read_b64_tr_b16 a[154:155], v13 offset:51008
v_cvt_pk_bf16_f32 v30, v36, v37
v_cvt_pk_bf16_f32 v31, v38, v39
v_mfma_f32_16x16x32_bf16 v[120:123], a[168:171], a[24:27], v[120:123]
s_add_u32 m0, s26, 12672
ds_read_b64_tr_b16 a[156:157], v13 offset:50784
ds_read_b64_tr_b16 a[158:159], v13 offset:51040
v_mfma_f32_16x16x32_bf16 v[124:127], a[168:171], a[28:31], v[124:127]
s_waitcnt lgkmcnt(8)
buffer_load_dwordx4 v241, s[60:63], s86 offen  lds
v_mfma_f32_16x16x32_bf16 v[128:131], a[172:175], a[24:27], v[128:131]
s_add_u32 s86, s86, 294912
ds_read_b64_tr_b16 a[160:161], v243 offset:54912
v_pk_max_i16 v28, v28, 0
v_pk_max_i16 v29, v29, 0
v_mfma_f32_16x16x32_bf16 v[132:135], a[172:175], a[28:31], v[132:135]
s_waitcnt lgkmcnt(7)
ds_read_b64_tr_b16 a[162:163], v243 offset:55168
v_pk_max_i16 v30, v30, 0
v_pk_max_i16 v31, v31, 0
v_mfma_f32_16x16x32_bf16 v[88:91], a[144:147], a[32:35], v[88:91]
s_add_u32 s36, s28, 0
ds_read_b64_tr_b16 a[164:165], v243 offset:54944
ds_read_b64_tr_b16 a[166:167], v243 offset:55200
v_mfma_f32_16x16x32_bf16 v[92:95], a[144:147], a[36:39], v[92:95]
s_waitcnt lgkmcnt(8)
buffer_store_dwordx4 v[24:27], v1, s[8:11], s36 offen sc1
v_mfma_f32_16x16x32_bf16 v[96:99], a[148:151], a[32:35], v[96:99]
ds_read_b64_tr_b16 a[168:169], v13 offset:59136
v_mul_f32 v40, v40, |v40|
v_mul_f32 v41, v41, |v41|
v_mfma_f32_16x16x32_bf16 v[100:103], a[148:151], a[36:39], v[100:103]
s_waitcnt lgkmcnt(7)
ds_read_b64_tr_b16 a[170:171], v13 offset:59392
v_mul_f32 v42, v42, |v42|
v_mul_f32 v43, v43, |v43|
v_mfma_f32_16x16x32_bf16 v[104:107], a[152:155], a[32:35], v[104:107]
s_add_u32 m0, s26, 16896
ds_read_b64_tr_b16 a[172:173], v13 offset:59168
ds_read_b64_tr_b16 a[174:175], v13 offset:59424
v_mfma_f32_16x16x32_bf16 v[108:111], a[152:155], a[36:39], v[108:111]
s_waitcnt lgkmcnt(8)
buffer_load_dwordx4 v241, s[60:63], s86 offen  lds
v_mfma_f32_16x16x32_bf16 v[112:115], a[156:159], a[32:35], v[112:115]
s_add_u32 s86, s86, 294912
ds_read_b64_tr_b16 a[144:145], v13 offset:59200
v_mul_f32 v48, v48, |v48|
v_mul_f32 v49, v49, |v49|
v_mfma_f32_16x16x32_bf16 v[116:119], a[156:159], a[36:39], v[116:119]
s_waitcnt lgkmcnt(7)
ds_read_b64_tr_b16 a[146:147], v13 offset:59456
v_mul_f32 v50, v50, |v50|
v_mul_f32 v51, v51, |v51|
v_mfma_f32_16x16x32_bf16 v[120:123], a[160:163], a[32:35], v[120:123]
s_add_u32 m0, s26, 21120
ds_read_b64_tr_b16 a[148:149], v13 offset:59232
ds_read_b64_tr_b16 a[150:151], v13 offset:59488
v_mfma_f32_16x16x32_bf16 v[124:127], a[160:163], a[36:39], v[124:127]
s_waitcnt lgkmcnt(8)
buffer_load_dwordx4 v241, s[60:63], s86 offen  lds
v_mfma_f32_16x16x32_bf16 v[128:131], a[164:167], a[32:35], v[128:131]
s_add_u32 s86, s86, 294912
ds_read_b64_tr_b16 a[152:153], v243 offset:57024
v_cvt_pk_bf16_f32 v40, v40, v41
v_cvt_pk_bf16_f32 v41, v42, v43
v_mfma_f32_16x16x32_bf16 v[132:135], a[164:167], a[36:39], v[132:135]
PADW1:
PAD2:
s_cbranch_execz PAD3
s_waitcnt lgkmcnt(7)
ds_read_b64_tr_b16 a[154:155], v243 offset:57280
v_cvt_pk_bf16_f32 v42, v48, v49
v_cvt_pk_bf16_f32 v43, v50, v51
v_mfma_f32_16x16x32_bf16 v[88:91], a[168:171], a[40:43], v[88:91]
ds_read_b64_tr_b16 a[156:157], v243 offset:57056
v_pk_max_i16 v40, v40, 0
v_pk_max_i16 v41, v41, 0
v_mfma_f32_16x16x32_bf16 v[92:95], a[168:171], a[44:47], v[92:95]
s_waitcnt lgkmcnt(7)
ds_read_b64_tr_b16 a[158:159], v243 offset:57312
v_pk_max_i16 v42, v42, 0
v_pk_max_i16 v43, v43, 0
v_mfma_f32_16x16x32_bf16 v[96:99], a[172:175], a[40:43], v[96:99]
ds_read_b64_tr_b16 a[160:161], v13 offset:63360
v_mul_f32 v44, v44, |v44|
v_mul_f32 v45, v45, |v45|
v_mfma_f32_16x16x32_bf16 v[100:103], a[172:175], a[44:47], v[100:103]
s_waitcnt lgkmcnt(7)
ds_read_b64_tr_b16 a[162:163], v13 offset:63616
v_mul_f32 v46, v46, |v46|
v_mul_f32 v47, v47, |v47|
v_mfma_f32_16x16x32_bf16 v[104:107], a[144:147], a[40:43], v[104:107]
ds_read_b64_tr_b16 a[164:165], v13 offset:63392
v_mul_f32 v52, v52, |v52|
v_mul_f32 v53, v53, |v53|
v_mfma_f32_16x16x32_bf16 v[108:111], a[144:147], a[44:47], v[108:111]
s_waitcnt lgkmcnt(7)
ds_read_b64_tr_b16 a[166:167], v13 offset:63648
v_mul_f32 v54, v54, |v54|
v_mul_f32 v55, v55, |v55|
v_mfma_f32_16x16x32_bf16 v[112:115], a[148:151], a[40:43], v[112:115]
ds_read_b64_tr_b16 a[168:169], v13 offset:63424
v_cvt_pk_bf16_f32 v44, v44, v45
v_cvt_pk_bf16_f32 v45, v46, v47
v_mfma_f32_16x16x32_bf16 v[116:119], a[148:151], a[44:47], v[116:119]
s_waitcnt lgkmcnt(7)
ds_read_b64_tr_b16 a[170:171], v13 offset:63680
v_cvt_pk_bf16_f32 v46, v52, v53
v_cvt_pk_bf16_f32 v47, v54, v55
v_mfma_f32_16x16x32_bf16 v[120:123], a[152:155], a[40:43], v[120:123]
s_add_u32 s36, s28, 1024
ds_read_b64_tr_b16 a[172:173], v13 offset:63456
ds_read_b64_tr_b16 a[174:175], v13 offset:63712
v_mfma_f32_16x16x32_bf16 v[124:127], a[152:155], a[44:47], v[124:127]
s_waitcnt lgkmcnt(8)
buffer_store_dwordx4 v[28:31], v1, s[8:11], s36 offen sc1
v_mfma_f32_16x16x32_bf16 v[128:131], a[156:159], a[40:43], v[128:131]
s_waitcnt vmcnt(26)
s_barrier
v_add_u32 v243, 65536, v243
ds_read_b64_tr_b16 a[144:145], v243 offset:10496
v_pk_max_i16 v44, v44, 0
v_pk_max_i16 v45, v45, 0
v_mfma_f32_16x16x32_bf16 v[132:135], a[156:159], a[44:47], v[132:135]
s_waitcnt lgkmcnt(7)
ds_read_b64_tr_b16 a[146:147], v243 offset:10752
v_pk_max_i16 v46, v46, 0
v_pk_max_i16 v47, v47, 0
v_mfma_f32_16x16x32_bf16 v[88:91], a[160:163], a[48:51], v[88:91]
s_add_u32 m0, s26, 25344
ds_read_b64_tr_b16 a[148:149], v243 offset:10528
ds_read_b64_tr_b16 a[150:151], v243 offset:10784
v_mfma_f32_16x16x32_bf16 v[92:95], a[160:163], a[52:55], v[92:95]
s_waitcnt lgkmcnt(8)
buffer_load_dwordx4 v241, s[60:63], s86 offen  lds
v_mfma_f32_16x16x32_bf16 v[96:99], a[164:167], a[48:51], v[96:99]
s_add_u32 s86, s86, 294912
v_add_u32 v13, 65536, v13
ds_read_b64_tr_b16 a[152:153], v13 offset:14720
v_mul_f32 v56, v56, |v56|
v_mul_f32 v57, v57, |v57|
v_mfma_f32_16x16x32_bf16 v[100:103], a[164:167], a[52:55], v[100:103]
s_waitcnt lgkmcnt(7)
ds_read_b64_tr_b16 a[154:155], v13 offset:14976
v_mul_f32 v58, v58, |v58|
v_mul_f32 v59, v59, |v59|
v_mfma_f32_16x16x32_bf16 v[104:107], a[168:171], a[48:51], v[104:107]
s_add_u32 m0, s26, 29568
ds_read_b64_tr_b16 a[156:157], v13 offset:14752
ds_read_b64_tr_b16 a[158:159], v13 offset:15008
v_mfma_f32_16x16x32_bf16 v[108:111], a[168:171], a[52:55], v[108:111]
s_waitcnt lgkmcnt(8)
buffer_load_dwordx4 v241, s[60:63], s86 offen  lds
v_mfma_f32_16x16x32_bf16 v[112:115], a[172:175], a[48:51], v[112:115]
s_add_u32 s86, s86, 294912
ds_read_b64_tr_b16 a[160:161], v13 offset:14784
v_mul_f32 v64, v64, |v64|
v_mul_f32 v65, v65, |v65|
v_mfma_f32_16x16x32_bf16 v[116:119], a[172:175], a[52:55], v[116:119]
s_waitcnt lgkmcnt(7)
ds_read_b64_tr_b16 a[162:163], v13 offset:15040
v_mul_f32 v66, v66, |v66|
v_mul_f32 v67, v67, |v67|
v_mfma_f32_16x16x32_bf16 v[120:123], a[144:147], a[48:51], v[120:123]
s_add_u32 m0, s26, 42240
ds_read_b64_tr_b16 a[164:165], v13 offset:14816
ds_read_b64_tr_b16 a[166:167], v13 offset:15072
v_mfma_f32_16x16x32_bf16 v[124:127], a[144:147], a[52:55], v[124:127]
s_waitcnt lgkmcnt(8)
buffer_load_dwordx4 v241, s[60:63], s86 offen  lds
v_mfma_f32_16x16x32_bf16 v[128:131], a[148:151], a[48:51], v[128:131]
s_add_u32 s86, s86, 294912
ds_read_b64_tr_b16 a[168:169], v243 offset:12608
v_cvt_pk_bf16_f32 v56, v56, v57
v_cvt_pk_bf16_f32 v57, v58, v59
v_mfma_f32_16x16x32_bf16 v[132:135], a[148:151], a[52:55], v[132:135]
s_waitcnt lgkmcnt(7)
ds_read_b64_tr_b16 a[170:171], v243 offset:12864
v_cvt_pk_bf16_f32 v58, v64, v65
v_cvt_pk_bf16_f32 v59, v66, v67
v_mfma_f32_16x16x32_bf16 v[88:91], a[152:155], a[56:59], v[88:91]
s_add_u32 m0, s26, 46464
ds_read_b64_tr_b16 a[172:173], v243 offset:12640
ds_read_b64_tr_b16 a[174:175], v243 offset:12896
v_mfma_f32_16x16x32_bf16 v[92:95], a[152:155], a[60:63], v[92:95]
s_waitcnt lgkmcnt(8)
buffer_load_dwordx4 v241, s[60:63], s86 offen  lds
v_mfma_f32_16x16x32_bf16 v[96:99], a[156:159], a[56:59], v[96:99]
s_add_u32 s86, s86, 294912
ds_read_b64_tr_b16 a[144:145], v13 offset:18944
v_pk_max_i16 v56, v56, 0
v_pk_max_i16 v57, v57, 0
v_mfma_f32_16x16x32_bf16 v[100:103], a[156:159], a[60:63], v[100:103]
s_waitcnt lgkmcnt(7)
ds_read_b64_tr_b16 a[146:147], v13 offset:19200
v_pk_max_i16 v58, v58, 0
v_pk_max_i16 v59, v59, 0
v_mfma_f32_16x16x32_bf16 v[104:107], a[160:163], a[56:59], v[104:107]
s_add_u32 s36, s28, 2048
ds_read_b64_tr_b16 a[148:149], v13 offset:18976
ds_read_b64_tr_b16 a[150:151], v13 offset:19232
v_mfma_f32_16x16x32_bf16 v[108:111], a[160:163], a[60:63], v[108:111]
s_waitcnt lgkmcnt(8)
buffer_store_dwordx4 v[40:43], v1, s[8:11], s36 offen sc1
v_mfma_f32_16x16x32_bf16 v[112:115], a[164:167], a[56:59], v[112:115]
ds_read_b64_tr_b16 a[152:153], v13 offset:19008
v_mul_f32 v60, v60, |v60|
v_mul_f32 v61, v61, |v61|
v_mfma_f32_16x16x32_bf16 v[116:119], a[164:167], a[60:63], v[116:119]
s_waitcnt lgkmcnt(7)
ds_read_b64_tr_b16 a[154:155], v13 offset:19264
v_mul_f32 v62, v62, |v62|
v_mul_f32 v63, v63, |v63|
v_mfma_f32_16x16x32_bf16 v[120:123], a[168:171], a[56:59], v[120:123]
ds_read_b64_tr_b16 a[156:157], v13 offset:19040
v_mul_f32 v68, v68, |v68|
v_mul_f32 v69, v69, |v69|
v_mfma_f32_16x16x32_bf16 v[124:127], a[168:171], a[60:63], v[124:127]
s_waitcnt lgkmcnt(7)
ds_read_b64_tr_b16 a[158:159], v13 offset:19296
v_mul_f32 v70, v70, |v70|
v_mul_f32 v71, v71, |v71|
v_mfma_f32_16x16x32_bf16 v[128:131], a[172:175], a[56:59], v[128:131]
ds_read_b64_tr_b16 a[160:161], v243 offset:23168
v_cvt_pk_bf16_f32 v60, v60, v61
v_cvt_pk_bf16_f32 v61, v62, v63
v_mfma_f32_16x16x32_bf16 v[132:135], a[172:175], a[60:63], v[132:135]
s_waitcnt lgkmcnt(7)
ds_read_b64_tr_b16 a[162:163], v243 offset:23424
v_cvt_pk_bf16_f32 v62, v68, v69
v_cvt_pk_bf16_f32 v63, v70, v71
v_mfma_f32_16x16x32_bf16 v[88:91], a[144:147], a[64:67], v[88:91]
ds_read_b64_tr_b16 a[164:165], v243 offset:23200
v_pk_max_i16 v60, v60, 0
v_pk_max_i16 v61, v61, 0
v_mfma_f32_16x16x32_bf16 v[92:95], a[144:147], a[68:71], v[92:95]
s_waitcnt lgkmcnt(7)
ds_read_b64_tr_b16 a[166:167], v243 offset:23456
v_pk_max_i16 v62, v62, 0
v_pk_max_i16 v63, v63, 0
v_mfma_f32_16x16x32_bf16 v[96:99], a[148:151], a[64:67], v[96:99]
s_waitcnt vmcnt(27)
s_barrier
ds_read_b64_tr_b16 a[168:169], v13 offset:27392
v_mul_f32 v72, v72, |v72|
v_mul_f32 v73, v73, |v73|
v_mfma_f32_16x16x32_bf16 v[100:103], a[148:151], a[68:71], v[100:103]
s_waitcnt lgkmcnt(7)
ds_read_b64_tr_b16 a[170:171], v13 offset:27648
v_mul_f32 v74, v74, |v74|
v_mul_f32 v75, v75, |v75|
v_mfma_f32_16x16x32_bf16 v[104:107], a[152:155], a[64:67], v[104:107]
s_add_u32 m0, s26, 50688
ds_read_b64_tr_b16 a[172:173], v13 offset:27424
ds_read_b64_tr_b16 a[174:175], v13 offset:27680
v_mfma_f32_16x16x32_bf16 v[108:111], a[152:155], a[68:71], v[108:111]
s_waitcnt lgkmcnt(8)
buffer_load_dwordx4 v241, s[60:63], s86 offen  lds
v_mfma_f32_16x16x32_bf16 v[112:115], a[156:159], a[64:67], v[112:115]
s_add_u32 s86, s86, 294912
ds_read_b64_tr_b16 a[144:145], v13 offset:27456
v_mul_f32 v80, v80, |v80|
v_mul_f32 v81, v81, |v81|
v_mfma_f32_16x16x32_bf16 v[116:119], a[156:159], a[68:71], v[116:119]
s_waitcnt lgkmcnt(7)
ds_read_b64_tr_b16 a[146:147], v13 offset:27712
v_mul_f32 v82, v82, |v82|
v_mul_f32 v83, v83, |v83|
v_mfma_f32_16x16x32_bf16 v[120:123], a[160:163], a[64:67], v[120:123]
s_add_u32 m0, s26, 54912
ds_read_b64_tr_b16 a[148:149], v13 offset:27488
ds_read_b64_tr_b16 a[150:151], v13 offset:27744
v_mfma_f32_16x16x32_bf16 v[124:127], a[160:163], a[68:71], v[124:127]
s_waitcnt lgkmcnt(8)
buffer_load_dwordx4 v241, s[60:63], s86 offen  lds
v_mfma_f32_16x16x32_bf16 v[128:131], a[164:167], a[64:67], v[128:131]
s_add_u32 s86, s86, 294912
ds_read_b64_tr_b16 a[152:153], v243 offset:25280
v_cvt_pk_bf16_f32 v72, v72, v73
v_cvt_pk_bf16_f32 v73, v74, v75
v_mfma_f32_16x16x32_bf16 v[132:135], a[164:167], a[68:71], v[132:135]
s_waitcnt lgkmcnt(7)
ds_read_b64_tr_b16 a[154:155], v243 offset:25536
v_cvt_pk_bf16_f32 v74, v80, v81
v_cvt_pk_bf16_f32 v75, v82, v83
v_mfma_f32_16x16x32_bf16 v[88:91], a[168:171], a[72:75], v[88:91]
s_add_u32 s36, s28, 3072
ds_read_b64_tr_b16 a[156:157], v243 offset:25312
ds_read_b64_tr_b16 a[158:159], v243 offset:25568
v_mfma_f32_16x16x32_bf16 v[92:95], a[168:171], a[76:79], v[92:95]
s_waitcnt lgkmcnt(8)
buffer_store_dwordx4 v[44:47], v1, s[8:11], s36 offen sc1
v_mfma_f32_16x16x32_bf16 v[96:99], a[172:175], a[72:75], v[96:99]
ds_read_b64_tr_b16 a[160:161], v13 offset:31616
v_pk_max_i16 v72, v72, 0
v_pk_max_i16 v73, v73, 0
v_mfma_f32_16x16x32_bf16 v[100:103], a[172:175], a[76:79], v[100:103]
s_waitcnt lgkmcnt(7)
ds_read_b64_tr_b16 a[162:163], v13 offset:31872
v_pk_max_i16 v74, v74, 0
v_pk_max_i16 v75, v75, 0
v_mfma_f32_16x16x32_bf16 v[104:107], a[144:147], a[72:75], v[104:107]
s_add_u32 m0, s26, 59136
ds_read_b64_tr_b16 a[164:165], v13 offset:31648
ds_read_b64_tr_b16 a[166:167], v13 offset:31904
v_mfma_f32_16x16x32_bf16 v[108:111], a[144:147], a[76:79], v[108:111]
s_waitcnt lgkmcnt(8)
buffer_load_dwordx4 v241, s[60:63], s86 offen  lds
v_mfma_f32_16x16x32_bf16 v[112:115], a[148:151], a[72:75], v[112:115]
s_add_u32 s86, s86, 294912
ds_read_b64_tr_b16 a[168:169], v13 offset:31680
v_mul_f32 v76, v76, |v76|
v_mul_f32 v77, v77, |v77|
v_mfma_f32_16x16x32_bf16 v[116:119], a[148:151], a[76:79], v[116:119]
s_waitcnt lgkmcnt(7)
ds_read_b64_tr_b16 a[170:171], v13 offset:31936
v_mul_f32 v78, v78, |v78|
v_mul_f32 v79, v79, |v79|
v_mfma_f32_16x16x32_bf16 v[120:123], a[152:155], a[72:75], v[120:123]
s_add_u32 m0, s26, 63360
ds_read_b64_tr_b16 a[172:173], v13 offset:31712
ds_read_b64_tr_b16 a[174:175], v13 offset:31968
v_mfma_f32_16x16x32_bf16 v[124:127], a[152:155], a[76:79], v[124:127]
s_waitcnt lgkmcnt(8)
buffer_load_dwordx4 v241, s[60:63], s86 offen  lds
v_mfma_f32_16x16x32_bf16 v[128:131], a[156:159], a[72:75], v[128:131]
s_add_u32 s86, s86, 294912
ds_read_b64_tr_b16 a[144:145], v243 offset:44288
v_mul_f32 v84, v84, |v84|
v_mul_f32 v85, v85, |v85|
v_mfma_f32_16x16x32_bf16 v[132:135], a[156:159], a[76:79], v[132:135]
s_waitcnt lgkmcnt(7)
ds_read_b64_tr_b16 a[146:147], v243 offset:44544
v_mul_f32 v86, v86, |v86|
v_mul_f32 v87, v87, |v87|
v_mfma_f32_16x16x32_bf16 v[88:91], a[160:163], a[80:83], v[88:91]
ds_read_b64_tr_b16 a[148:149], v243 offset:44320
v_cvt_pk_bf16_f32 v76, v76, v77
v_cvt_pk_bf16_f32 v77, v78, v79
v_mfma_f32_16x16x32_bf16 v[92:95], a[160:163], a[84:87], v[92:95]
s_waitcnt lgkmcnt(7)
ds_read_b64_tr_b16 a[150:151], v243 offset:44576
v_cvt_pk_bf16_f32 v78, v84, v85
v_cvt_pk_bf16_f32 v79, v86, v87
v_mfma_f32_16x16x32_bf16 v[96:99], a[164:167], a[80:83], v[96:99]
ds_read_b64_tr_b16 a[152:153], v13 offset:48512
v_pk_max_i16 v76, v76, 0
v_pk_max_i16 v77, v77, 0
v_mfma_f32_16x16x32_bf16 v[100:103], a[164:167], a[84:87], v[100:103]
s_waitcnt lgkmcnt(7)
ds_read_b64_tr_b16 a[154:155], v13 offset:48768
v_pk_max_i16 v78, v78, 0
v_pk_max_i16 v79, v79, 0
v_mfma_f32_16x16x32_bf16 v[104:107], a[168:171], a[80:83], v[104:107]
ds_read_b64_tr_b16 a[156:157], v13 offset:48544
v_mfma_f32_16x16x32_bf16 v[108:111], a[168:171], a[84:87], v[108:111]
s_waitcnt lgkmcnt(7)
ds_read_b64_tr_b16 a[158:159], v13 offset:48800
v_mfma_f32_16x16x32_bf16 v[112:115], a[172:175], a[80:83], v[112:115]
ds_read_b64_tr_b16 a[160:161], v13 offset:48576
v_mfma_f32_16x16x32_bf16 v[116:119], a[172:175], a[84:87], v[116:119]
s_waitcnt lgkmcnt(7)
ds_read_b64_tr_b16 a[162:163], v13 offset:48832
v_mfma_f32_16x16x32_bf16 v[120:123], a[144:147], a[80:83], v[120:123]
s_add_u32 s36, s28, 4096
ds_read_b64_tr_b16 a[164:165], v13 offset:48608
ds_read_b64_tr_b16 a[166:167], v13 offset:48864
v_mfma_f32_16x16x32_bf16 v[124:127], a[144:147], a[84:87], v[124:127]
s_waitcnt lgkmcnt(8)
buffer_store_dwordx4 v[56:59], v1, s[8:11], s36 offen sc1
v_mfma_f32_16x16x32_bf16 v[128:131], a[148:151], a[80:83], v[128:131]
ds_read_b64_tr_b16 a[168:169], v243 offset:46400
v_mfma_f32_16x16x32_bf16 v[132:135], a[148:151], a[84:87], v[132:135]
s_waitcnt lgkmcnt(7)
ds_read_b64_tr_b16 a[170:171], v243 offset:46656
v_mfma_f32_16x16x32_bf16 v[88:91], a[152:155], a[88:91], v[88:91]
ds_read_b64_tr_b16 a[172:173], v243 offset:46432
v_mfma_f32_16x16x32_bf16 v[92:95], a[152:155], a[92:95], v[92:95]
s_waitcnt lgkmcnt(7)
ds_read_b64_tr_b16 a[174:175], v243 offset:46688
v_mfma_f32_16x16x32_bf16 v[96:99], a[156:159], a[88:91], v[96:99]
s_waitcnt vmcnt(29)
s_barrier
v_add_u32 v13, 4294901760, v13
ds_read_b64_tr_b16 a[144:145], v13 offset:0
v_mfma_f32_16x16x32_bf16 v[100:103], a[156:159], a[92:95], v[100:103]
s_waitcnt lgkmcnt(7)
ds_read_b64_tr_b16 a[146:147], v13 offset:256
v_mfma_f32_16x16x32_bf16 v[104:107], a[160:163], a[88:91], v[104:107]
s_add_u32 m0, s26, 76032
ds_read_b64_tr_b16 a[148:149], v13 offset:32
ds_read_b64_tr_b16 a[150:151], v13 offset:288
v_mfma_f32_16x16x32_bf16 v[108:111], a[160:163], a[92:95], v[108:111]
s_waitcnt lgkmcnt(8)
buffer_load_dwordx4 v241, s[60:63], s86 offen  lds
v_mfma_f32_16x16x32_bf16 v[112:115], a[164:167], a[88:91], v[112:115]
s_add_u32 s86, s86, 294912
ds_read_b64_tr_b16 a[152:153], v13 offset:64
v_mfma_f32_16x16x32_bf16 v[116:119], a[164:167], a[92:95], v[116:119]
s_waitcnt lgkmcnt(7)
ds_read_b64_tr_b16 a[154:155], v13 offset:320
v_mfma_f32_16x16x32_bf16 v[120:123], a[168:171], a[88:91], v[120:123]
s_add_u32 m0, s26, 80256
ds_read_b64_tr_b16 a[156:157], v13 offset:96
ds_read_b64_tr_b16 a[158:159], v13 offset:352
v_mfma_f32_16x16x32_bf16 v[124:127], a[168:171], a[92:95], v[124:127]
s_waitcnt lgkmcnt(8)
buffer_load_dwordx4 v241, s[60:63], s86 offen  lds
v_mfma_f32_16x16x32_bf16 v[128:131], a[172:175], a[88:91], v[128:131]
s_add_u32 s86, s86, 294912
v_add_u32 v243, 4294901760, v243
ds_read_b64_tr_b16 a[160:161], v243 offset:4224
v_mfma_f32_16x16x32_bf16 v[132:135], a[172:175], a[92:95], v[132:135]
s_waitcnt lgkmcnt(7)
ds_read_b64_tr_b16 a[162:163], v243 offset:4480
v_mfma_f32_16x16x32_bf16 v[88:91], a[144:147], a[96:99], v[88:91]
s_add_u32 m0, s26, 84480
ds_read_b64_tr_b16 a[164:165], v243 offset:4256
ds_read_b64_tr_b16 a[166:167], v243 offset:4512
v_mfma_f32_16x16x32_bf16 v[92:95], a[144:147], a[100:103], v[92:95]
s_waitcnt lgkmcnt(8)
buffer_load_dwordx4 v2, s[8:11], s25 offen sc1 lds
v_mfma_f32_16x16x32_bf16 v[96:99], a[148:151], a[96:99], v[96:99]
s_add_u32 s25, s25, 4096
ds_read_b64_tr_b16 a[168:169], v13 offset:33792
v_mfma_f32_16x16x32_bf16 v[100:103], a[148:151], a[100:103], v[100:103]
s_waitcnt lgkmcnt(7)
ds_read_b64_tr_b16 a[170:171], v13 offset:34048
v_mfma_f32_16x16x32_bf16 v[104:107], a[152:155], a[96:99], v[104:107]
s_add_u32 s36, s28, 5120
ds_read_b64_tr_b16 a[172:173], v13 offset:33824
ds_read_b64_tr_b16 a[174:175], v13 offset:34080
v_mfma_f32_16x16x32_bf16 v[108:111], a[152:155], a[100:103], v[108:111]
s_waitcnt lgkmcnt(8)
buffer_store_dwordx4 v[60:63], v1, s[8:11], s36 offen sc1
v_mfma_f32_16x16x32_bf16 v[112:115], a[156:159], a[96:99], v[112:115]
ds_read_b64_tr_b16 a[144:145], v13 offset:33856
v_mfma_f32_16x16x32_bf16 v[116:119], a[156:159], a[100:103], v[116:119]
s_waitcnt lgkmcnt(7)
ds_read_b64_tr_b16 a[146:147], v13 offset:34112
v_mfma_f32_16x16x32_bf16 v[120:123], a[160:163], a[96:99], v[120:123]
s_add_u32 m0, s26, 88704
ds_read_b64_tr_b16 a[148:149], v13 offset:33888
ds_read_b64_tr_b16 a[150:151], v13 offset:34144
v_mfma_f32_16x16x32_bf16 v[124:127], a[160:163], a[100:103], v[124:127]
s_waitcnt lgkmcnt(8)
buffer_load_dwordx4 v2, s[8:11], s25 offen sc1 lds
v_mfma_f32_16x16x32_bf16 v[128:131], a[164:167], a[96:99], v[128:131]
s_add_u32 s25, s25, 4096
ds_read_b64_tr_b16 a[152:153], v243 offset:6336
v_mfma_f32_16x16x32_bf16 v[132:135], a[164:167], a[100:103], v[132:135]
s_waitcnt lgkmcnt(7)
ds_read_b64_tr_b16 a[154:155], v243 offset:6592
v_mfma_f32_16x16x32_bf16 v[88:91], a[168:171], a[104:107], v[88:91]
ds_read_b64_tr_b16 a[156:157], v243 offset:6368
v_mfma_f32_16x16x32_bf16 v[92:95], a[168:171], a[108:111], v[92:95]
s_waitcnt lgkmcnt(7)
ds_read_b64_tr_b16 a[158:159], v243 offset:6624
v_mfma_f32_16x16x32_bf16 v[96:99], a[172:175], a[104:107], v[96:99]
ds_read_b64_tr_b16 a[160:161], v13 offset:38016
v_mfma_f32_16x16x32_bf16 v[100:103], a[172:175], a[108:111], v[100:103]
s_waitcnt lgkmcnt(7)
ds_read_b64_tr_b16 a[162:163], v13 offset:38272
v_mfma_f32_16x16x32_bf16 v[104:107], a[144:147], a[104:107], v[104:107]
ds_read_b64_tr_b16 a[164:165], v13 offset:38048
v_mfma_f32_16x16x32_bf16 v[108:111], a[144:147], a[108:111], v[108:111]
s_waitcnt lgkmcnt(7)
ds_read_b64_tr_b16 a[166:167], v13 offset:38304
v_mfma_f32_16x16x32_bf16 v[112:115], a[148:151], a[104:107], v[112:115]
ds_read_b64_tr_b16 a[168:169], v13 offset:38080
v_mfma_f32_16x16x32_bf16 v[116:119], a[148:151], a[108:111], v[116:119]
s_waitcnt lgkmcnt(7)
ds_read_b64_tr_b16 a[170:171], v13 offset:38336
v_mfma_f32_16x16x32_bf16 v[120:123], a[152:155], a[104:107], v[120:123]
ds_read_b64_tr_b16 a[172:173], v13 offset:38112
v_mfma_f32_16x16x32_bf16 v[124:127], a[152:155], a[108:111], v[124:127]
s_waitcnt lgkmcnt(7)
ds_read_b64_tr_b16 a[174:175], v13 offset:38368
v_mfma_f32_16x16x32_bf16 v[128:131], a[156:159], a[104:107], v[128:131]
s_waitcnt vmcnt(30)
s_barrier
v_add_u32 v243, 65536, v243
ds_read_b64_tr_b16 a[144:145], v243 offset:2048
v_mfma_f32_16x16x32_bf16 v[132:135], a[156:159], a[108:111], v[132:135]
s_waitcnt lgkmcnt(7)
ds_read_b64_tr_b16 a[146:147], v243 offset:2304
v_mfma_f32_16x16x32_bf16 v[88:91], a[160:163], a[112:115], v[88:91]
s_add_u32 s36, s28, 6144
ds_read_b64_tr_b16 a[148:149], v243 offset:2080
ds_read_b64_tr_b16 a[150:151], v243 offset:2336
v_mfma_f32_16x16x32_bf16 v[92:95], a[160:163], a[116:119], v[92:95]
s_waitcnt lgkmcnt(8)
buffer_store_dwordx4 v[72:75], v1, s[8:11], s36 offen sc1
v_mfma_f32_16x16x32_bf16 v[96:99], a[164:167], a[112:115], v[96:99]
v_add_u32 v13, 65536, v13
ds_read_b64_tr_b16 a[152:153], v13 offset:6272
v_mfma_f32_16x16x32_bf16 v[100:103], a[164:167], a[116:119], v[100:103]
s_waitcnt lgkmcnt(7)
ds_read_b64_tr_b16 a[154:155], v13 offset:6528
v_mfma_f32_16x16x32_bf16 v[104:107], a[168:171], a[112:115], v[104:107]
s_add_u32 m0, s26, 92928
ds_read_b64_tr_b16 a[156:157], v13 offset:6304
ds_read_b64_tr_b16 a[158:159], v13 offset:6560
v_mfma_f32_16x16x32_bf16 v[108:111], a[168:171], a[116:119], v[108:111]
s_waitcnt lgkmcnt(8)
buffer_load_dwordx4 v2, s[8:11], s25 offen sc1 lds
v_mfma_f32_16x16x32_bf16 v[112:115], a[172:175], a[112:115], v[112:115]
s_add_u32 s25, s25, 4096
ds_read_b64_tr_b16 a[160:161], v13 offset:6336
v_mfma_f32_16x16x32_bf16 v[116:119], a[172:175], a[116:119], v[116:119]
s_waitcnt lgkmcnt(7)
ds_read_b64_tr_b16 a[162:163], v13 offset:6592
v_mfma_f32_16x16x32_bf16 v[120:123], a[144:147], a[112:115], v[120:123]
s_add_u32 m0, s26, 97152
ds_read_b64_tr_b16 a[164:165], v13 offset:6368
ds_read_b64_tr_b16 a[166:167], v13 offset:6624
v_mfma_f32_16x16x32_bf16 v[124:127], a[144:147], a[116:119], v[124:127]
s_waitcnt lgkmcnt(8)
buffer_load_dwordx4 v2, s[8:11], s25 offen sc1 lds
v_mfma_f32_16x16x32_bf16 v[128:131], a[148:151], a[112:115], v[128:131]
s_add_u32 s25, s25, 4096
ds_read_b64_tr_b16 a[168:169], v243 offset:4160
v_mfma_f32_16x16x32_bf16 v[132:135], a[148:151], a[116:119], v[132:135]
s_waitcnt lgkmcnt(7)
ds_read_b64_tr_b16 a[170:171], v243 offset:4416
v_mfma_f32_16x16x32_bf16 v[88:91], a[152:155], a[120:123], v[88:91]
s_add_u32 m0, s26, 109824
ds_read_b64_tr_b16 a[172:173], v243 offset:4192
ds_read_b64_tr_b16 a[174:175], v243 offset:4448
v_mfma_f32_16x16x32_bf16 v[92:95], a[152:155], a[124:127], v[92:95]
s_waitcnt lgkmcnt(8)
buffer_load_dwordx4 v2, s[8:11], s25 offen sc1 lds
v_mfma_f32_16x16x32_bf16 v[96:99], a[156:159], a[120:123], v[96:99]
s_add_u32 s25, s25, 4096
ds_read_b64_tr_b16 a[144:145], v13 offset:35840
v_mfma_f32_16x16x32_bf16 v[100:103], a[156:159], a[124:127], v[100:103]
s_waitcnt lgkmcnt(7)
ds_read_b64_tr_b16 a[146:147], v13 offset:36096
v_mfma_f32_16x16x32_bf16 v[104:107], a[160:163], a[120:123], v[104:107]
s_add_u32 m0, s26, 114048
ds_read_b64_tr_b16 a[148:149], v13 offset:35872
ds_read_b64_tr_b16 a[150:151], v13 offset:36128
v_mfma_f32_16x16x32_bf16 v[108:111], a[160:163], a[124:127], v[108:111]
s_waitcnt lgkmcnt(8)
buffer_load_dwordx4 v2, s[8:11], s25 offen sc1 lds
v_mfma_f32_16x16x32_bf16 v[112:115], a[164:167], a[120:123], v[112:115]
s_add_u32 s25, s25, 4096
ds_read_b64_tr_b16 a[152:153], v13 offset:35904
v_mfma_f32_16x16x32_bf16 v[116:119], a[164:167], a[124:127], v[116:119]
s_waitcnt lgkmcnt(7)
ds_read_b64_tr_b16 a[154:155], v13 offset:36160
v_mfma_f32_16x16x32_bf16 v[120:123], a[168:171], a[120:123], v[120:123]
s_add_u32 s36, s28, 7168
ds_read_b64_tr_b16 a[156:157], v13 offset:35936
ds_read_b64_tr_b16 a[158:159], v13 offset:36192
v_mfma_f32_16x16x32_bf16 v[124:127], a[168:171], a[124:127], v[124:127]
s_waitcnt lgkmcnt(8)
buffer_store_dwordx4 v[76:79], v1, s[8:11], s36 offen sc1
v_mfma_f32_16x16x32_bf16 v[128:131], a[172:175], a[120:123], v[128:131]
ds_read_b64_tr_b16 a[160:161], v243 offset:40064
v_mfma_f32_16x16x32_bf16 v[132:135], a[172:175], a[124:127], v[132:135]
s_waitcnt lgkmcnt(7)
ds_read_b64_tr_b16 a[162:163], v243 offset:40320
v_mfma_f32_16x16x32_bf16 v[88:91], a[144:147], a[128:131], v[88:91]
ds_read_b64_tr_b16 a[164:165], v243 offset:40096
v_mfma_f32_16x16x32_bf16 v[92:95], a[144:147], a[132:135], v[92:95]
s_waitcnt lgkmcnt(7)
ds_read_b64_tr_b16 a[166:167], v243 offset:40352
v_mfma_f32_16x16x32_bf16 v[96:99], a[148:151], a[128:131], v[96:99]
s_waitcnt vmcnt(32)
s_barrier
ds_read_b64_tr_b16 a[168:169], v13 offset:52736
v_mfma_f32_16x16x32_bf16 v[100:103], a[148:151], a[132:135], v[100:103]
s_waitcnt lgkmcnt(7)
ds_read_b64_tr_b16 a[170:171], v13 offset:52992
v_mfma_f32_16x16x32_bf16 v[104:107], a[152:155], a[128:131], v[104:107]
s_add_u32 m0, s26, 0
ds_read_b64_tr_b16 a[172:173], v13 offset:52768
ds_read_b64_tr_b16 a[174:175], v13 offset:53024
v_mfma_f32_16x16x32_bf16 v[108:111], a[152:155], a[132:135], v[108:111]
s_waitcnt lgkmcnt(8)
buffer_load_dwordx4 v2, s[8:11], s25 offen sc1 lds
v_mfma_f32_16x16x32_bf16 v[112:115], a[156:159], a[128:131], v[112:115]
s_add_u32 s25, s25, 4096
ds_read_b64_tr_b16 a[144:145], v13 offset:52800
v_mfma_f32_16x16x32_bf16 v[116:119], a[156:159], a[132:135], v[116:119]
s_waitcnt lgkmcnt(7)
ds_read_b64_tr_b16 a[146:147], v13 offset:53056
v_mfma_f32_16x16x32_bf16 v[120:123], a[160:163], a[128:131], v[120:123]
s_add_u32 m0, s26, 4224
ds_read_b64_tr_b16 a[148:149], v13 offset:52832
ds_read_b64_tr_b16 a[150:151], v13 offset:53088
v_mfma_f32_16x16x32_bf16 v[124:127], a[160:163], a[132:135], v[124:127]
s_waitcnt lgkmcnt(8)
buffer_load_dwordx4 v2, s[8:11], s25 offen sc1 lds
v_mfma_f32_16x16x32_bf16 v[128:131], a[164:167], a[128:131], v[128:131]
s_add_u32 s25, s25, 4096
ds_read_b64_tr_b16 a[152:153], v243 offset:42176
v_mfma_f32_16x16x32_bf16 v[132:135], a[164:167], a[132:135], v[132:135]
s_waitcnt lgkmcnt(7)
ds_read_b64_tr_b16 a[154:155], v243 offset:42432
v_mfma_f32_16x16x32_bf16 v[88:91], a[168:171], a[136:139], v[88:91]
s_add_u32 m0, s26, 33792
ds_read_b64_tr_b16 a[156:157], v243 offset:42208
ds_read_b64_tr_b16 a[158:159], v243 offset:42464
v_mfma_f32_16x16x32_bf16 v[92:95], a[168:171], a[140:143], v[92:95]
s_waitcnt lgkmcnt(8)
buffer_load_dwordx4 v2, s[8:11], s25 offen sc1 lds
v_mfma_f32_16x16x32_bf16 v[96:99], a[172:175], a[136:139], v[96:99]
s_add_u32 s25, s25, 4096
v_add_u32 v11, 65536, v11
ds_read_b128 a[160:163], v11 offset:56960
v_mfma_f32_16x16x32_bf16 v[100:103], a[172:175], a[140:143], v[100:103]
s_waitcnt lgkmcnt(7)
v_mfma_f32_16x16x32_bf16 v[104:107], a[144:147], a[136:139], v[104:107]
s_add_u32 m0, s26, 38016
ds_read_b128 a[164:167], v11 offset:58016
v_mfma_f32_16x16x32_bf16 v[108:111], a[144:147], a[140:143], v[108:111]
s_waitcnt lgkmcnt(6)
buffer_load_dwordx4 v2, s[8:11], s25 offen sc1 lds
v_mfma_f32_16x16x32_bf16 v[112:115], a[148:151], a[136:139], v[112:115]
s_add_u32 s25, s25, 4096
ds_read_b128 a[168:171], v11 offset:59072
v_mfma_f32_16x16x32_bf16 v[116:119], a[148:151], a[140:143], v[116:119]
PAD3:
s_cbranch_execz PAD_ret
s_waitcnt lgkmcnt(5)
v_mfma_f32_16x16x32_bf16 v[120:123], a[152:155], a[136:139], v[120:123]
ds_read_b128 a[172:175], v11 offset:60128
v_mfma_f32_16x16x32_bf16 v[124:127], a[152:155], a[140:143], v[124:127]
s_waitcnt lgkmcnt(4)
v_mfma_f32_16x16x32_bf16 v[128:131], a[156:159], a[136:139], v[128:131]
ds_read_b128 a[144:147], v11 offset:61184
v_mfma_f32_16x16x32_bf16 v[132:135], a[156:159], a[140:143], v[132:135]
s_waitcnt lgkmcnt(4)
v_mfma_f32_16x16x32_bf16 v[88:91], a[160:163], v[16:19], v[88:91]
ds_read_b128 a[148:151], v11 offset:62240
v_mfma_f32_16x16x32_bf16 v[92:95], a[160:163], v[20:23], v[92:95]
s_waitcnt lgkmcnt(4)
v_mfma_f32_16x16x32_bf16 v[96:99], a[164:167], v[16:19], v[96:99]
ds_read_b128 a[152:155], v11 offset:63296
v_mfma_f32_16x16x32_bf16 v[100:103], a[164:167], v[20:23], v[100:103]
s_waitcnt lgkmcnt(4)
v_mfma_f32_16x16x32_bf16 v[104:107], a[168:171], v[16:19], v[104:107]
ds_read_b128 a[156:159], v11 offset:64352
v_mfma_f32_16x16x32_bf16 v[108:111], a[168:171], v[20:23], v[108:111]
s_waitcnt lgkmcnt(4)
v_mfma_f32_16x16x32_bf16 v[112:115], a[172:175], v[16:19], v[112:115]
ds_read_b128 a[160:163], v11 offset:65408
v_mfma_f32_16x16x32_bf16 v[116:119], a[172:175], v[20:23], v[116:119]
s_waitcnt lgkmcnt(4)
v_mfma_f32_16x16x32_bf16 v[120:123], a[144:147], v[16:19], v[120:123]
v_add_u32 v11, 65536, v11
ds_read_b128 a[164:167], v11 offset:928
v_mfma_f32_16x16x32_bf16 v[124:127], a[144:147], v[20:23], v[124:127]
s_waitcnt lgkmcnt(4)
v_mfma_f32_16x16x32_bf16 v[128:131], a[148:151], v[16:19], v[128:131]
s_waitcnt vmcnt(32)
s_barrier
v_add_u32 v13, 65536, v13
ds_read_b64_tr_b16 a[168:169], v13 offset:4096
v_mfma_f32_16x16x32_bf16 v[132:135], a[148:151], v[20:23], v[132:135]
s_waitcnt lgkmcnt(4)
ds_read_b64_tr_b16 a[170:171], v13 offset:4352
v_mfma_f32_16x16x32_bf16 v[136:139], a[152:155], v[16:19], 0
s_add_u32 m0, s26, 67584
ds_read_b64_tr_b16 a[172:173], v13 offset:4128
ds_read_b64_tr_b16 a[174:175], v13 offset:4384
v_mfma_f32_16x16x32_bf16 v[140:143], a[152:155], v[20:23], 0
s_waitcnt lgkmcnt(6)
buffer_load_dwordx4 v2, s[8:11], s25 offen sc1 lds
v_mfma_f32_16x16x32_bf16 v[144:147], a[156:159], v[16:19], 0
s_add_u32 s25, s25, 4096
ds_read_b64_tr_b16 a[144:145], v13 offset:4160
v_mfma_f32_16x16x32_bf16 v[148:151], a[156:159], v[20:23], 0
s_waitcnt lgkmcnt(6)
ds_read_b64_tr_b16 a[146:147], v13 offset:4416
v_mfma_f32_16x16x32_bf16 v[152:155], a[160:163], v[16:19], 0
s_add_u32 m0, s26, 71808
ds_read_b64_tr_b16 a[148:149], v13 offset:4192
ds_read_b64_tr_b16 a[150:151], v13 offset:4448
v_mfma_f32_16x16x32_bf16 v[156:159], a[160:163], v[20:23], 0
s_waitcnt lgkmcnt(8)
buffer_load_dwordx4 v2, s[8:11], s25 offen sc1 lds
v_mfma_f32_16x16x32_bf16 v[160:163], a[164:167], v[16:19], 0
s_add_u32 s25, s25, 4096
ds_read_b64_tr_b16 a[152:153], v13 offset:8320
v_mul_f32 v88, v88, |v88|
v_mul_f32 v89, v89, |v89|
v_mfma_f32_16x16x32_bf16 v[164:167], a[164:167], v[20:23], 0
s_waitcnt lgkmcnt(7)
ds_read_b64_tr_b16 a[154:155], v13 offset:8576
v_mul_f32 v90, v90, |v90|
v_mul_f32 v91, v91, |v91|
v_mfma_f32_16x16x32_bf16 v[136:139], a[168:171], a[0:3], v[136:139]
s_add_u32 m0, s26, 101376
ds_read_b64_tr_b16 a[156:157], v13 offset:8352
ds_read_b64_tr_b16 a[158:159], v13 offset:8608
v_mfma_f32_16x16x32_bf16 v[140:143], a[168:171], a[4:7], v[140:143]
s_waitcnt lgkmcnt(8)
buffer_load_dwordx4 v2, s[8:11], s25 offen sc1 lds
v_mfma_f32_16x16x32_bf16 v[144:147], a[172:175], a[0:3], v[144:147]
s_add_u32 s25, s25, 4096
ds_read_b64_tr_b16 a[160:161], v13 offset:8384
v_mul_f32 v96, v96, |v96|
v_mul_f32 v97, v97, |v97|
v_mfma_f32_16x16x32_bf16 v[148:151], a[172:175], a[4:7], v[148:151]
s_waitcnt lgkmcnt(7)
ds_read_b64_tr_b16 a[162:163], v13 offset:8640
v_mul_f32 v98, v98, |v98|
v_mul_f32 v99, v99, |v99|
v_mfma_f32_16x16x32_bf16 v[152:155], a[144:147], a[0:3], v[152:155]
s_add_u32 m0, s26, 105600
ds_read_b64_tr_b16 a[164:165], v13 offset:8416
ds_read_b64_tr_b16 a[166:167], v13 offset:8672
v_mfma_f32_16x16x32_bf16 v[156:159], a[144:147], a[4:7], v[156:159]
s_waitcnt lgkmcnt(8)
buffer_load_dwordx4 v2, s[8:11], s25 offen sc1 lds
v_mfma_f32_16x16x32_bf16 v[160:163], a[148:151], a[0:3], v[160:163]
s_add_u32 s25, s25, 4096
ds_read_b64_tr_b16 a[168:169], v13 offset:12544
v_cvt_pk_bf16_f32 v88, v88, v89
v_cvt_pk_bf16_f32 v89, v90, v91
v_mfma_f32_16x16x32_bf16 v[164:167], a[148:151], a[4:7], v[164:167]
s_waitcnt lgkmcnt(7)
ds_read_b64_tr_b16 a[170:171], v13 offset:12800
v_cvt_pk_bf16_f32 v90, v96, v97
v_cvt_pk_bf16_f32 v91, v98, v99
v_mfma_f32_16x16x32_bf16 v[136:139], a[152:155], a[8:11], v[136:139]
ds_read_b64_tr_b16 a[172:173], v13 offset:12576
v_pk_max_i16 v88, v88, 0
v_pk_max_i16 v89, v89, 0
v_mfma_f32_16x16x32_bf16 v[140:143], a[152:155], a[12:15], v[140:143]
s_waitcnt lgkmcnt(7)
ds_read_b64_tr_b16 a[174:175], v13 offset:12832
v_pk_max_i16 v90, v90, 0
v_pk_max_i16 v91, v91, 0
v_mfma_f32_16x16x32_bf16 v[144:147], a[156:159], a[8:11], v[144:147]
ds_read_b64_tr_b16 a[144:145], v13 offset:12608
v_mul_f32 v92, v92, |v92|
v_mul_f32 v93, v93, |v93|
v_mfma_f32_16x16x32_bf16 v[148:151], a[156:159], a[12:15], v[148:151]
s_waitcnt lgkmcnt(7)
ds_read_b64_tr_b16 a[146:147], v13 offset:12864
v_mul_f32 v94, v94, |v94|
v_mul_f32 v95, v95, |v95|
v_mfma_f32_16x16x32_bf16 v[152:155], a[160:163], a[8:11], v[152:155]
ds_read_b64_tr_b16 a[148:149], v13 offset:12640
v_mul_f32 v100, v100, |v100|
v_mul_f32 v101, v101, |v101|
v_mfma_f32_16x16x32_bf16 v[156:159], a[160:163], a[12:15], v[156:159]
s_waitcnt lgkmcnt(7)
s_waitcnt vmcnt(8)
v_mov_b32 v14, s4
buffer_store_dword v14, v4, s[8:11], s32 offen sc1
ds_read_b64_tr_b16 a[150:151], v13 offset:12896
v_mfma_f32_16x16x32_bf16 v[160:163], a[164:167], a[8:11], v[160:163]
ds_read_b64_tr_b16 a[152:153], v13 offset:16768
v_mul_f32 v102, v102, |v102|
v_mul_f32 v103, v103, |v103|
v_mfma_f32_16x16x32_bf16 v[164:167], a[164:167], a[12:15], v[164:167]
s_waitcnt lgkmcnt(7)
ds_read_b64_tr_b16 a[154:155], v13 offset:17024
v_cvt_pk_bf16_f32 v92, v92, v93
v_cvt_pk_bf16_f32 v93, v94, v95
v_mfma_f32_16x16x32_bf16 v[136:139], a[168:171], a[16:19], v[136:139]
s_add_u32 s36, s28, 8192
ds_read_b64_tr_b16 a[156:157], v13 offset:16800
ds_read_b64_tr_b16 a[158:159], v13 offset:17056
v_mfma_f32_16x16x32_bf16 v[140:143], a[168:171], a[20:23], v[140:143]
s_waitcnt lgkmcnt(8)
buffer_store_dwordx4 v[88:91], v1, s[8:11], s36 offen sc1
v_mfma_f32_16x16x32_bf16 v[144:147], a[172:175], a[16:19], v[144:147]
ds_read_b64_tr_b16 a[160:161], v13 offset:16832
v_cvt_pk_bf16_f32 v94, v100, v101
v_cvt_pk_bf16_f32 v95, v102, v103
v_mfma_f32_16x16x32_bf16 v[148:151], a[172:175], a[20:23], v[148:151]
s_waitcnt lgkmcnt(7)
ds_read_b64_tr_b16 a[162:163], v13 offset:17088
v_pk_max_i16 v92, v92, 0
v_pk_max_i16 v93, v93, 0
v_mfma_f32_16x16x32_bf16 v[152:155], a[144:147], a[16:19], v[152:155]
ds_read_b64_tr_b16 a[164:165], v13 offset:16864
v_pk_max_i16 v94, v94, 0
v_pk_max_i16 v95, v95, 0
v_mfma_f32_16x16x32_bf16 v[156:159], a[144:147], a[20:23], v[156:159]
s_waitcnt lgkmcnt(7)
ds_read_b64_tr_b16 a[166:167], v13 offset:17120
v_mul_f32 v104, v104, |v104|
v_mul_f32 v105, v105, |v105|
v_mfma_f32_16x16x32_bf16 v[160:163], a[148:151], a[16:19], v[160:163]
s_barrier
v_add_u32 v13, 4294836224, v13
ds_read_b64_tr_b16 a[168:169], v13 offset:8448
v_mul_f32 v106, v106, |v106|
v_mul_f32 v107, v107, |v107|
v_mfma_f32_16x16x32_bf16 v[164:167], a[148:151], a[20:23], v[164:167]
s_waitcnt lgkmcnt(7)
ds_read_b64_tr_b16 a[170:171], v13 offset:8704
v_mul_f32 v112, v112, |v112|
v_mul_f32 v113, v113, |v113|
v_mfma_f32_16x16x32_bf16 v[136:139], a[152:155], a[24:27], v[136:139]
s_add_u32 m0, s26, 118272
ds_read_b64_tr_b16 a[172:173], v13 offset:8480
ds_read_b64_tr_b16 a[174:175], v13 offset:8736
v_mfma_f32_16x16x32_bf16 v[140:143], a[152:155], a[28:31], v[140:143]
s_waitcnt lgkmcnt(8)
buffer_load_dwordx4 v2, s[8:11], s25 offen sc1 lds
v_mfma_f32_16x16x32_bf16 v[144:147], a[156:159], a[24:27], v[144:147]
s_add_u32 s25, s25, 4096
ds_read_b64_tr_b16 a[144:145], v13 offset:8512
v_mul_f32 v114, v114, |v114|
v_mul_f32 v115, v115, |v115|
v_mfma_f32_16x16x32_bf16 v[148:151], a[156:159], a[28:31], v[148:151]
s_waitcnt lgkmcnt(7)
ds_read_b64_tr_b16 a[146:147], v13 offset:8768
v_cvt_pk_bf16_f32 v104, v104, v105
v_cvt_pk_bf16_f32 v105, v106, v107
v_mfma_f32_16x16x32_bf16 v[152:155], a[160:163], a[24:27], v[152:155]
s_add_u32 m0, s26, 122496
ds_read_b64_tr_b16 a[148:149], v13 offset:8544
ds_read_b64_tr_b16 a[150:151], v13 offset:8800
v_mfma_f32_16x16x32_bf16 v[156:159], a[160:163], a[28:31], v[156:159]
s_waitcnt lgkmcnt(8)
buffer_load_dwordx4 v2, s[8:11], s25 offen sc1 lds
v_mfma_f32_16x16x32_bf16 v[160:163], a[164:167], a[24:27], v[160:163]
s_add_u32 s25, s25, 4096
ds_read_b64_tr_b16 a[152:153], v13 offset:12672
v_cvt_pk_bf16_f32 v106, v112, v113
v_cvt_pk_bf16_f32 v107, v114, v115
v_mfma_f32_16x16x32_bf16 v[164:167], a[164:167], a[28:31], v[164:167]
s_waitcnt lgkmcnt(7)
ds_read_b64_tr_b16 a[154:155], v13 offset:12928
v_pk_max_i16 v104, v104, 0
v_pk_max_i16 v105, v105, 0
v_mfma_f32_16x16x32_bf16 v[136:139], a[168:171], a[32:35], v[136:139]
s_add_u32 m0, s26, 126720
ds_read_b64_tr_b16 a[156:157], v13 offset:12704
ds_read_b64_tr_b16 a[158:159], v13 offset:12960
v_mfma_f32_16x16x32_bf16 v[140:143], a[168:171], a[36:39], v[140:143]
s_waitcnt lgkmcnt(8)
buffer_load_dwordx4 v2, s[8:11], s25 offen sc1 lds
v_mfma_f32_16x16x32_bf16 v[144:147], a[172:175], a[32:35], v[144:147]
s_add_u32 s25, s25, 4096
ds_read_b64_tr_b16 a[160:161], v13 offset:12736
v_pk_max_i16 v106, v106, 0
v_pk_max_i16 v107, v107, 0
v_mfma_f32_16x16x32_bf16 v[148:151], a[172:175], a[36:39], v[148:151]
s_waitcnt lgkmcnt(7)
ds_read_b64_tr_b16 a[162:163], v13 offset:12992
v_mul_f32 v108, v108, |v108|
v_mul_f32 v109, v109, |v109|
v_mfma_f32_16x16x32_bf16 v[152:155], a[144:147], a[32:35], v[152:155]
s_add_u32 s36, s28, 9216
ds_read_b64_tr_b16 a[164:165], v13 offset:12768
ds_read_b64_tr_b16 a[166:167], v13 offset:13024
v_mfma_f32_16x16x32_bf16 v[156:159], a[144:147], a[36:39], v[156:159]
s_waitcnt lgkmcnt(8)
buffer_store_dwordx4 v[92:95], v1, s[8:11], s36 offen sc1
v_mfma_f32_16x16x32_bf16 v[160:163], a[148:151], a[32:35], v[160:163]
ds_read_b64_tr_b16 a[168:169], v13 offset:16896
v_mul_f32 v110, v110, |v110|
v_mul_f32 v111, v111, |v111|
v_mfma_f32_16x16x32_bf16 v[164:167], a[148:151], a[36:39], v[164:167]
s_waitcnt lgkmcnt(7)
ds_read_b64_tr_b16 a[170:171], v13 offset:17152
v_mul_f32 v116, v116, |v116|
v_mul_f32 v117, v117, |v117|
v_mfma_f32_16x16x32_bf16 v[136:139], a[152:155], a[40:43], v[136:139]
s_add_u32 m0, s26, 130944
ds_read_b64_tr_b16 a[172:173], v13 offset:16928
ds_read_b64_tr_b16 a[174:175], v13 offset:17184
v_mfma_f32_16x16x32_bf16 v[140:143], a[152:155], a[44:47], v[140:143]
s_waitcnt lgkmcnt(8)
buffer_load_dwordx4 v2, s[8:11], s25 offen sc1 lds
v_mfma_f32_16x16x32_bf16 v[144:147], a[156:159], a[40:43], v[144:147]
s_add_u32 s25, s25, 4096
ds_read_b64_tr_b16 a[144:145], v13 offset:16960
v_mul_f32 v118, v118, |v118|
v_mul_f32 v119, v119, |v119|
v_mfma_f32_16x16x32_bf16 v[148:151], a[156:159], a[44:47], v[148:151]
s_waitcnt lgkmcnt(7)
ds_read_b64_tr_b16 a[146:147], v13 offset:17216
v_cvt_pk_bf16_f32 v108, v108, v109
v_cvt_pk_bf16_f32 v109, v110, v111
v_mfma_f32_16x16x32_bf16 v[152:155], a[160:163], a[40:43], v[152:155]
ds_read_b64_tr_b16 a[148:149], v13 offset:16992
v_cvt_pk_bf16_f32 v110, v116, v117
v_cvt_pk_bf16_f32 v111, v118, v119
v_mfma_f32_16x16x32_bf16 v[156:159], a[160:163], a[44:47], v[156:159]
s_waitcnt lgkmcnt(7)
ds_read_b64_tr_b16 a[150:151], v13 offset:17248
v_pk_max_i16 v108, v108, 0
v_pk_max_i16 v109, v109, 0
v_mfma_f32_16x16x32_bf16 v[160:163], a[164:167], a[40:43], v[160:163]
ds_read_b64_tr_b16 a[152:153], v13 offset:21120
v_pk_max_i16 v110, v110, 0
v_pk_max_i16 v111, v111, 0
v_mfma_f32_16x16x32_bf16 v[164:167], a[164:167], a[44:47], v[164:167]
s_waitcnt lgkmcnt(7)
ds_read_b64_tr_b16 a[154:155], v13 offset:21376
v_mul_f32 v120, v120, |v120|
v_mul_f32 v121, v121, |v121|
v_mfma_f32_16x16x32_bf16 v[136:139], a[168:171], a[48:51], v[136:139]
ds_read_b64_tr_b16 a[156:157], v13 offset:21152
v_mul_f32 v122, v122, |v122|
v_mul_f32 v123, v123, |v123|
v_mfma_f32_16x16x32_bf16 v[140:143], a[168:171], a[52:55], v[140:143]
s_waitcnt lgkmcnt(7)
ds_read_b64_tr_b16 a[158:159], v13 offset:21408
v_mul_f32 v128, v128, |v128|
v_mul_f32 v129, v129, |v129|
v_mfma_f32_16x16x32_bf16 v[144:147], a[172:175], a[48:51], v[144:147]
ds_read_b64_tr_b16 a[160:161], v13 offset:21184
v_mul_f32 v130, v130, |v130|
v_mul_f32 v131, v131, |v131|
v_mfma_f32_16x16x32_bf16 v[148:151], a[172:175], a[52:55], v[148:151]
s_waitcnt lgkmcnt(7)
ds_read_b64_tr_b16 a[162:163], v13 offset:21440
v_cvt_pk_bf16_f32 v120, v120, v121
v_cvt_pk_bf16_f32 v121, v122, v123
v_mfma_f32_16x16x32_bf16 v[152:155], a[144:147], a[48:51], v[152:155]
ds_read_b64_tr_b16 a[164:165], v13 offset:21216
v_cvt_pk_bf16_f32 v122, v128, v129
v_cvt_pk_bf16_f32 v123, v130, v131
v_mfma_f32_16x16x32_bf16 v[156:159], a[144:147], a[52:55], v[156:159]
s_waitcnt lgkmcnt(7)
ds_read_b64_tr_b16 a[166:167], v13 offset:21472
v_pk_max_i16 v120, v120, 0
v_pk_max_i16 v121, v121, 0
v_mfma_f32_16x16x32_bf16 v[160:163], a[148:151], a[48:51], v[160:163]
s_barrier
ds_read_b64_tr_b16 a[168:169], v13 offset:25344
v_pk_max_i16 v122, v122, 0
v_pk_max_i16 v123, v123, 0
v_mfma_f32_16x16x32_bf16 v[164:167], a[148:151], a[52:55], v[164:167]
s_waitcnt lgkmcnt(7)
ds_read_b64_tr_b16 a[170:171], v13 offset:25600
v_mul_f32 v124, v124, |v124|
v_mul_f32 v125, v125, |v125|
v_mfma_f32_16x16x32_bf16 v[136:139], a[152:155], a[56:59], v[136:139]
s_add_u32 s36, s28, 10240
ds_read_b64_tr_b16 a[172:173], v13 offset:25376
ds_read_b64_tr_b16 a[174:175], v13 offset:25632
v_mfma_f32_16x16x32_bf16 v[140:143], a[152:155], a[60:63], v[140:143]
s_waitcnt lgkmcnt(8)
buffer_store_dwordx4 v[104:107], v1, s[8:11], s36 offen sc1
v_mfma_f32_16x16x32_bf16 v[144:147], a[156:159], a[56:59], v[144:147]
buffer_load_dword v7, v5, s[8:11], s33 offen sc1
ds_read_b64_tr_b16 a[144:145], v13 offset:25408
v_mfma_f32_16x16x32_bf16 v[148:151], a[156:159], a[60:63], v[148:151]
s_waitcnt lgkmcnt(7)
ds_read_b64_tr_b16 a[146:147], v13 offset:25664
v_mul_f32 v126, v126, |v126|
v_mul_f32 v127, v127, |v127|
v_mfma_f32_16x16x32_bf16 v[152:155], a[160:163], a[56:59], v[152:155]
ds_read_b64_tr_b16 a[148:149], v13 offset:25440
v_mul_f32 v132, v132, |v132|
v_mul_f32 v133, v133, |v133|
v_mfma_f32_16x16x32_bf16 v[156:159], a[160:163], a[60:63], v[156:159]
s_waitcnt lgkmcnt(7)
ds_read_b64_tr_b16 a[150:151], v13 offset:25696
v_mul_f32 v134, v134, |v134|
v_mul_f32 v135, v135, |v135|
v_mfma_f32_16x16x32_bf16 v[160:163], a[164:167], a[56:59], v[160:163]
s_add_u32 m0, s26, 135168
ds_read_b64_tr_b16 a[152:153], v13 offset:29568
ds_read_b64_tr_b16 a[154:155], v13 offset:29824
v_mfma_f32_16x16x32_bf16 v[164:167], a[164:167], a[60:63], v[164:167]
s_waitcnt lgkmcnt(8)
buffer_load_dwordx4 v2, s[8:11], s25 offen sc1 lds
v_mfma_f32_16x16x32_bf16 v[136:139], a[168:171], a[64:67], v[136:139]
s_add_u32 s25, s25, 4096
ds_read_b64_tr_b16 a[156:157], v13 offset:29600
v_cvt_pk_bf16_f32 v124, v124, v125
v_cvt_pk_bf16_f32 v125, v126, v127
v_mfma_f32_16x16x32_bf16 v[140:143], a[168:171], a[68:71], v[140:143]
s_waitcnt lgkmcnt(7)
ds_read_b64_tr_b16 a[158:159], v13 offset:29856
v_cvt_pk_bf16_f32 v126, v132, v133
v_cvt_pk_bf16_f32 v127, v134, v135
v_mfma_f32_16x16x32_bf16 v[144:147], a[172:175], a[64:67], v[144:147]
s_add_u32 m0, s26, 139392
ds_read_b64_tr_b16 a[160:161], v13 offset:29632
ds_read_b64_tr_b16 a[162:163], v13 offset:29888
v_mfma_f32_16x16x32_bf16 v[148:151], a[172:175], a[68:71], v[148:151]
s_waitcnt lgkmcnt(8)
buffer_load_dwordx4 v2, s[8:11], s25 offen sc1 lds
v_mfma_f32_16x16x32_bf16 v[152:155], a[144:147], a[64:67], v[152:155]
s_add_u32 s25, s25, 4096
ds_read_b64_tr_b16 a[164:165], v13 offset:29664
v_pk_max_i16 v124, v124, 0
v_pk_max_i16 v125, v125, 0
v_mfma_f32_16x16x32_bf16 v[156:159], a[144:147], a[68:71], v[156:159]
s_waitcnt lgkmcnt(7)
ds_read_b64_tr_b16 a[166:167], v13 offset:29920
v_pk_max_i16 v126, v126, 0
v_pk_max_i16 v127, v127, 0
v_mfma_f32_16x16x32_bf16 v[160:163], a[148:151], a[64:67], v[160:163]
s_add_u32 m0, s26, 143616
ds_read_b64_tr_b16 a[168:169], v13 offset:42240
ds_read_b64_tr_b16 a[170:171], v13 offset:42496
v_mfma_f32_16x16x32_bf16 v[164:167], a[148:151], a[68:71], v[164:167]
s_waitcnt lgkmcnt(8)
buffer_load_dwordx4 v2, s[8:11], s25 offen sc1 lds
v_mfma_f32_16x16x32_bf16 v[136:139], a[152:155], a[72:75], v[136:139]
s_add_u32 s25, s25, 4096
ds_read_b64_tr_b16 a[172:173], v13 offset:42272
v_mfma_f32_16x16x32_bf16 v[140:143], a[152:155], a[76:79], v[140:143]
s_waitcnt lgkmcnt(7)
ds_read_b64_tr_b16 a[174:175], v13 offset:42528
v_mfma_f32_16x16x32_bf16 v[144:147], a[156:159], a[72:75], v[144:147]
s_add_u32 m0, s26, 147840
ds_read_b64_tr_b16 a[144:145], v13 offset:42304
ds_read_b64_tr_b16 a[146:147], v13 offset:42560
v_mfma_f32_16x16x32_bf16 v[148:151], a[156:159], a[76:79], v[148:151]
s_waitcnt lgkmcnt(8)
buffer_load_dwordx4 v2, s[8:11], s25 offen sc1 lds
v_mfma_f32_16x16x32_bf16 v[152:155], a[160:163], a[72:75], v[152:155]
s_add_u32 s25, s25, 4096
ds_read_b64_tr_b16 a[148:149], v13 offset:42336
v_mfma_f32_16x16x32_bf16 v[156:159], a[160:163], a[76:79], v[156:159]
s_waitcnt lgkmcnt(7)
ds_read_b64_tr_b16 a[150:151], v13 offset:42592
v_mfma_f32_16x16x32_bf16 v[160:163], a[164:167], a[72:75], v[160:163]
s_add_u32 s36, s28, 11264
ds_read_b64_tr_b16 a[152:153], v13 offset:46464
ds_read_b64_tr_b16 a[154:155], v13 offset:46720
v_mfma_f32_16x16x32_bf16 v[164:167], a[164:167], a[76:79], v[164:167]
s_waitcnt lgkmcnt(8)
buffer_store_dwordx4 v[108:111], v1, s[8:11], s36 offen sc1
v_mfma_f32_16x16x32_bf16 v[136:139], a[168:171], a[80:83], v[136:139]
ds_read_b64_tr_b16 a[156:157], v13 offset:46496
v_mfma_f32_16x16x32_bf16 v[140:143], a[168:171], a[84:87], v[140:143]
s_waitcnt lgkmcnt(7)
ds_read_b64_tr_b16 a[158:159], v13 offset:46752
v_mfma_f32_16x16x32_bf16 v[144:147], a[172:175], a[80:83], v[144:147]
ds_read_b64_tr_b16 a[160:161], v13 offset:46528
v_mfma_f32_16x16x32_bf16 v[148:151], a[172:175], a[84:87], v[148:151]
s_waitcnt lgkmcnt(7)
ds_read_b64_tr_b16 a[162:163], v13 offset:46784
v_mfma_f32_16x16x32_bf16 v[152:155], a[144:147], a[80:83], v[152:155]
ds_read_b64_tr_b16 a[164:165], v13 offset:46560
v_mfma_f32_16x16x32_bf16 v[156:159], a[144:147], a[84:87], v[156:159]
s_waitcnt lgkmcnt(7)
ds_read_b64_tr_b16 a[166:167], v13 offset:46816
v_mfma_f32_16x16x32_bf16 v[160:163], a[148:151], a[80:83], v[160:163]
s_barrier
ds_read_b64_tr_b16 a[168:169], v13 offset:50688
v_mfma_f32_16x16x32_bf16 v[164:167], a[148:151], a[84:87], v[164:167]
s_waitcnt lgkmcnt(7)
ds_read_b64_tr_b16 a[170:171], v13 offset:50944
v_mfma_f32_16x16x32_bf16 v[136:139], a[152:155], a[88:91], v[136:139]
s_add_u32 m0, s26, 8448
ds_read_b64_tr_b16 a[172:173], v13 offset:50720
ds_read_b64_tr_b16 a[174:175], v13 offset:50976
v_mfma_f32_16x16x32_bf16 v[140:143], a[152:155], a[92:95], v[140:143]
s_waitcnt lgkmcnt(8)
buffer_load_dwordx4 v2, s[8:11], s25 offen sc1 lds
v_mfma_f32_16x16x32_bf16 v[144:147], a[156:159], a[88:91], v[144:147]
s_add_u32 s25, s25, 4096
ds_read_b64_tr_b16 a[144:145], v13 offset:50752
v_mfma_f32_16x16x32_bf16 v[148:151], a[156:159], a[92:95], v[148:151]
s_waitcnt lgkmcnt(7)
ds_read_b64_tr_b16 a[146:147], v13 offset:51008
v_mfma_f32_16x16x32_bf16 v[152:155], a[160:163], a[88:91], v[152:155]
s_add_u32 m0, s26, 12672
ds_read_b64_tr_b16 a[148:149], v13 offset:50784
ds_read_b64_tr_b16 a[150:151], v13 offset:51040
v_mfma_f32_16x16x32_bf16 v[156:159], a[160:163], a[92:95], v[156:159]
s_waitcnt lgkmcnt(8)
buffer_load_dwordx4 v2, s[8:11], s25 offen sc1 lds
v_mfma_f32_16x16x32_bf16 v[160:163], a[164:167], a[88:91], v[160:163]
s_add_u32 s25, s25, 4096
ds_read_b64_tr_b16 a[152:153], v13 offset:54912
v_mfma_f32_16x16x32_bf16 v[164:167], a[164:167], a[92:95], v[164:167]
s_waitcnt lgkmcnt(7)
ds_read_b64_tr_b16 a[154:155], v13 offset:55168
v_mfma_f32_16x16x32_bf16 v[136:139], a[168:171], a[96:99], v[136:139]
s_add_u32 s36, s28, 12288
ds_read_b64_tr_b16 a[156:157], v13 offset:54944
ds_read_b64_tr_b16 a[158:159], v13 offset:55200
v_mfma_f32_16x16x32_bf16 v[140:143], a[168:171], a[100:103], v[140:143]
s_waitcnt lgkmcnt(8)
buffer_store_dwordx4 v[120:123], v1, s[8:11], s36 offen sc1
v_mfma_f32_16x16x32_bf16 v[144:147], a[172:175], a[96:99], v[144:147]
ds_read_b64_tr_b16 a[160:161], v13 offset:54976
v_mfma_f32_16x16x32_bf16 v[148:151], a[172:175], a[100:103], v[148:151]
s_waitcnt lgkmcnt(7)
ds_read_b64_tr_b16 a[162:163], v13 offset:55232
v_mfma_f32_16x16x32_bf16 v[152:155], a[144:147], a[96:99], v[152:155]
s_add_u32 m0, s26, 16896
ds_read_b64_tr_b16 a[164:165], v13 offset:55008
ds_read_b64_tr_b16 a[166:167], v13 offset:55264
v_mfma_f32_16x16x32_bf16 v[156:159], a[144:147], a[100:103], v[156:159]
s_waitcnt lgkmcnt(8)
buffer_load_dwordx4 v2, s[8:11], s25 offen sc1 lds
v_mfma_f32_16x16x32_bf16 v[160:163], a[148:151], a[96:99], v[160:163]
s_add_u32 s25, s25, 4096
ds_read_b64_tr_b16 a[168:169], v13 offset:59136
v_mfma_f32_16x16x32_bf16 v[164:167], a[148:151], a[100:103], v[164:167]
s_waitcnt lgkmcnt(7)
s_waitcnt vmcnt(9)
v_subrev_u32 v7, s4, v7
v_cmp_lt_u32 vcc, 3, v7
s_cbranch_vccnz L3_poll1
L3_poll1_ret:
ds_read_b64_tr_b16 a[170:171], v13 offset:59392
v_mfma_f32_16x16x32_bf16 v[136:139], a[152:155], a[104:107], v[136:139]
s_add_u32 s36, s29, 0
ds_read_b64_tr_b16 a[172:173], v13 offset:59168
ds_read_b64_tr_b16 a[174:175], v13 offset:59424
v_mfma_f32_16x16x32_bf16 v[140:143], a[152:155], a[108:111], v[140:143]
s_waitcnt lgkmcnt(8)
buffer_load_dwordx4 a[176:179], v1, s[8:11], s36 offen sc1
v_mfma_f32_16x16x32_bf16 v[144:147], a[156:159], a[104:107], v[144:147]
ds_read_b64_tr_b16 a[144:145], v13 offset:59200
v_mfma_f32_16x16x32_bf16 v[148:151], a[156:159], a[108:111], v[148:151]
s_waitcnt lgkmcnt(7)
ds_read_b64_tr_b16 a[146:147], v13 offset:59456
v_mfma_f32_16x16x32_bf16 v[152:155], a[160:163], a[104:107], v[152:155]
s_add_u32 s36, s29, 1024
ds_read_b64_tr_b16 a[148:149], v13 offset:59232
ds_read_b64_tr_b16 a[150:151], v13 offset:59488
v_mfma_f32_16x16x32_bf16 v[156:159], a[160:163], a[108:111], v[156:159]
s_waitcnt lgkmcnt(8)
buffer_load_dwordx4 a[180:183], v1, s[8:11], s36 offen sc1
v_mfma_f32_16x16x32_bf16 v[160:163], a[164:167], a[104:107], v[160:163]
ds_read_b64_tr_b16 a[152:153], v13 offset:63360
v_mfma_f32_16x16x32_bf16 v[164:167], a[164:167], a[108:111], v[164:167]
s_waitcnt lgkmcnt(7)
ds_read_b64_tr_b16 a[154:155], v13 offset:63616
v_mfma_f32_16x16x32_bf16 v[136:139], a[168:171], a[112:115], v[136:139]
s_add_u32 s36, s30, 0
ds_read_b64_tr_b16 a[156:157], v13 offset:63392
ds_read_b64_tr_b16 a[158:159], v13 offset:63648
v_mfma_f32_16x16x32_bf16 v[140:143], a[168:171], a[116:119], v[140:143]
s_waitcnt lgkmcnt(8)
buffer_load_dwordx4 a[184:187], v1, s[8:11], s36 offen sc1
v_mfma_f32_16x16x32_bf16 v[144:147], a[172:175], a[112:115], v[144:147]
ds_read_b64_tr_b16 a[160:161], v13 offset:63424
v_mfma_f32_16x16x32_bf16 v[148:151], a[172:175], a[116:119], v[148:151]
s_waitcnt lgkmcnt(7)
ds_read_b64_tr_b16 a[162:163], v13 offset:63680
v_mfma_f32_16x16x32_bf16 v[152:155], a[144:147], a[112:115], v[152:155]
s_add_u32 s36, s28, 13312
ds_read_b64_tr_b16 a[164:165], v13 offset:63456
ds_read_b64_tr_b16 a[166:167], v13 offset:63712
v_mfma_f32_16x16x32_bf16 v[156:159], a[144:147], a[116:119], v[156:159]
s_waitcnt lgkmcnt(8)
buffer_store_dwordx4 v[124:127], v1, s[8:11], s36 offen sc1
v_mfma_f32_16x16x32_bf16 v[160:163], a[148:151], a[112:115], v[160:163]
s_barrier
v_add_u32 v13, 65536, v13
ds_read_b64_tr_b16 a[168:169], v13 offset:10496
v_mfma_f32_16x16x32_bf16 v[164:167], a[148:151], a[116:119], v[164:167]
s_waitcnt lgkmcnt(7)
ds_read_b64_tr_b16 a[170:171], v13 offset:10752
v_mfma_f32_16x16x32_bf16 v[136:139], a[152:155], a[120:123], v[136:139]
s_add_u32 s36, s30, 1024
ds_read_b64_tr_b16 a[172:173], v13 offset:10528
ds_read_b64_tr_b16 a[174:175], v13 offset:10784
v_mfma_f32_16x16x32_bf16 v[140:143], a[152:155], a[124:127], v[140:143]
s_waitcnt lgkmcnt(8)
buffer_load_dwordx4 a[188:191], v1, s[8:11], s36 offen sc1
v_mfma_f32_16x16x32_bf16 v[144:147], a[156:159], a[120:123], v[144:147]
ds_read_b64_tr_b16 a[144:145], v13 offset:10560
v_mfma_f32_16x16x32_bf16 v[148:151], a[156:159], a[124:127], v[148:151]
s_waitcnt lgkmcnt(7)
ds_read_b64_tr_b16 a[146:147], v13 offset:10816
v_mfma_f32_16x16x32_bf16 v[152:155], a[160:163], a[120:123], v[152:155]
s_add_u32 s36, s31, 0
ds_read_b64_tr_b16 a[148:149], v13 offset:10592
ds_read_b64_tr_b16 a[150:151], v13 offset:10848
v_mfma_f32_16x16x32_bf16 v[156:159], a[160:163], a[124:127], v[156:159]
s_waitcnt lgkmcnt(8)
buffer_load_dwordx4 a[192:195], v1, s[8:11], s36 offen sc1
v_mfma_f32_16x16x32_bf16 v[160:163], a[164:167], a[120:123], v[160:163]
ds_read_b64_tr_b16 a[152:153], v13 offset:14720
v_mfma_f32_16x16x32_bf16 v[164:167], a[164:167], a[124:127], v[164:167]
s_waitcnt lgkmcnt(7)
ds_read_b64_tr_b16 a[154:155], v13 offset:14976
v_mfma_f32_16x16x32_bf16 v[136:139], a[168:171], a[128:131], v[136:139]
s_add_u32 s36, s31, 1024
ds_read_b64_tr_b16 a[156:157], v13 offset:14752
ds_read_b64_tr_b16 a[158:159], v13 offset:15008
v_mfma_f32_16x16x32_bf16 v[140:143], a[168:171], a[132:135], v[140:143]
PADW2:
PAD4:
s_cbranch_execz PAD5
s_waitcnt lgkmcnt(8)
buffer_load_dwordx4 a[196:199], v1, s[8:11], s36 offen sc1
v_mfma_f32_16x16x32_bf16 v[144:147], a[172:175], a[128:131], v[144:147]
ds_read_b64_tr_b16 a[160:161], v13 offset:14784
v_mfma_f32_16x16x32_bf16 v[148:151], a[172:175], a[132:135], v[148:151]
s_waitcnt lgkmcnt(7)
ds_read_b64_tr_b16 a[162:163], v13 offset:15040
v_mfma_f32_16x16x32_bf16 v[152:155], a[144:147], a[128:131], v[152:155]
s_add_u32 s36, s29, 2048
ds_read_b64_tr_b16 a[164:165], v13 offset:14816
ds_read_b64_tr_b16 a[166:167], v13 offset:15072
v_mfma_f32_16x16x32_bf16 v[156:159], a[144:147], a[132:135], v[156:159]
s_waitcnt lgkmcnt(8)
buffer_load_dwordx4 a[200:203], v1, s[8:11], s36 offen sc1
v_mfma_f32_16x16x32_bf16 v[160:163], a[148:151], a[128:131], v[160:163]
v_add_u32 v11, 4294901760, v11
ds_read_b128 a[168:171], v11 offset:18944
v_mfma_f32_16x16x32_bf16 v[164:167], a[148:151], a[132:135], v[164:167]
s_waitcnt lgkmcnt(7)
v_mfma_f32_16x16x32_bf16 v[136:139], a[152:155], a[136:139], v[136:139]
s_add_u32 s36, s29, 3072
ds_read_b128 a[172:175], v11 offset:20000
v_mfma_f32_16x16x32_bf16 v[140:143], a[152:155], a[140:143], v[140:143]
s_waitcnt lgkmcnt(6)
buffer_load_dwordx4 a[204:207], v1, s[8:11], s36 offen sc1
v_mfma_f32_16x16x32_bf16 v[144:147], a[156:159], a[136:139], v[144:147]
ds_read_b128 a[144:147], v11 offset:21056
v_mfma_f32_16x16x32_bf16 v[148:151], a[156:159], a[140:143], v[148:151]
s_waitcnt lgkmcnt(5)
v_mfma_f32_16x16x32_bf16 v[152:155], a[160:163], a[136:139], v[152:155]
s_add_u32 s36, s30, 2048
ds_read_b128 a[148:151], v11 offset:22112
v_mfma_f32_16x16x32_bf16 v[156:159], a[160:163], a[140:143], v[156:159]
s_waitcnt lgkmcnt(4)
buffer_load_dwordx4 a[208:211], v1, s[8:11], s36 offen sc1
v_mfma_f32_16x16x32_bf16 v[160:163], a[164:167], a[136:139], v[160:163]
ds_read_b128 a[152:155], v11 offset:23168
v_mfma_f32_16x16x32_bf16 v[164:167], a[164:167], a[140:143], v[164:167]
s_waitcnt lgkmcnt(4)
v_mfma_f32_16x16x32_bf16 v[168:171], a[168:171], v[24:27], 0
s_add_u32 s36, s30, 3072
ds_read_b128 a[156:159], v11 offset:24224
v_mfma_f32_16x16x32_bf16 v[172:175], a[168:171], v[28:31], 0
s_waitcnt lgkmcnt(4)
buffer_load_dwordx4 a[212:215], v1, s[8:11], s36 offen sc1
v_mfma_f32_16x16x32_bf16 v[176:179], a[172:175], v[24:27], 0
ds_read_b128 a[160:163], v11 offset:25280
v_mfma_f32_16x16x32_bf16 v[180:183], a[172:175], v[28:31], 0
s_waitcnt lgkmcnt(4)
v_mfma_f32_16x16x32_bf16 v[184:187], a[144:147], v[24:27], 0
s_add_u32 s36, s31, 2048
ds_read_b128 a[164:167], v11 offset:26336
v_mul_f32 v136, v136, |v136|
v_mfma_f32_16x16x32_bf16 v[188:191], a[144:147], v[28:31], 0
s_waitcnt lgkmcnt(4)
buffer_load_dwordx4 a[216:219], v1, s[8:11], s36 offen sc1
v_mfma_f32_16x16x32_bf16 v[192:195], a[148:151], v[24:27], 0
s_barrier
ds_read_b128 a[168:171], v11 offset:27392
v_mul_f32 v137, v137, |v137|
v_mfma_f32_16x16x32_bf16 v[196:199], a[148:151], v[28:31], 0
s_waitcnt lgkmcnt(4)
v_mul_f32 v138, v138, |v138|
v_mul_f32 v139, v139, |v139|
v_mfma_f32_16x16x32_bf16 v[200:203], a[152:155], v[24:27], 0
s_add_u32 s36, s31, 3072
ds_read_b128 a[172:175], v11 offset:28448
v_mul_f32 v144, v144, |v144|
v_mfma_f32_16x16x32_bf16 v[204:207], a[152:155], v[28:31], 0
s_waitcnt lgkmcnt(4)
buffer_load_dwordx4 a[220:223], v1, s[8:11], s36 offen sc1
v_mfma_f32_16x16x32_bf16 v[208:211], a[156:159], v[24:27], 0
ds_read_b128 a[144:147], v11 offset:29504
v_mul_f32 v145, v145, |v145|
v_mfma_f32_16x16x32_bf16 v[212:215], a[156:159], v[28:31], 0
s_waitcnt lgkmcnt(4)
v_mul_f32 v146, v146, |v146|
v_mul_f32 v147, v147, |v147|
v_mfma_f32_16x16x32_bf16 v[232:235], a[160:163], v[24:27], 0
s_add_u32 s36, s29, 4096
ds_read_b128 a[148:151], v11 offset:30560
v_cvt_pk_bf16_f32 v136, v136, v137
v_mfma_f32_16x16x32_bf16 v[236:239], a[160:163], v[28:31], 0
s_waitcnt lgkmcnt(4)
buffer_load_dwordx4 a[224:227], v1, s[8:11], s36 offen sc1
v_mfma_f32_16x16x32_bf16 v[168:171], a[164:167], v[40:43], v[168:171]
ds_read_b128 a[152:155], v11 offset:31616
v_cvt_pk_bf16_f32 v137, v138, v139
v_mfma_f32_16x16x32_bf16 v[172:175], a[164:167], v[44:47], v[172:175]
s_waitcnt lgkmcnt(4)
v_cvt_pk_bf16_f32 v138, v144, v145
v_cvt_pk_bf16_f32 v139, v146, v147
v_mfma_f32_16x16x32_bf16 v[176:179], a[168:171], v[40:43], v[176:179]
s_add_u32 s36, s29, 5120
ds_read_b128 a[156:159], v11 offset:32672
v_pk_max_i16 v136, v136, 0
v_mfma_f32_16x16x32_bf16 v[180:183], a[168:171], v[44:47], v[180:183]
s_waitcnt lgkmcnt(4)
buffer_load_dwordx4 a[228:231], v1, s[8:11], s36 offen sc1
v_mfma_f32_16x16x32_bf16 v[184:187], a[172:175], v[40:43], v[184:187]
ds_read_b128 a[160:163], v11 offset:33728
v_pk_max_i16 v137, v137, 0
v_mfma_f32_16x16x32_bf16 v[188:191], a[172:175], v[44:47], v[188:191]
s_waitcnt lgkmcnt(4)
v_pk_max_i16 v138, v138, 0
v_pk_max_i16 v139, v139, 0
v_mfma_f32_16x16x32_bf16 v[192:195], a[144:147], v[40:43], v[192:195]
s_add_u32 m0, s26, 21120
ds_read_b128 a[164:167], v11 offset:34784
v_mul_f32 v140, v140, |v140|
v_mfma_f32_16x16x32_bf16 v[196:199], a[144:147], v[44:47], v[196:199]
s_waitcnt lgkmcnt(4)
buffer_load_dwordx4 v2, s[8:11], s25 offen sc1 lds
v_mfma_f32_16x16x32_bf16 v[200:203], a[148:151], v[40:43], v[200:203]
s_add_u32 s25, s25, 4096
ds_read_b128 a[168:171], v11 offset:44288
v_mul_f32 v141, v141, |v141|
v_mfma_f32_16x16x32_bf16 v[204:207], a[148:151], v[44:47], v[204:207]
s_waitcnt lgkmcnt(4)
v_mul_f32 v142, v142, |v142|
v_mul_f32 v143, v143, |v143|
v_mfma_f32_16x16x32_bf16 v[208:211], a[152:155], v[40:43], v[208:211]
s_add_u32 s36, s28, 14336
ds_read_b128 a[172:175], v11 offset:45344
v_mul_f32 v148, v148, |v148|
v_mfma_f32_16x16x32_bf16 v[212:215], a[152:155], v[44:47], v[212:215]
s_waitcnt lgkmcnt(4)
buffer_store_dwordx4 v[136:139], v1, s[8:11], s36 offen sc1
v_mfma_f32_16x16x32_bf16 v[232:235], a[156:159], v[40:43], v[232:235]
ds_read_b128 a[144:147], v11 offset:46400
v_mul_f32 v149, v149, |v149|
v_mfma_f32_16x16x32_bf16 v[236:239], a[156:159], v[44:47], v[236:239]
s_waitcnt lgkmcnt(4)
v_mul_f32 v150, v150, |v150|
v_mul_f32 v151, v151, |v151|
v_mfma_f32_16x16x32_bf16 v[168:171], a[160:163], v[56:59], v[168:171]
s_add_u32 s36, s30, 4096
ds_read_b128 a[148:151], v11 offset:47456
v_cvt_pk_bf16_f32 v140, v140, v141
v_mfma_f32_16x16x32_bf16 v[172:175], a[160:163], v[60:63], v[172:175]
s_waitcnt lgkmcnt(4)
buffer_load_dwordx4 a[232:235], v1, s[8:11], s36 offen sc1
v_mfma_f32_16x16x32_bf16 v[176:179], a[164:167], v[56:59], v[176:179]
ds_read_b128 a[152:155], v11 offset:48512
v_cvt_pk_bf16_f32 v141, v142, v143
v_mfma_f32_16x16x32_bf16 v[180:183], a[164:167], v[60:63], v[180:183]
s_waitcnt lgkmcnt(4)
v_cvt_pk_bf16_f32 v142, v148, v149
v_cvt_pk_bf16_f32 v143, v150, v151
v_mfma_f32_16x16x32_bf16 v[184:187], a[168:171], v[56:59], v[184:187]
s_add_u32 s36, s30, 5120
ds_read_b128 a[156:159], v11 offset:49568
v_pk_max_i16 v140, v140, 0
v_mfma_f32_16x16x32_bf16 v[188:191], a[168:171], v[60:63], v[188:191]
s_waitcnt lgkmcnt(4)
s_waitcnt vmcnt(14)
v_mov_b32 v14, s5
buffer_store_dword v14, v4, s[8:11], s32 offen sc1
buffer_load_dwordx4 a[236:239], v1, s[8:11], s36 offen sc1
v_mfma_f32_16x16x32_bf16 v[192:195], a[172:175], v[56:59], v[192:195]
ds_read_b128 a[160:163], v11 offset:50624
v_pk_max_i16 v141, v141, 0
v_mfma_f32_16x16x32_bf16 v[196:199], a[172:175], v[60:63], v[196:199]
s_waitcnt lgkmcnt(4)
v_pk_max_i16 v142, v142, 0
v_pk_max_i16 v143, v143, 0
v_mfma_f32_16x16x32_bf16 v[200:203], a[144:147], v[56:59], v[200:203]
s_add_u32 s36, s31, 4096
ds_read_b128 a[164:167], v11 offset:51680
v_mul_f32 v152, v152, |v152|
v_mfma_f32_16x16x32_bf16 v[204:207], a[144:147], v[60:63], v[204:207]
s_waitcnt lgkmcnt(4)
buffer_load_dwordx4 a[240:243], v1, s[8:11], s36 offen sc1
v_mfma_f32_16x16x32_bf16 v[208:211], a[148:151], v[56:59], v[208:211]
s_barrier
v_add_u32 v11, 4294901760, v11
ds_read_b128 a[168:171], v11 offset:0
v_mul_f32 v153, v153, |v153|
v_mfma_f32_16x16x32_bf16 v[212:215], a[148:151], v[60:63], v[212:215]
s_waitcnt lgkmcnt(4)
v_mul_f32 v154, v154, |v154|
v_mul_f32 v155, v155, |v155|
v_mfma_f32_16x16x32_bf16 v[232:235], a[152:155], v[56:59], v[232:235]
s_add_u32 s36, s31, 5120
ds_read_b128 a[172:175], v11 offset:1056
v_mul_f32 v160, v160, |v160|
v_mfma_f32_16x16x32_bf16 v[236:239], a[152:155], v[60:63], v[236:239]
s_waitcnt lgkmcnt(4)
buffer_load_dwordx4 a[244:247], v1, s[8:11], s36 offen sc1
v_mfma_f32_16x16x32_bf16 v[168:171], a[156:159], v[72:75], v[168:171]
ds_read_b128 a[144:147], v11 offset:2112
v_mul_f32 v161, v161, |v161|
v_mfma_f32_16x16x32_bf16 v[172:175], a[156:159], v[76:79], v[172:175]
s_waitcnt lgkmcnt(4)
v_mul_f32 v162, v162, |v162|
v_mul_f32 v163, v163, |v163|
v_mfma_f32_16x16x32_bf16 v[176:179], a[160:163], v[72:75], v[176:179]
s_add_u32 s36, s28, 15360
ds_read_b128 a[148:151], v11 offset:3168
v_cvt_pk_bf16_f32 v152, v152, v153
v_mfma_f32_16x16x32_bf16 v[180:183], a[160:163], v[76:79], v[180:183]
s_waitcnt lgkmcnt(4)
buffer_store_dwordx4 v[140:143], v1, s[8:11], s36 offen sc1
v_mfma_f32_16x16x32_bf16 v[184:187], a[164:167], v[72:75], v[184:187]
ds_read_b128 a[152:155], v11 offset:4224
v_cvt_pk_bf16_f32 v153, v154, v155
v_mfma_f32_16x16x32_bf16 v[188:191], a[164:167], v[76:79], v[188:191]
s_waitcnt lgkmcnt(4)
v_cvt_pk_bf16_f32 v154, v160, v161
v_cvt_pk_bf16_f32 v155, v162, v163
v_mfma_f32_16x16x32_bf16 v[192:195], a[168:171], v[72:75], v[192:195]
s_add_u32 m0, s26, 25344
ds_read_b128 a[156:159], v11 offset:5280
v_pk_max_i16 v152, v152, 0
v_mfma_f32_16x16x32_bf16 v[196:199], a[168:171], v[76:79], v[196:199]
s_waitcnt lgkmcnt(4)
buffer_load_dwordx4 v2, s[8:11], s25 offen sc1 lds
v_mfma_f32_16x16x32_bf16 v[200:203], a[172:175], v[72:75], v[200:203]
s_add_u32 s25, s25, 4096
ds_read_b128 a[160:163], v11 offset:6336
v_pk_max_i16 v153, v153, 0
v_mfma_f32_16x16x32_bf16 v[204:207], a[172:175], v[76:79], v[204:207]
s_waitcnt lgkmcnt(4)
v_pk_max_i16 v154, v154, 0
v_pk_max_i16 v155, v155, 0
v_mfma_f32_16x16x32_bf16 v[208:211], a[144:147], v[72:75], v[208:211]
s_add_u32 m0, s26, 29568
ds_read_b128 a[164:167], v11 offset:7392
v_mul_f32 v156, v156, |v156|
v_mfma_f32_16x16x32_bf16 v[212:215], a[144:147], v[76:79], v[212:215]
s_waitcnt lgkmcnt(4)
buffer_load_dwordx4 v2, s[8:11], s25 offen sc1 lds
v_mfma_f32_16x16x32_bf16 v[232:235], a[148:151], v[72:75], v[232:235]
s_add_u32 s25, s25, 4096
ds_read_b128 a[168:171], v11 offset:33792
v_mul_f32 v157, v157, |v157|
v_mfma_f32_16x16x32_bf16 v[236:239], a[148:151], v[76:79], v[236:239]
s_waitcnt lgkmcnt(4)
v_mul_f32 v158, v158, |v158|
v_mul_f32 v159, v159, |v159|
v_mfma_f32_16x16x32_bf16 v[168:171], a[152:155], v[88:91], v[168:171]
s_add_u32 m0, s26, 42240
ds_read_b128 a[172:175], v11 offset:34848
v_mul_f32 v164, v164, |v164|
v_mfma_f32_16x16x32_bf16 v[172:175], a[152:155], v[92:95], v[172:175]
s_waitcnt lgkmcnt(4)
buffer_load_dwordx4 v2, s[8:11], s25 offen sc1 lds
v_mfma_f32_16x16x32_bf16 v[176:179], a[156:159], v[88:91], v[176:179]
s_add_u32 s25, s25, 4096
ds_read_b128 a[144:147], v11 offset:35904
v_mul_f32 v165, v165, |v165|
v_mfma_f32_16x16x32_bf16 v[180:183], a[156:159], v[92:95], v[180:183]
s_waitcnt lgkmcnt(4)
v_mul_f32 v166, v166, |v166|
v_mul_f32 v167, v167, |v167|
v_mfma_f32_16x16x32_bf16 v[184:187], a[160:163], v[88:91], v[184:187]
s_add_u32 m0, s26, 46464
ds_read_b128 a[148:151], v11 offset:36960
v_cvt_pk_bf16_f32 v156, v156, v157
v_mfma_f32_16x16x32_bf16 v[188:191], a[160:163], v[92:95], v[188:191]
s_waitcnt lgkmcnt(4)
buffer_load_dwordx4 v2, s[8:11], s25 offen sc1 lds
v_mfma_f32_16x16x32_bf16 v[192:195], a[164:167], v[88:91], v[192:195]
s_add_u32 s25, s25, 4096
ds_read_b128 a[152:155], v11 offset:38016
v_cvt_pk_bf16_f32 v157, v158, v159
v_mfma_f32_16x16x32_bf16 v[196:199], a[164:167], v[92:95], v[196:199]
s_waitcnt lgkmcnt(4)
v_cvt_pk_bf16_f32 v158, v164, v165
v_cvt_pk_bf16_f32 v159, v166, v167
v_mfma_f32_16x16x32_bf16 v[200:203], a[168:171], v[88:91], v[200:203]
s_add_u32 s36, s28, 16384
ds_read_b128 a[156:159], v11 offset:39072
v_pk_max_i16 v156, v156, 0
v_mfma_f32_16x16x32_bf16 v[204:207], a[168:171], v[92:95], v[204:207]
s_waitcnt lgkmcnt(4)
buffer_store_dwordx4 v[152:155], v1, s[8:11], s36 offen sc1
v_mfma_f32_16x16x32_bf16 v[208:211], a[172:175], v[88:91], v[208:211]
ds_read_b128 a[160:163], v11 offset:40128
v_pk_max_i16 v157, v157, 0
v_mfma_f32_16x16x32_bf16 v[212:215], a[172:175], v[92:95], v[212:215]
s_waitcnt lgkmcnt(4)
v_pk_max_i16 v158, v158, 0
v_pk_max_i16 v159, v159, 0
v_mfma_f32_16x16x32_bf16 v[232:235], a[144:147], v[88:91], v[232:235]
s_add_u32 s36, s29, 6144
ds_read_b128 a[164:167], v11 offset:41184
v_mfma_f32_16x16x32_bf16 v[236:239], a[144:147], v[92:95], v[236:239]
s_waitcnt lgkmcnt(4)
buffer_load_dwordx4 a[248:251], v1, s[8:11], s36 offen sc1
v_mfma_f32_16x16x32_bf16 v[168:171], a[148:151], v[104:107], v[168:171]
s_barrier
v_add_u32 v11, 65536, v11
ds_read_b128 a[168:171], v11 offset:2048
v_mfma_f32_16x16x32_bf16 v[172:175], a[148:151], v[108:111], v[172:175]
s_waitcnt lgkmcnt(4)
v_mfma_f32_16x16x32_bf16 v[176:179], a[152:155], v[104:107], v[176:179]
s_add_u32 s36, s29, 7168
ds_read_b128 a[172:175], v11 offset:3104
v_mfma_f32_16x16x32_bf16 v[180:183], a[152:155], v[108:111], v[180:183]
s_waitcnt lgkmcnt(4)
buffer_load_dwordx4 a[252:255], v1, s[8:11], s36 offen sc1
v_mfma_f32_16x16x32_bf16 v[184:187], a[156:159], v[104:107], v[184:187]
ds_read_b128 a[144:147], v11 offset:4160
v_mfma_f32_16x16x32_bf16 v[188:191], a[156:159], v[108:111], v[188:191]
s_waitcnt lgkmcnt(4)
v_mfma_f32_16x16x32_bf16 v[192:195], a[160:163], v[104:107], v[192:195]
s_add_u32 s36, s30, 6144
ds_read_b128 a[148:151], v11 offset:5216
v_mfma_f32_16x16x32_bf16 v[196:199], a[160:163], v[108:111], v[196:199]
s_waitcnt lgkmcnt(4)
buffer_load_dwordx4 a[0:3], v1, s[8:11], s36 offen sc1
v_mfma_f32_16x16x32_bf16 v[200:203], a[164:167], v[104:107], v[200:203]
buffer_load_dword v7, v5, s[8:11], s33 offen sc1
ds_read_b128 a[152:155], v11 offset:6272
v_mfma_f32_16x16x32_bf16 v[204:207], a[164:167], v[108:111], v[204:207]
s_waitcnt lgkmcnt(4)
v_mfma_f32_16x16x32_bf16 v[208:211], a[168:171], v[104:107], v[208:211]
ds_read_b128 a[156:159], v11 offset:7328
v_mfma_f32_16x16x32_bf16 v[212:215], a[168:171], v[108:111], v[212:215]
s_waitcnt lgkmcnt(4)
v_mfma_f32_16x16x32_bf16 v[232:235], a[172:175], v[104:107], v[232:235]
s_add_u32 s36, s30, 7168
ds_read_b128 a[160:163], v11 offset:8384
v_mfma_f32_16x16x32_bf16 v[236:239], a[172:175], v[108:111], v[236:239]
s_waitcnt lgkmcnt(4)
buffer_load_dwordx4 a[4:7], v1, s[8:11], s36 offen sc1
v_mfma_f32_16x16x32_bf16 v[168:171], a[144:147], v[120:123], v[168:171]
ds_read_b128 a[164:167], v11 offset:9440
v_mfma_f32_16x16x32_bf16 v[172:175], a[144:147], v[124:127], v[172:175]
s_waitcnt lgkmcnt(4)
v_mfma_f32_16x16x32_bf16 v[176:179], a[148:151], v[120:123], v[176:179]
s_add_u32 s36, s28, 17408
ds_read_b128 a[168:171], v11 offset:35840
v_mfma_f32_16x16x32_bf16 v[180:183], a[148:151], v[124:127], v[180:183]
s_waitcnt lgkmcnt(4)
buffer_store_dwordx4 v[156:159], v1, s[8:11], s36 offen sc1
v_mfma_f32_16x16x32_bf16 v[184:187], a[152:155], v[120:123], v[184:187]
ds_read_b128 a[172:175], v11 offset:36896
v_mfma_f32_16x16x32_bf16 v[188:191], a[152:155], v[124:127], v[188:191]
s_waitcnt lgkmcnt(4)
v_mfma_f32_16x16x32_bf16 v[192:195], a[156:159], v[120:123], v[192:195]
s_add_u32 m0, s26, 50688
ds_read_b128 a[144:147], v11 offset:37952
v_mfma_f32_16x16x32_bf16 v[196:199], a[156:159], v[124:127], v[196:199]
s_waitcnt lgkmcnt(4)
buffer_load_dwordx4 v2, s[8:11], s25 offen sc1 lds
v_mfma_f32_16x16x32_bf16 v[200:203], a[160:163], v[120:123], v[200:203]
s_add_u32 s25, s25, 4096
ds_read_b128 a[148:151], v11 offset:39008
v_mfma_f32_16x16x32_bf16 v[204:207], a[160:163], v[124:127], v[204:207]
s_waitcnt lgkmcnt(4)
v_mfma_f32_16x16x32_bf16 v[208:211], a[164:167], v[120:123], v[208:211]
s_add_u32 m0, s26, 54912
ds_read_b128 a[152:155], v11 offset:40064
v_mfma_f32_16x16x32_bf16 v[212:215], a[164:167], v[124:127], v[212:215]
s_waitcnt lgkmcnt(4)
buffer_load_dwordx4 v2, s[8:11], s25 offen sc1 lds
v_mfma_f32_16x16x32_bf16 v[232:235], a[168:171], v[120:123], v[232:235]
s_add_u32 s25, s25, 4096
ds_read_b128 a[156:159], v11 offset:41120
v_mfma_f32_16x16x32_bf16 v[236:239], a[168:171], v[124:127], v[236:239]
s_waitcnt lgkmcnt(4)
v_mfma_f32_16x16x32_bf16 v[168:171], a[172:175], v[136:139], v[168:171]
s_add_u32 m0, s26, 59136
ds_read_b128 a[160:163], v11 offset:42176
v_mfma_f32_16x16x32_bf16 v[172:175], a[172:175], v[140:143], v[172:175]
s_waitcnt lgkmcnt(4)
buffer_load_dwordx4 v2, s[8:11], s25 offen sc1 lds
v_mfma_f32_16x16x32_bf16 v[176:179], a[144:147], v[136:139], v[176:179]
s_add_u32 s25, s25, 4096
ds_read_b128 a[164:167], v11 offset:43232
v_mfma_f32_16x16x32_bf16 v[180:183], a[144:147], v[140:143], v[180:183]
s_waitcnt lgkmcnt(4)
v_mfma_f32_16x16x32_bf16 v[184:187], a[148:151], v[136:139], v[184:187]
s_add_u32 m0, s26, 63360
s_barrier
ds_read_b128 a[168:171], v11 offset:52736
v_mfma_f32_16x16x32_bf16 v[188:191], a[148:151], v[140:143], v[188:191]
s_waitcnt lgkmcnt(4)
buffer_load_dwordx4 v2, s[8:11], s25 offen sc1 lds
v_mfma_f32_16x16x32_bf16 v[192:195], a[152:155], v[136:139], v[192:195]
s_add_u32 s25, s25, 4096
ds_read_b128 a[172:175], v11 offset:53792
v_mfma_f32_16x16x32_bf16 v[196:199], a[152:155], v[140:143], v[196:199]
s_waitcnt lgkmcnt(4)
v_mfma_f32_16x16x32_bf16 v[200:203], a[156:159], v[136:139], v[200:203]
s_add_u32 s36, s31, 6144
ds_read_b128 a[144:147], v11 offset:54848
v_mfma_f32_16x16x32_bf16 v[204:207], a[156:159], v[140:143], v[204:207]
s_waitcnt lgkmcnt(4)
buffer_load_dwordx4 a[8:11], v1, s[8:11], s36 offen sc1
v_mfma_f32_16x16x32_bf16 v[208:211], a[160:163], v[136:139], v[208:211]
ds_read_b128 a[148:151], v11 offset:55904
v_mfma_f32_16x16x32_bf16 v[212:215], a[160:163], v[140:143], v[212:215]
s_waitcnt lgkmcnt(4)
v_mfma_f32_16x16x32_bf16 v[232:235], a[164:167], v[136:139], v[232:235]
s_add_u32 s36, s31, 7168
ds_read_b128 a[152:155], v11 offset:56960
v_mfma_f32_16x16x32_bf16 v[236:239], a[164:167], v[140:143], v[236:239]
s_waitcnt lgkmcnt(4)
buffer_load_dwordx4 a[12:15], v1, s[8:11], s36 offen sc1
v_mfma_f32_16x16x32_bf16 v[168:171], a[168:171], v[152:155], v[168:171]
ds_read_b128 a[156:159], v11 offset:58016
v_mfma_f32_16x16x32_bf16 v[172:175], a[168:171], v[156:159], v[172:175]
s_waitcnt lgkmcnt(4)
v_mfma_f32_16x16x32_bf16 v[176:179], a[172:175], v[152:155], v[176:179]
s_add_u32 m0, s26, 76032
ds_read_b128 a[160:163], v11 offset:59072
v_mfma_f32_16x16x32_bf16 v[180:183], a[172:175], v[156:159], v[180:183]
s_waitcnt lgkmcnt(4)
buffer_load_dwordx4 v2, s[8:11], s25 offen sc1 lds
v_mfma_f32_16x16x32_bf16 v[184:187], a[144:147], v[152:155], v[184:187]
s_add_u32 s25, s25, 4096
ds_read_b128 a[164:167], v11 offset:60128
v_mfma_f32_16x16x32_bf16 v[188:191], a[144:147], v[156:159], v[188:191]
s_waitcnt lgkmcnt(4)
v_mfma_f32_16x16x32_bf16 v[192:195], a[148:151], v[152:155], v[192:195]
s_add_u32 m0, s26, 80256
ds_read_b128 a[168:171], v11 offset:61184
v_mfma_f32_16x16x32_bf16 v[196:199], a[148:151], v[156:159], v[196:199]
s_waitcnt lgkmcnt(4)
buffer_load_dwordx4 v2, s[8:11], s25 offen sc1 lds
v_mfma_f32_16x16x32_bf16 v[200:203], a[152:155], v[152:155], v[200:203]
s_add_u32 s25, s25, 4096
ds_read_b128 a[172:175], v11 offset:62240
v_mfma_f32_16x16x32_bf16 v[204:207], a[152:155], v[156:159], v[204:207]
s_waitcnt lgkmcnt(4)
v_mfma_f32_16x16x32_bf16 v[208:211], a[156:159], v[152:155], v[208:211]
s_add_u32 m0, s26, 84480
ds_read_b128 a[144:147], v11 offset:63296
v_mfma_f32_16x16x32_bf16 v[212:215], a[156:159], v[156:159], v[212:215]
s_waitcnt lgkmcnt(4)
s_waitcnt vmcnt(10)
v_subrev_u32 v7, s5, v7
v_cmp_lt_u32 vcc, 2, v7
s_cbranch_vccnz L3_poll2
L3_poll2_ret:
buffer_load_dwordx4 v2, s[8:11], s25 offen sc1 lds
v_mfma_f32_16x16x32_bf16 v[232:235], a[160:163], v[152:155], v[232:235]
s_add_u32 s25, s25, 4096
ds_read_b128 a[148:151], v11 offset:64352
v_mfma_f32_16x16x32_bf16 v[236:239], a[160:163], v[156:159], v[236:239]
s_waitcnt lgkmcnt(4)
v_mfma_f32_16x16x32_bf16 v[168:171], a[164:167], a[176:179], v[168:171]
s_add_u32 s36, s29, 8192
ds_read_b128 a[152:155], v11 offset:65408
v_mfma_f32_16x16x32_bf16 v[172:175], a[164:167], a[180:183], v[172:175]
s_waitcnt lgkmcnt(4)
buffer_load_dwordx4 a[16:19], v1, s[8:11], s36 offen sc1
v_mfma_f32_16x16x32_bf16 v[176:179], a[168:171], a[176:179], v[176:179]
v_add_u32 v11, 65536, v11
ds_read_b128 a[156:159], v11 offset:928
v_mfma_f32_16x16x32_bf16 v[180:183], a[168:171], a[180:183], v[180:183]
s_waitcnt lgkmcnt(4)
v_mfma_f32_16x16x32_bf16 v[184:187], a[172:175], a[176:179], v[184:187]
s_add_u32 s36, s29, 9216
ds_read_b128 a[160:163], v11 offset:1984
v_mfma_f32_16x16x32_bf16 v[188:191], a[172:175], a[180:183], v[188:191]
s_waitcnt lgkmcnt(4)
buffer_load_dwordx4 a[20:23], v1, s[8:11], s36 offen sc1
v_mfma_f32_16x16x32_bf16 v[192:195], a[144:147], a[176:179], v[192:195]
ds_read_b128 a[164:167], v11 offset:3040
v_mfma_f32_16x16x32_bf16 v[196:199], a[144:147], a[180:183], v[196:199]
s_waitcnt lgkmcnt(4)
v_mfma_f32_16x16x32_bf16 v[200:203], a[148:151], a[176:179], v[200:203]
s_add_u32 s36, s30, 8192
s_barrier
ds_read_b128 a[168:171], v11 offset:4096
v_mfma_f32_16x16x32_bf16 v[204:207], a[148:151], a[180:183], v[204:207]
s_waitcnt lgkmcnt(4)
buffer_load_dwordx4 a[24:27], v1, s[8:11], s36 offen sc1
v_mfma_f32_16x16x32_bf16 v[208:211], a[152:155], a[176:179], v[208:211]
ds_read_b128 a[172:175], v11 offset:5152
v_mfma_f32_16x16x32_bf16 v[212:215], a[152:155], a[180:183], v[212:215]
s_waitcnt lgkmcnt(4)
v_mfma_f32_16x16x32_bf16 v[232:235], a[156:159], a[176:179], v[232:235]
s_add_u32 s36, s30, 9216
ds_read_b128 a[144:147], v11 offset:6208
v_mfma_f32_16x16x32_bf16 v[236:239], a[156:159], a[180:183], v[236:239]
s_waitcnt lgkmcnt(4)
buffer_load_dwordx4 a[28:31], v1, s[8:11], s36 offen sc1
v_mfma_f32_16x16x32_bf16 v[168:171], a[160:163], a[184:187], v[168:171]
ds_read_b128 a[148:151], v11 offset:7264
v_mfma_f32_16x16x32_bf16 v[172:175], a[160:163], a[188:191], v[172:175]
s_waitcnt lgkmcnt(4)
v_mfma_f32_16x16x32_bf16 v[176:179], a[164:167], a[184:187], v[176:179]
s_add_u32 s36, s31, 8192
ds_read_b128 a[152:155], v11 offset:8320
v_mfma_f32_16x16x32_bf16 v[180:183], a[164:167], a[188:191], v[180:183]
s_waitcnt lgkmcnt(4)
buffer_load_dwordx4 a[32:35], v1, s[8:11], s36 offen sc1
v_mfma_f32_16x16x32_bf16 v[184:187], a[168:171], a[184:187], v[184:187]
ds_read_b128 a[156:159], v11 offset:9376
v_mfma_f32_16x16x32_bf16 v[188:191], a[168:171], a[188:191], v[188:191]
s_waitcnt lgkmcnt(4)
s_waitcnt vmcnt(14)
v_mov_b32 v14, s6
buffer_store_dword v14, v4, s[8:11], s32 offen sc1
v_mfma_f32_16x16x32_bf16 v[192:195], a[172:175], a[184:187], v[192:195]
ds_read_b128 a[160:163], v11 offset:10432
v_mfma_f32_16x16x32_bf16 v[196:199], a[172:175], a[188:191], v[196:199]
s_waitcnt lgkmcnt(4)
v_mfma_f32_16x16x32_bf16 v[200:203], a[144:147], a[184:187], v[200:203]
s_add_u32 s36, s31, 9216
ds_read_b128 a[164:167], v11 offset:11488
v_mfma_f32_16x16x32_bf16 v[204:207], a[144:147], a[188:191], v[204:207]
s_waitcnt lgkmcnt(4)
buffer_load_dwordx4 a[36:39], v1, s[8:11], s36 offen sc1
v_mfma_f32_16x16x32_bf16 v[208:211], a[148:151], a[184:187], v[208:211]
ds_read_b128 a[168:171], v11 offset:12544
v_mfma_f32_16x16x32_bf16 v[212:215], a[148:151], a[188:191], v[212:215]
s_waitcnt lgkmcnt(4)
v_mfma_f32_16x16x32_bf16 v[232:235], a[152:155], a[184:187], v[232:235]
s_add_u32 s36, s29, 10240
ds_read_b128 a[172:175], v11 offset:13600
v_mfma_f32_16x16x32_bf16 v[236:239], a[152:155], a[188:191], v[236:239]
s_waitcnt lgkmcnt(4)
buffer_load_dwordx4 a[40:43], v1, s[8:11], s36 offen sc1
v_mfma_f32_16x16x32_bf16 v[168:171], a[156:159], a[192:195], v[168:171]
ds_read_b128 a[144:147], v11 offset:14656
v_mfma_f32_16x16x32_bf16 v[172:175], a[156:159], a[196:199], v[172:175]
s_waitcnt lgkmcnt(4)
v_mfma_f32_16x16x32_bf16 v[176:179], a[160:163], a[192:195], v[176:179]
s_add_u32 s36, s29, 11264
ds_read_b128 a[148:151], v11 offset:15712
v_mfma_f32_16x16x32_bf16 v[180:183], a[160:163], a[196:199], v[180:183]
s_waitcnt lgkmcnt(4)
buffer_load_dwordx4 a[44:47], v1, s[8:11], s36 offen sc1
v_mfma_f32_16x16x32_bf16 v[184:187], a[164:167], a[192:195], v[184:187]
ds_read_b128 a[152:155], v11 offset:16768
v_mfma_f32_16x16x32_bf16 v[188:191], a[164:167], a[196:199], v[188:191]
s_waitcnt lgkmcnt(4)
v_mfma_f32_16x16x32_bf16 v[192:195], a[168:171], a[192:195], v[192:195]
s_add_u32 s36, s30, 10240
ds_read_b128 a[156:159], v11 offset:17824
v_mfma_f32_16x16x32_bf16 v[196:199], a[168:171], a[196:199], v[196:199]
s_waitcnt lgkmcnt(4)
buffer_load_dwordx4 a[48:51], v1, s[8:11], s36 offen sc1
v_mfma_f32_16x16x32_bf16 v[200:203], a[172:175], a[192:195], v[200:203]
ds_read_b128 a[160:163], v11 offset:18880
v_mfma_f32_16x16x32_bf16 v[204:207], a[172:175], a[196:199], v[204:207]
s_waitcnt lgkmcnt(4)
v_mfma_f32_16x16x32_bf16 v[208:211], a[144:147], a[192:195], v[208:211]
s_add_u32 s36, s30, 11264
ds_read_b128 a[164:167], v11 offset:19936
v_mfma_f32_16x16x32_bf16 v[212:215], a[144:147], a[196:199], v[212:215]
s_waitcnt lgkmcnt(4)
buffer_load_dwordx4 a[52:55], v1, s[8:11], s36 offen sc1
v_mfma_f32_16x16x32_bf16 v[232:235], a[148:151], a[192:195], v[232:235]
s_barrier
v_add_u32 v11, 4294836224, v11
ds_read_b128 a[168:171], v11 offset:8448
v_mfma_f32_16x16x32_bf16 v[236:239], a[148:151], a[196:199], v[236:239]
s_waitcnt lgkmcnt(4)
v_mfma_f32_16x16x32_bf16 v[168:171], a[152:155], a[200:203], v[168:171]
s_add_u32 m0, s26, 88704
ds_read_b128 a[172:175], v11 offset:9504
v_mfma_f32_16x16x32_bf16 v[172:175], a[152:155], a[204:207], v[172:175]
s_waitcnt lgkmcnt(4)
buffer_load_dwordx4 v2, s[8:11], s25 offen sc1 lds
v_mfma_f32_16x16x32_bf16 v[176:179], a[156:159], a[200:203], v[176:179]
s_add_u32 s25, s25, 4096
ds_read_b128 a[144:147], v11 offset:10560
v_mfma_f32_16x16x32_bf16 v[180:183], a[156:159], a[204:207], v[180:183]
PAD5:
s_cbranch_execz PAD_ret
s_waitcnt lgkmcnt(4)
v_mfma_f32_16x16x32_bf16 v[184:187], a[160:163], a[200:203], v[184:187]
s_add_u32 s36, s31, 10240
ds_read_b128 a[148:151], v11 offset:11616
v_mfma_f32_16x16x32_bf16 v[188:191], a[160:163], a[204:207], v[188:191]
s_waitcnt lgkmcnt(4)
buffer_load_dwordx4 a[56:59], v1, s[8:11], s36 offen sc1
v_mfma_f32_16x16x32_bf16 v[192:195], a[164:167], a[200:203], v[192:195]
ds_read_b128 a[152:155], v11 offset:12672
v_mfma_f32_16x16x32_bf16 v[196:199], a[164:167], a[204:207], v[196:199]
s_waitcnt lgkmcnt(4)
v_mfma_f32_16x16x32_bf16 v[200:203], a[168:171], a[200:203], v[200:203]
s_add_u32 s36, s31, 11264
ds_read_b128 a[156:159], v11 offset:13728
v_mfma_f32_16x16x32_bf16 v[204:207], a[168:171], a[204:207], v[204:207]
s_waitcnt lgkmcnt(4)
buffer_load_dwordx4 a[60:63], v1, s[8:11], s36 offen sc1
v_mfma_f32_16x16x32_bf16 v[208:211], a[172:175], a[200:203], v[208:211]
ds_read_b128 a[160:163], v11 offset:14784
v_mfma_f32_16x16x32_bf16 v[212:215], a[172:175], a[204:207], v[212:215]
s_waitcnt lgkmcnt(4)
v_mfma_f32_16x16x32_bf16 v[232:235], a[144:147], a[200:203], v[232:235]
s_add_u32 s36, s29, 12288
ds_read_b128 a[164:167], v11 offset:15840
v_mfma_f32_16x16x32_bf16 v[236:239], a[144:147], a[204:207], v[236:239]
s_waitcnt lgkmcnt(4)
buffer_load_dwordx4 a[64:67], v1, s[8:11], s36 offen sc1
v_mfma_f32_16x16x32_bf16 v[168:171], a[148:151], a[208:211], v[168:171]
ds_read_b128 a[168:171], v11 offset:16896
v_mfma_f32_16x16x32_bf16 v[172:175], a[148:151], a[212:215], v[172:175]
s_waitcnt lgkmcnt(4)
v_mfma_f32_16x16x32_bf16 v[176:179], a[152:155], a[208:211], v[176:179]
s_add_u32 s36, s29, 13312
ds_read_b128 a[172:175], v11 offset:17952
v_mfma_f32_16x16x32_bf16 v[180:183], a[152:155], a[212:215], v[180:183]
s_waitcnt lgkmcnt(4)
buffer_load_dwordx4 a[68:71], v1, s[8:11], s36 offen sc1
v_mfma_f32_16x16x32_bf16 v[184:187], a[156:159], a[208:211], v[184:187]
ds_read_b128 a[144:147], v11 offset:19008
v_mfma_f32_16x16x32_bf16 v[188:191], a[156:159], a[212:215], v[188:191]
s_waitcnt lgkmcnt(4)
v_mfma_f32_16x16x32_bf16 v[192:195], a[160:163], a[208:211], v[192:195]
s_add_u32 s36, s30, 12288
ds_read_b128 a[148:151], v11 offset:20064
v_mfma_f32_16x16x32_bf16 v[196:199], a[160:163], a[212:215], v[196:199]
s_waitcnt lgkmcnt(4)
buffer_load_dwordx4 a[72:75], v1, s[8:11], s36 offen sc1
v_mfma_f32_16x16x32_bf16 v[200:203], a[164:167], a[208:211], v[200:203]
buffer_load_dword v7, v5, s[8:11], s33 offen sc1
ds_read_b128 a[152:155], v11 offset:21120
v_mfma_f32_16x16x32_bf16 v[204:207], a[164:167], a[212:215], v[204:207]
s_waitcnt lgkmcnt(4)
v_mfma_f32_16x16x32_bf16 v[208:211], a[168:171], a[208:211], v[208:211]
ds_read_b128 a[156:159], v11 offset:22176
v_mfma_f32_16x16x32_bf16 v[212:215], a[168:171], a[212:215], v[212:215]
s_waitcnt lgkmcnt(4)
v_mfma_f32_16x16x32_bf16 v[232:235], a[172:175], a[208:211], v[232:235]
s_add_u32 s36, s30, 13312
ds_read_b128 a[160:163], v11 offset:23232
v_mfma_f32_16x16x32_bf16 v[236:239], a[172:175], a[212:215], v[236:239]
s_waitcnt lgkmcnt(4)
buffer_load_dwordx4 a[76:79], v1, s[8:11], s36 offen sc1
v_mfma_f32_16x16x32_bf16 v[168:171], a[144:147], a[216:219], v[168:171]
ds_read_b128 a[164:167], v11 offset:24288
v_mfma_f32_16x16x32_bf16 v[172:175], a[144:147], a[220:223], v[172:175]
s_waitcnt lgkmcnt(4)
v_mfma_f32_16x16x32_bf16 v[176:179], a[148:151], a[216:219], v[176:179]
s_add_u32 s36, s31, 12288
s_barrier
ds_read_b128 a[168:171], v11 offset:25344
v_mfma_f32_16x16x32_bf16 v[180:183], a[148:151], a[220:223], v[180:183]
s_waitcnt lgkmcnt(4)
buffer_load_dwordx4 a[80:83], v1, s[8:11], s36 offen sc1
v_mfma_f32_16x16x32_bf16 v[184:187], a[152:155], a[216:219], v[184:187]
s_lshl_b32 s51, s23, 4
s_lshl_b32 s50, s22, 2
s_add_u32 s51, s51, s50
s_lshl_b32 s59, s51, 4
s_mul_i32 s51, s51, 33024
s_lshl_b32 s50, s35, 3
s_add_u32 s50, s50, s51
s_add_u32 s50, s50, 50606080
buffer_load_dwordx4 v[36:39], v3, s[8:11], s50 offen sc1
buffer_load_dwordx4 v[48:51], v255, s[8:11], s50 offen sc1
buffer_load_dwordx4 v[52:55], v9, s[16:19], s59 offen
s_mul_i32 s50, s35, 1152
s_add_u32 s59, s59, s50
ds_read_b128 a[172:175], v11 offset:26400
v_mfma_f32_16x16x32_bf16 v[188:191], a[152:155], a[220:223], v[188:191]
s_waitcnt lgkmcnt(4)
v_mfma_f32_16x16x32_bf16 v[192:195], a[156:159], a[216:219], v[192:195]
ds_read_b128 a[144:147], v11 offset:27456
v_mfma_f32_16x16x32_bf16 v[196:199], a[156:159], a[220:223], v[196:199]
s_waitcnt lgkmcnt(4)
v_mfma_f32_16x16x32_bf16 v[200:203], a[160:163], a[216:219], v[200:203]
s_add_u32 s36, s31, 13312
ds_read_b128 a[148:151], v11 offset:28512
v_mfma_f32_16x16x32_bf16 v[204:207], a[160:163], a[220:223], v[204:207]
s_waitcnt lgkmcnt(4)
buffer_load_dwordx4 a[84:87], v1, s[8:11], s36 offen sc1
v_mfma_f32_16x16x32_bf16 v[208:211], a[164:167], a[216:219], v[208:211]
ds_read_b128 a[152:155], v11 offset:29568
v_mfma_f32_16x16x32_bf16 v[212:215], a[164:167], a[220:223], v[212:215]
s_waitcnt lgkmcnt(4)
v_mul_u32_u24 v82, 1032, v9
v_and_b32 v83, 15, v0
v_lshl_add_u32 v82, v83, 4, v82
s_mul_i32 s51, s23, 66048
s_lshl_b32 s50, s35, 3
s_add_u32 s50, s50, s51
s_add_u32 s50, s50, 52719616
buffer_load_dwordx4 v[64:67], v82, s[8:11], s50 offen sc1
v_lshrrev_b32 v83, 1, v9
s_lshl_b32 s50, s23, 5
buffer_load_dwordx2 v[68:69], v83, s[16:19], s50 offen offset:1024
v_mfma_f32_16x16x32_bf16 v[232:235], a[168:171], a[216:219], v[232:235]
ds_read_b128 a[156:159], v11 offset:30624
v_mfma_f32_16x16x32_bf16 v[236:239], a[168:171], a[220:223], v[236:239]
s_waitcnt lgkmcnt(4)
v_mfma_f32_16x16x32_bf16 v[168:171], a[172:175], a[224:227], v[168:171]
s_add_u32 m0, s26, 92928
ds_read_b128 a[160:163], v11 offset:31680
v_mfma_f32_16x16x32_bf16 v[172:175], a[172:175], a[228:231], v[172:175]
s_waitcnt lgkmcnt(4)
buffer_load_dwordx4 v2, s[8:11], s25 offen sc1 lds
v_mfma_f32_16x16x32_bf16 v[176:179], a[144:147], a[224:227], v[176:179]
s_add_u32 s25, s25, 4096
ds_read_b128 a[164:167], v11 offset:32736
v_mfma_f32_16x16x32_bf16 v[180:183], a[144:147], a[228:231], v[180:183]
s_waitcnt lgkmcnt(4)
v_mfma_f32_16x16x32_bf16 v[184:187], a[148:151], a[224:227], v[184:187]
s_add_u32 m0, s26, 97152
ds_read_b128 a[168:171], v11 offset:42240
v_mfma_f32_16x16x32_bf16 v[188:191], a[148:151], a[228:231], v[188:191]
s_waitcnt lgkmcnt(4)
buffer_load_dwordx4 v2, s[8:11], s25 offen sc1 lds
v_mfma_f32_16x16x32_bf16 v[192:195], a[152:155], a[224:227], v[192:195]
s_add_u32 s25, s25, 4096
ds_read_b128 a[172:175], v11 offset:43296
v_mfma_f32_16x16x32_bf16 v[196:199], a[152:155], a[228:231], v[196:199]
s_waitcnt lgkmcnt(4)
v_mfma_f32_16x16x32_bf16 v[200:203], a[156:159], a[224:227], v[200:203]
s_add_u32 m0, s26, 109824
ds_read_b128 a[144:147], v11 offset:44352
v_mfma_f32_16x16x32_bf16 v[204:207], a[156:159], a[228:231], v[204:207]
s_waitcnt lgkmcnt(4)
buffer_load_dwordx4 v2, s[8:11], s25 offen sc1 lds
v_mfma_f32_16x16x32_bf16 v[208:211], a[160:163], a[224:227], v[208:211]
s_add_u32 s25, s25, 4096
ds_read_b128 a[148:151], v11 offset:45408
v_mfma_f32_16x16x32_bf16 v[212:215], a[160:163], a[228:231], v[212:215]
s_waitcnt lgkmcnt(4)
v_mfma_f32_16x16x32_bf16 v[232:235], a[164:167], a[224:227], v[232:235]
s_add_u32 m0, s26, 114048
ds_read_b128 a[152:155], v11 offset:46464
v_mfma_f32_16x16x32_bf16 v[236:239], a[164:167], a[228:231], v[236:239]
s_waitcnt lgkmcnt(4)
buffer_load_dwordx4 v2, s[8:11], s25 offen sc1 lds
v_mfma_f32_16x16x32_bf16 v[168:171], a[168:171], a[232:235], v[168:171]
s_add_u32 s25, s25, 4096
ds_read_b128 a[156:159], v11 offset:47520
v_mfma_f32_16x16x32_bf16 v[172:175], a[168:171], a[236:239], v[172:175]
s_waitcnt lgkmcnt(4)
v_mfma_f32_16x16x32_bf16 v[176:179], a[172:175], a[232:235], v[176:179]
s_add_u32 m0, s26, 0
ds_read_b128 a[160:163], v11 offset:48576
v_mfma_f32_16x16x32_bf16 v[180:183], a[172:175], a[236:239], v[180:183]
s_waitcnt lgkmcnt(4)
buffer_load_dwordx4 v2, s[8:11], s25 offen sc1 lds
v_mfma_f32_16x16x32_bf16 v[184:187], a[144:147], a[232:235], v[184:187]
s_add_u32 s25, s25, 4096
ds_read_b128 a[164:167], v11 offset:49632
v_mfma_f32_16x16x32_bf16 v[188:191], a[144:147], a[236:239], v[188:191]
s_waitcnt lgkmcnt(4)
v_mfma_f32_16x16x32_bf16 v[192:195], a[148:151], a[232:235], v[192:195]
s_add_u32 m0, s26, 4224
s_waitcnt vmcnt(36)
s_barrier
ds_read_b128 a[168:171], v11 offset:50688
v_mfma_f32_16x16x32_bf16 v[196:199], a[148:151], a[236:239], v[196:199]
s_waitcnt lgkmcnt(4)
buffer_load_dwordx4 v2, s[8:11], s25 offen sc1 lds
v_mfma_f32_16x16x32_bf16 v[200:203], a[152:155], a[232:235], v[200:203]
s_add_u32 s25, s25, 4096
ds_read_b128 a[172:175], v11 offset:51744
v_mfma_f32_16x16x32_bf16 v[204:207], a[152:155], a[236:239], v[204:207]
s_waitcnt lgkmcnt(4)
v_mfma_f32_16x16x32_bf16 v[208:211], a[156:159], a[232:235], v[208:211]
s_add_u32 m0, s26, 33792
ds_read_b128 a[144:147], v11 offset:52800
v_mfma_f32_16x16x32_bf16 v[212:215], a[156:159], a[236:239], v[212:215]
s_waitcnt lgkmcnt(4)
s_waitcnt vmcnt(14)
v_subrev_u32 v7, s6, v7
v_cmp_lt_u32 vcc, 1, v7
s_cbranch_vccnz L3_poll3
L3_poll3_ret:
buffer_load_dwordx4 v2, s[8:11], s25 offen sc1 lds
v_mfma_f32_16x16x32_bf16 v[232:235], a[160:163], a[232:235], v[232:235]
s_add_u32 s25, s25, 4096
ds_read_b128 a[148:151], v11 offset:53856
v_mfma_f32_16x16x32_bf16 v[236:239], a[160:163], a[236:239], v[236:239]
s_waitcnt lgkmcnt(4)
v_mfma_f32_16x16x32_bf16 v[168:171], a[164:167], a[240:243], v[168:171]
s_add_u32 s36, s29, 14336
ds_read_b128 a[152:155], v11 offset:54912
v_mfma_f32_16x16x32_bf16 v[172:175], a[164:167], a[244:247], v[172:175]
s_waitcnt lgkmcnt(4)
buffer_load_dwordx4 a[88:91], v1, s[8:11], s36 offen sc1
v_mfma_f32_16x16x32_bf16 v[176:179], a[168:171], a[240:243], v[176:179]
s_add_u32 s36, s29, 15360
ds_read_b128 a[156:159], v11 offset:55968
v_mfma_f32_16x16x32_bf16 v[180:183], a[168:171], a[244:247], v[180:183]
s_waitcnt lgkmcnt(4)
buffer_load_dwordx4 a[92:95], v1, s[8:11], s36 offen sc1
v_mfma_f32_16x16x32_bf16 v[184:187], a[172:175], a[240:243], v[184:187]
s_add_u32 s36, s30, 14336
ds_read_b128 a[160:163], v11 offset:57024
v_mfma_f32_16x16x32_bf16 v[188:191], a[172:175], a[244:247], v[188:191]
s_waitcnt lgkmcnt(4)
buffer_load_dwordx4 a[96:99], v1, s[8:11], s36 offen sc1
v_mfma_f32_16x16x32_bf16 v[192:195], a[144:147], a[240:243], v[192:195]
s_add_u32 s36, s30, 15360
ds_read_b128 a[164:167], v11 offset:58080
v_mfma_f32_16x16x32_bf16 v[196:199], a[144:147], a[244:247], v[196:199]
s_waitcnt lgkmcnt(4)
buffer_load_dwordx4 a[100:103], v1, s[8:11], s36 offen sc1
v_mfma_f32_16x16x32_bf16 v[200:203], a[148:151], a[240:243], v[200:203]
s_add_u32 s36, s31, 14336
ds_read_b128 a[168:171], v11 offset:59136
v_mfma_f32_16x16x32_bf16 v[204:207], a[148:151], a[244:247], v[204:207]
s_waitcnt lgkmcnt(4)
buffer_load_dwordx4 a[104:107], v1, s[8:11], s36 offen sc1
v_mfma_f32_16x16x32_bf16 v[208:211], a[152:155], a[240:243], v[208:211]
s_add_u32 s36, s31, 15360
ds_read_b128 a[172:175], v11 offset:60192
v_mfma_f32_16x16x32_bf16 v[212:215], a[152:155], a[244:247], v[212:215]
s_waitcnt lgkmcnt(4)
buffer_load_dwordx4 a[108:111], v1, s[8:11], s36 offen sc1
v_mfma_f32_16x16x32_bf16 v[232:235], a[156:159], a[240:243], v[232:235]
s_add_u32 s36, s29, 16384
ds_read_b128 a[144:147], v11 offset:61248
v_mfma_f32_16x16x32_bf16 v[236:239], a[156:159], a[244:247], v[236:239]
s_waitcnt lgkmcnt(4)
buffer_load_dwordx4 a[112:115], v1, s[8:11], s36 offen sc1
v_mfma_f32_16x16x32_bf16 v[168:171], a[160:163], a[248:251], v[168:171]
s_add_u32 s36, s29, 17408
ds_read_b128 a[148:151], v11 offset:62304
v_mfma_f32_16x16x32_bf16 v[172:175], a[160:163], a[252:255], v[172:175]
s_waitcnt lgkmcnt(4)
buffer_load_dwordx4 a[116:119], v1, s[8:11], s36 offen sc1
v_mfma_f32_16x16x32_bf16 v[176:179], a[164:167], a[248:251], v[176:179]
s_add_u32 s36, s30, 16384
ds_read_b128 a[152:155], v11 offset:63360
v_mfma_f32_16x16x32_bf16 v[180:183], a[164:167], a[252:255], v[180:183]
s_waitcnt lgkmcnt(4)
buffer_load_dwordx4 a[120:123], v1, s[8:11], s36 offen sc1
v_mfma_f32_16x16x32_bf16 v[184:187], a[168:171], a[248:251], v[184:187]
s_add_u32 s36, s30, 17408
ds_read_b128 a[156:159], v11 offset:64416
v_mfma_f32_16x16x32_bf16 v[188:191], a[168:171], a[252:255], v[188:191]
s_waitcnt lgkmcnt(4)
buffer_load_dwordx4 a[124:127], v1, s[8:11], s36 offen sc1
v_mfma_f32_16x16x32_bf16 v[192:195], a[172:175], a[248:251], v[192:195]
s_add_u32 s36, s31, 16384
ds_read_b128 a[160:163], v11 offset:65472
v_mfma_f32_16x16x32_bf16 v[196:199], a[172:175], a[252:255], v[196:199]
s_waitcnt lgkmcnt(4)
buffer_load_dwordx4 a[128:131], v1, s[8:11], s36 offen sc1
v_mfma_f32_16x16x32_bf16 v[200:203], a[144:147], a[248:251], v[200:203]
s_add_u32 s36, s31, 17408
v_add_u32 v11, 65536, v11
ds_read_b128 a[164:167], v11 offset:992
v_mfma_f32_16x16x32_bf16 v[204:207], a[144:147], a[252:255], v[204:207]
s_waitcnt lgkmcnt(4)
buffer_load_dwordx4 a[132:135], v1, s[8:11], s36 offen sc1
v_mfma_f32_16x16x32_bf16 v[208:211], a[148:151], a[248:251], v[208:211]
s_add_u32 m0, s26, 38016
s_barrier
ds_read_b128 a[168:171], v11 offset:10496
v_mfma_f32_16x16x32_bf16 v[212:215], a[148:151], a[252:255], v[212:215]
s_waitcnt lgkmcnt(4)
buffer_load_dwordx4 v2, s[8:11], s25 offen sc1 lds
v_mfma_f32_16x16x32_bf16 v[232:235], a[152:155], a[248:251], v[232:235]
s_add_u32 s25, s25, 4096
ds_read_b128 a[172:175], v11 offset:11552
v_mfma_f32_16x16x32_bf16 v[236:239], a[152:155], a[252:255], v[236:239]
s_waitcnt lgkmcnt(4)
v_mfma_f32_16x16x32_bf16 v[168:171], a[156:159], a[0:3], v[168:171]
s_add_u32 m0, s26, 67584
ds_read_b128 a[144:147], v11 offset:12608
v_mfma_f32_16x16x32_bf16 v[172:175], a[156:159], a[4:7], v[172:175]
s_waitcnt lgkmcnt(4)
buffer_load_dwordx4 v2, s[8:11], s25 offen sc1 lds
v_mfma_f32_16x16x32_bf16 v[176:179], a[160:163], a[0:3], v[176:179]
s_add_u32 s25, s25, 4096
ds_read_b128 a[148:151], v11 offset:13664
v_mfma_f32_16x16x32_bf16 v[180:183], a[160:163], a[4:7], v[180:183]
s_waitcnt lgkmcnt(4)
v_mfma_f32_16x16x32_bf16 v[184:187], a[164:167], a[0:3], v[184:187]
s_add_u32 m0, s26, 71808
ds_read_b128 a[152:155], v11 offset:14720
v_mfma_f32_16x16x32_bf16 v[188:191], a[164:167], a[4:7], v[188:191]
s_waitcnt lgkmcnt(4)
buffer_load_dwordx4 v2, s[8:11], s25 offen sc1 lds
v_mfma_f32_16x16x32_bf16 v[192:195], a[168:171], a[0:3], v[192:195]
s_add_u32 s25, s25, 4096
ds_read_b128 a[156:159], v11 offset:15776
v_mfma_f32_16x16x32_bf16 v[196:199], a[168:171], a[4:7], v[196:199]
s_waitcnt lgkmcnt(4)
v_mfma_f32_16x16x32_bf16 v[200:203], a[172:175], a[0:3], v[200:203]
s_add_u32 m0, s26, 101376
ds_read_b128 a[160:163], v11 offset:16832
v_mfma_f32_16x16x32_bf16 v[204:207], a[172:175], a[4:7], v[204:207]
s_waitcnt lgkmcnt(4)
buffer_load_dwordx4 v2, s[8:11], s25 offen sc1 lds
v_mfma_f32_16x16x32_bf16 v[208:211], a[144:147], a[0:3], v[208:211]
s_add_u32 s25, s25, 4096
ds_read_b128 a[164:167], v11 offset:17888
v_mfma_f32_16x16x32_bf16 v[212:215], a[144:147], a[4:7], v[212:215]
s_waitcnt lgkmcnt(4)
v_mfma_f32_16x16x32_bf16 v[232:235], a[148:151], a[0:3], v[232:235]
s_add_u32 m0, s26, 105600
ds_read_b128 a[168:171], v11 offset:18944
v_mfma_f32_16x16x32_bf16 v[236:239], a[148:151], a[4:7], v[236:239]
s_waitcnt lgkmcnt(4)
buffer_load_dwordx4 v2, s[8:11], s25 offen sc1 lds
v_mfma_f32_16x16x32_bf16 v[168:171], a[152:155], a[8:11], v[168:171]
s_add_u32 s25, s25, 4096
ds_read_b128 a[172:175], v11 offset:20000
v_mfma_f32_16x16x32_bf16 v[172:175], a[152:155], a[12:15], v[172:175]
s_waitcnt lgkmcnt(4)
v_mfma_f32_16x16x32_bf16 v[176:179], a[156:159], a[8:11], v[176:179]
s_add_u32 m0, s26, 118272
ds_read_b128 a[144:147], v11 offset:21056
v_mfma_f32_16x16x32_bf16 v[180:183], a[156:159], a[12:15], v[180:183]
s_waitcnt lgkmcnt(4)
buffer_load_dwordx4 v2, s[8:11], s25 offen sc1 lds
v_mfma_f32_16x16x32_bf16 v[184:187], a[160:163], a[8:11], v[184:187]
s_add_u32 s25, s25, 4096
ds_read_b128 a[148:151], v11 offset:22112
v_mfma_f32_16x16x32_bf16 v[188:191], a[160:163], a[12:15], v[188:191]
s_waitcnt lgkmcnt(4)
v_mfma_f32_16x16x32_bf16 v[192:195], a[164:167], a[8:11], v[192:195]
s_add_u32 m0, s26, 122496
ds_read_b128 a[152:155], v11 offset:23168
v_mfma_f32_16x16x32_bf16 v[196:199], a[164:167], a[12:15], v[196:199]
s_waitcnt lgkmcnt(4)
buffer_load_dwordx4 v2, s[8:11], s25 offen sc1 lds
v_mfma_f32_16x16x32_bf16 v[200:203], a[168:171], a[8:11], v[200:203]
s_add_u32 s25, s25, 4096
ds_read_b128 a[156:159], v11 offset:24224
v_mfma_f32_16x16x32_bf16 v[204:207], a[168:171], a[12:15], v[204:207]
s_waitcnt lgkmcnt(4)
v_mfma_f32_16x16x32_bf16 v[208:211], a[172:175], a[8:11], v[208:211]
s_add_u32 m0, s26, 126720
ds_read_b128 a[160:163], v11 offset:25280
v_mfma_f32_16x16x32_bf16 v[212:215], a[172:175], a[12:15], v[212:215]
s_waitcnt lgkmcnt(4)
buffer_load_dwordx4 v2, s[8:11], s25 offen sc1 lds
v_mfma_f32_16x16x32_bf16 v[232:235], a[144:147], a[8:11], v[232:235]
s_add_u32 s25, s25, 4096
ds_read_b128 a[164:167], v11 offset:26336
v_mfma_f32_16x16x32_bf16 v[236:239], a[144:147], a[12:15], v[236:239]
s_waitcnt lgkmcnt(4)
v_mfma_f32_16x16x32_bf16 v[168:171], a[148:151], a[16:19], v[168:171]
s_add_u32 m0, s26, 130944
s_waitcnt vmcnt(23)
s_barrier
ds_read_b128 a[168:171], v11 offset:27392
v_mfma_f32_16x16x32_bf16 v[172:175], a[148:151], a[20:23], v[172:175]
s_waitcnt lgkmcnt(4)
buffer_load_dwordx4 v2, s[8:11], s25 offen sc1 lds
v_mfma_f32_16x16x32_bf16 v[176:179], a[152:155], a[16:19], v[176:179]
s_add_u32 s25, s25, 4096
ds_read_b128 a[172:175], v11 offset:28448
v_mfma_f32_16x16x32_bf16 v[180:183], a[152:155], a[20:23], v[180:183]
s_waitcnt lgkmcnt(4)
v_mfma_f32_16x16x32_bf16 v[168:171], a[156:159], a[24:27], v[168:171]
s_add_u32 m0, s26, 135168
ds_read_b128 a[144:147], v11 offset:29504
v_mfma_f32_16x16x32_bf16 v[172:175], a[156:159], a[28:31], v[172:175]
s_waitcnt lgkmcnt(4)
buffer_load_dwordx4 v2, s[8:11], s25 offen sc1 lds
v_mfma_f32_16x16x32_bf16 v[176:179], a[160:163], a[24:27], v[176:179]
s_add_u32 s25, s25, 4096
ds_read_b128 a[148:151], v11 offset:30560
v_mfma_f32_16x16x32_bf16 v[180:183], a[160:163], a[28:31], v[180:183]
s_waitcnt lgkmcnt(4)
v_mfma_f32_16x16x32_bf16 v[168:171], a[164:167], a[32:35], v[168:171]
s_add_u32 m0, s26, 139392
ds_read_b128 a[152:155], v11 offset:31616
v_mfma_f32_16x16x32_bf16 v[172:175], a[164:167], a[36:39], v[172:175]
s_waitcnt lgkmcnt(4)
buffer_load_dwordx4 v2, s[8:11], s25 offen sc1 lds
v_mfma_f32_16x16x32_bf16 v[176:179], a[168:171], a[32:35], v[176:179]
s_add_u32 s25, s25, 4096
ds_read_b128 a[156:159], v11 offset:32672
v_mfma_f32_16x16x32_bf16 v[180:183], a[168:171], a[36:39], v[180:183]
s_waitcnt lgkmcnt(4)
v_mfma_f32_16x16x32_bf16 v[168:171], a[172:175], a[40:43], v[168:171]
s_add_u32 m0, s26, 143616
ds_read_b128 a[160:163], v11 offset:33728
v_mfma_f32_16x16x32_bf16 v[172:175], a[172:175], a[44:47], v[172:175]
s_waitcnt lgkmcnt(4)
buffer_load_dwordx4 v2, s[8:11], s25 offen sc1 lds
v_mfma_f32_16x16x32_bf16 v[176:179], a[144:147], a[40:43], v[176:179]
s_add_u32 s25, s25, 4096
ds_read_b128 a[164:167], v11 offset:34784
v_mfma_f32_16x16x32_bf16 v[180:183], a[144:147], a[44:47], v[180:183]
s_waitcnt lgkmcnt(4)
v_mfma_f32_16x16x32_bf16 v[168:171], a[148:151], a[48:51], v[168:171]
s_add_u32 m0, s26, 147840
ds_read_b128 a[168:171], v11 offset:44288
v_mfma_f32_16x16x32_bf16 v[172:175], a[148:151], a[52:55], v[172:175]
s_waitcnt lgkmcnt(4)
buffer_load_dwordx4 v2, s[8:11], s25 offen sc1 lds
v_mfma_f32_16x16x32_bf16 v[176:179], a[152:155], a[48:51], v[176:179]
s_add_u32 s25, s25, 4096
ds_read_b128 a[172:175], v11 offset:45344
v_mfma_f32_16x16x32_bf16 v[180:183], a[152:155], a[52:55], v[180:183]
s_waitcnt lgkmcnt(4)
v_mfma_f32_16x16x32_bf16 v[168:171], a[156:159], a[56:59], v[168:171]
s_add_u32 m0, s26, 8448
ds_read_b128 a[144:147], v11 offset:46400
v_mfma_f32_16x16x32_bf16 v[172:175], a[156:159], a[60:63], v[172:175]
s_waitcnt lgkmcnt(4)
buffer_load_dwordx4 v2, s[8:11], s25 offen sc1 lds
v_mfma_f32_16x16x32_bf16 v[176:179], a[160:163], a[56:59], v[176:179]
s_add_u32 s25, s25, 4096
ds_read_b128 a[148:151], v11 offset:47456
v_mfma_f32_16x16x32_bf16 v[180:183], a[160:163], a[60:63], v[180:183]
s_waitcnt lgkmcnt(4)
v_mfma_f32_16x16x32_bf16 v[168:171], a[164:167], a[64:67], v[168:171]
s_add_u32 m0, s26, 12672
ds_read_b128 a[152:155], v11 offset:48512
v_mfma_f32_16x16x32_bf16 v[172:175], a[164:167], a[68:71], v[172:175]
s_waitcnt lgkmcnt(4)
buffer_load_dwordx4 v2, s[8:11], s25 offen sc1 lds
v_mfma_f32_16x16x32_bf16 v[176:179], a[168:171], a[64:67], v[176:179]
s_add_u32 s25, s25, 4096
ds_read_b128 a[156:159], v11 offset:49568
v_lshlrev_b32 v240, 16, v36
v_mfma_f32_16x16x32_bf16 v[180:183], a[168:171], a[68:71], v[180:183]
s_waitcnt lgkmcnt(4)
v_and_b32 v241, 0xffff0000, v36
v_lshlrev_b32 v10, 16, v52
v_mfma_f32_16x16x32_bf16 v[168:171], a[172:175], a[72:75], v[168:171]
s_add_u32 m0, s26, 16896
ds_read_b128 a[160:163], v11 offset:50624
v_add_f32 v240, v240, v10
v_mfma_f32_16x16x32_bf16 v[172:175], a[172:175], a[76:79], v[172:175]
s_waitcnt lgkmcnt(4)
buffer_load_dwordx4 v2, s[8:11], s25 offen sc1 lds
v_mfma_f32_16x16x32_bf16 v[176:179], a[144:147], a[72:75], v[176:179]
s_add_u32 s25, s25, 4096
ds_read_b128 a[164:167], v11 offset:51680
v_and_b32 v10, 0xffff0000, v52
v_mfma_f32_16x16x32_bf16 v[180:183], a[144:147], a[76:79], v[180:183]
s_waitcnt lgkmcnt(4)
v_add_f32 v241, v241, v10
v_lshlrev_b32 v242, 16, v37
v_mfma_f32_16x16x32_bf16 v[168:171], a[148:151], a[80:83], v[168:171]
s_add_u32 m0, s26, 21120
s_waitcnt vmcnt(15)
s_barrier
v_add_u32 v11, 4294901760, v11
ds_read_b128 a[168:171], v11 offset:0
v_and_b32 v243, 0xffff0000, v37
v_mfma_f32_16x16x32_bf16 v[172:175], a[148:151], a[84:87], v[172:175]
s_waitcnt lgkmcnt(4)
buffer_load_dwordx4 v2, s[8:11], s25 offen sc1 lds
v_mfma_f32_16x16x32_bf16 v[176:179], a[152:155], a[80:83], v[176:179]
s_add_u32 s25, s25, 4096
ds_read_b128 a[172:175], v11 offset:1056
v_lshlrev_b32 v10, 16, v53
v_mfma_f32_16x16x32_bf16 v[180:183], a[152:155], a[84:87], v[180:183]
s_waitcnt lgkmcnt(4)
v_add_f32 v242, v242, v10
v_and_b32 v10, 0xffff0000, v53
v_mfma_f32_16x16x32_bf16 v[168:171], a[156:159], a[88:91], v[168:171]
s_add_u32 m0, s26, 25344
ds_read_b128 a[144:147], v11 offset:2112
v_add_f32 v243, v243, v10
v_mfma_f32_16x16x32_bf16 v[172:175], a[156:159], a[92:95], v[172:175]
s_waitcnt lgkmcnt(4)
buffer_load_dwordx4 v2, s[8:11], s25 offen sc1 lds
v_mfma_f32_16x16x32_bf16 v[176:179], a[160:163], a[88:91], v[176:179]
s_add_u32 s25, s25, 4096
ds_read_b128 a[148:151], v11 offset:3168
v_lshlrev_b32 v244, 16, v48
v_mfma_f32_16x16x32_bf16 v[180:183], a[160:163], a[92:95], v[180:183]
s_waitcnt lgkmcnt(4)
v_and_b32 v245, 0xffff0000, v48
v_lshlrev_b32 v10, 16, v54
v_mfma_f32_16x16x32_bf16 v[168:171], a[164:167], a[96:99], v[168:171]
s_add_u32 m0, s26, 29568
ds_read_b128 a[152:155], v11 offset:4224
v_add_f32 v244, v244, v10
v_mfma_f32_16x16x32_bf16 v[172:175], a[164:167], a[100:103], v[172:175]
s_waitcnt lgkmcnt(4)
buffer_load_dwordx4 v2, s[8:11], s25 offen sc1 lds
v_mfma_f32_16x16x32_bf16 v[176:179], a[168:171], a[96:99], v[176:179]
s_add_u32 s25, s25, 4096
ds_read_b128 a[156:159], v11 offset:5280
v_and_b32 v10, 0xffff0000, v54
v_mfma_f32_16x16x32_bf16 v[180:183], a[168:171], a[100:103], v[180:183]
s_waitcnt lgkmcnt(4)
v_add_f32 v245, v245, v10
v_lshlrev_b32 v246, 16, v49
v_mfma_f32_16x16x32_bf16 v[168:171], a[172:175], a[104:107], v[168:171]
s_add_u32 m0, s26, 42240
ds_read_b128 a[160:163], v11 offset:6336
v_and_b32 v247, 0xffff0000, v49
v_mfma_f32_16x16x32_bf16 v[172:175], a[172:175], a[108:111], v[172:175]
s_waitcnt lgkmcnt(4)
buffer_load_dwordx4 v2, s[8:11], s25 offen sc1 lds
v_mfma_f32_16x16x32_bf16 v[176:179], a[144:147], a[104:107], v[176:179]
s_add_u32 s25, s25, 4096
ds_read_b128 a[164:167], v11 offset:7392
v_lshlrev_b32 v10, 16, v55
v_mfma_f32_16x16x32_bf16 v[180:183], a[144:147], a[108:111], v[180:183]
s_waitcnt lgkmcnt(4)
v_add_f32 v246, v246, v10
v_and_b32 v10, 0xffff0000, v55
v_mfma_f32_16x16x32_bf16 v[168:171], a[148:151], a[112:115], v[168:171]
s_add_u32 m0, s26, 46464
ds_read_b128 a[168:171], v11 offset:33792
v_add_f32 v247, v247, v10
v_mfma_f32_16x16x32_bf16 v[172:175], a[148:151], a[116:119], v[172:175]
s_waitcnt lgkmcnt(4)
buffer_load_dwordx4 v2, s[8:11], s25 offen sc1 lds
v_mfma_f32_16x16x32_bf16 v[176:179], a[152:155], a[112:115], v[176:179]
s_add_u32 s25, s25, 4096
ds_read_b128 a[172:175], v11 offset:34848
v_lshlrev_b32 v248, 16, v38
v_mfma_f32_16x16x32_bf16 v[180:183], a[152:155], a[116:119], v[180:183]
s_waitcnt lgkmcnt(4)
v_and_b32 v249, 0xffff0000, v38
v_lshlrev_b32 v10, 16, v52
v_mfma_f32_16x16x32_bf16 v[168:171], a[156:159], a[120:123], v[168:171]
s_add_u32 m0, s26, 50688
ds_read_b128 a[144:147], v11 offset:35904
v_add_f32 v248, v248, v10
v_mfma_f32_16x16x32_bf16 v[172:175], a[156:159], a[124:127], v[172:175]
s_waitcnt lgkmcnt(4)
buffer_load_dwordx4 v2, s[8:11], s25 offen sc1 lds
v_mfma_f32_16x16x32_bf16 v[176:179], a[160:163], a[120:123], v[176:179]
s_add_u32 s25, s25, 4096
ds_read_b128 a[148:151], v11 offset:36960
v_and_b32 v10, 0xffff0000, v52
v_mfma_f32_16x16x32_bf16 v[180:183], a[160:163], a[124:127], v[180:183]
s_waitcnt lgkmcnt(4)
v_add_f32 v249, v249, v10
v_lshlrev_b32 v250, 16, v39
v_mfma_f32_16x16x32_bf16 v[168:171], a[164:167], a[128:131], v[168:171]
s_add_u32 m0, s26, 54912
ds_read_b128 a[152:155], v11 offset:38016
v_and_b32 v251, 0xffff0000, v39
v_mfma_f32_16x16x32_bf16 v[172:175], a[164:167], a[132:135], v[172:175]
s_waitcnt lgkmcnt(4)
buffer_load_dwordx4 v2, s[8:11], s25 offen sc1 lds
v_mfma_f32_16x16x32_bf16 v[176:179], a[168:171], a[128:131], v[176:179]
s_add_u32 s25, s25, 4096
ds_read_b128 a[156:159], v11 offset:39072
v_lshlrev_b32 v10, 16, v53
v_mfma_f32_16x16x32_bf16 v[180:183], a[168:171], a[132:135], v[180:183]
s_waitcnt lgkmcnt(4)
v_add_f32 v250, v250, v10
v_and_b32 v10, 0xffff0000, v53
v_mfma_f32_16x16x32_bf16 v[184:187], a[172:175], a[16:19], v[184:187]
s_add_u32 m0, s26, 59136
ds_read_b128 a[160:163], v11 offset:40128
v_add_f32 v251, v251, v10
v_mfma_f32_16x16x32_bf16 v[188:191], a[172:175], a[20:23], v[188:191]
s_waitcnt lgkmcnt(4)
buffer_load_dwordx4 v2, s[8:11], s25 offen sc1 lds
v_mfma_f32_16x16x32_bf16 v[192:195], a[144:147], a[16:19], v[192:195]
s_add_u32 s25, s25, 4096
ds_read_b128 a[164:167], v11 offset:41184
v_lshlrev_b32 v252, 16, v50
v_mfma_f32_16x16x32_bf16 v[196:199], a[144:147], a[20:23], v[196:199]
PADW3:
PAD6:
s_cbranch_execz PAD7
s_waitcnt lgkmcnt(4)
v_and_b32 v253, 0xffff0000, v50
v_lshlrev_b32 v10, 16, v54
v_mfma_f32_16x16x32_bf16 v[184:187], a[148:151], a[24:27], v[184:187]
s_add_u32 m0, s26, 63360
s_waitcnt vmcnt(19)
s_barrier
v_add_u32 v11, 65536, v11
ds_read_b128 a[168:171], v11 offset:2048
v_add_f32 v252, v252, v10
v_mfma_f32_16x16x32_bf16 v[188:191], a[148:151], a[28:31], v[188:191]
s_waitcnt lgkmcnt(4)
buffer_load_dwordx4 v2, s[8:11], s25 offen sc1 lds
v_mfma_f32_16x16x32_bf16 v[192:195], a[152:155], a[24:27], v[192:195]
s_add_u32 s25, s25, 4096
ds_read_b128 a[172:175], v11 offset:3104
v_and_b32 v10, 0xffff0000, v54
v_mfma_f32_16x16x32_bf16 v[196:199], a[152:155], a[28:31], v[196:199]
s_waitcnt lgkmcnt(4)
v_add_f32 v253, v253, v10
v_lshlrev_b32 v254, 16, v51
v_mfma_f32_16x16x32_bf16 v[184:187], a[156:159], a[32:35], v[184:187]
s_add_u32 m0, s26, 76032
ds_read_b128 a[144:147], v11 offset:4160
v_and_b32 v255, 0xffff0000, v51
v_mfma_f32_16x16x32_bf16 v[188:191], a[156:159], a[36:39], v[188:191]
s_waitcnt lgkmcnt(4)
buffer_load_dwordx4 v2, s[8:11], s25 offen sc1 lds
v_mfma_f32_16x16x32_bf16 v[192:195], a[160:163], a[32:35], v[192:195]
s_add_u32 s25, s25, 4096
ds_read_b128 a[148:151], v11 offset:5216
v_lshlrev_b32 v10, 16, v55
v_mfma_f32_16x16x32_bf16 v[196:199], a[160:163], a[36:39], v[196:199]
s_waitcnt lgkmcnt(4)
v_add_f32 v254, v254, v10
v_and_b32 v10, 0xffff0000, v55
v_mfma_f32_16x16x32_bf16 v[184:187], a[164:167], a[40:43], v[184:187]
s_add_u32 m0, s26, 80256
ds_read_b128 a[152:155], v11 offset:6272
v_add_f32 v255, v255, v10
v_mfma_f32_16x16x32_bf16 v[188:191], a[164:167], a[44:47], v[188:191]
s_waitcnt lgkmcnt(4)
buffer_load_dwordx4 v2, s[8:11], s25 offen sc1 lds
v_mfma_f32_16x16x32_bf16 v[192:195], a[168:171], a[40:43], v[192:195]
s_add_u32 s25, s25, 4096
ds_read_b128 a[156:159], v11 offset:7328
v_lshlrev_b32 v160, 16, v64
v_mfma_f32_16x16x32_bf16 v[196:199], a[168:171], a[44:47], v[196:199]
s_waitcnt lgkmcnt(4)
v_and_b32 v161, 0xffff0000, v64
v_lshlrev_b32 v10, 16, v68
v_mfma_f32_16x16x32_bf16 v[184:187], a[172:175], a[48:51], v[184:187]
s_add_u32 m0, s26, 84480
ds_read_b128 a[160:163], v11 offset:8384
v_add_f32 v160, v160, v10
v_mfma_f32_16x16x32_bf16 v[188:191], a[172:175], a[52:55], v[188:191]
s_waitcnt lgkmcnt(4)
buffer_load_dwordx4 v2, s[8:11], s25 offen sc1 lds
v_mfma_f32_16x16x32_bf16 v[192:195], a[144:147], a[48:51], v[192:195]
s_add_u32 s25, s25, 4096
ds_read_b128 a[164:167], v11 offset:9440
v_and_b32 v10, 0xffff0000, v68
v_mfma_f32_16x16x32_bf16 v[196:199], a[144:147], a[52:55], v[196:199]
s_waitcnt lgkmcnt(4)
v_add_f32 v161, v161, v10
v_lshlrev_b32 v162, 16, v65
v_mfma_f32_16x16x32_bf16 v[184:187], a[148:151], a[56:59], v[184:187]
s_add_u32 m0, s26, 88704
ds_read_b128 a[168:171], v11 offset:35840
v_and_b32 v163, 0xffff0000, v65
v_mfma_f32_16x16x32_bf16 v[188:191], a[148:151], a[60:63], v[188:191]
s_waitcnt lgkmcnt(4)
buffer_load_dwordx4 v2, s[8:11], s25 offen sc1 lds
v_mfma_f32_16x16x32_bf16 v[192:195], a[152:155], a[56:59], v[192:195]
s_add_u32 s25, s25, 4096
ds_read_b128 a[172:175], v11 offset:36896
v_lshlrev_b32 v10, 16, v69
v_mfma_f32_16x16x32_bf16 v[196:199], a[152:155], a[60:63], v[196:199]
s_waitcnt lgkmcnt(4)
v_add_f32 v162, v162, v10
v_and_b32 v10, 0xffff0000, v69
v_mfma_f32_16x16x32_bf16 v[184:187], a[156:159], a[64:67], v[184:187]
s_add_u32 m0, s26, 92928
ds_read_b128 a[144:147], v11 offset:37952
v_add_f32 v163, v163, v10
v_mfma_f32_16x16x32_bf16 v[188:191], a[156:159], a[68:71], v[188:191]
s_waitcnt lgkmcnt(4)
buffer_load_dwordx4 v2, s[8:11], s25 offen sc1 lds
v_mfma_f32_16x16x32_bf16 v[192:195], a[160:163], a[64:67], v[192:195]
s_add_u32 s25, s25, 4096
ds_read_b128 a[148:151], v11 offset:39008
v_lshlrev_b32 v164, 16, v66
v_mfma_f32_16x16x32_bf16 v[196:199], a[160:163], a[68:71], v[196:199]
s_waitcnt lgkmcnt(4)
v_and_b32 v165, 0xffff0000, v66
v_lshlrev_b32 v10, 16, v68
v_mfma_f32_16x16x32_bf16 v[184:187], a[164:167], a[72:75], v[184:187]
s_add_u32 m0, s26, 97152
ds_read_b128 a[152:155], v11 offset:40064
v_add_f32 v164, v164, v10
v_mfma_f32_16x16x32_bf16 v[188:191], a[164:167], a[76:79], v[188:191]
s_waitcnt lgkmcnt(4)
buffer_load_dwordx4 v2, s[8:11], s25 offen sc1 lds
v_mfma_f32_16x16x32_bf16 v[192:195], a[168:171], a[72:75], v[192:195]
s_add_u32 s25, s25, 4096
ds_read_b128 a[156:159], v11 offset:41120
v_and_b32 v10, 0xffff0000, v68
v_mfma_f32_16x16x32_bf16 v[196:199], a[168:171], a[76:79], v[196:199]
s_waitcnt lgkmcnt(4)
v_add_f32 v165, v165, v10
v_lshlrev_b32 v166, 16, v67
v_mfma_f32_16x16x32_bf16 v[184:187], a[172:175], a[80:83], v[184:187]
s_add_u32 m0, s26, 109824
ds_read_b128 a[160:163], v11 offset:42176
v_and_b32 v167, 0xffff0000, v67
v_mfma_f32_16x16x32_bf16 v[188:191], a[172:175], a[84:87], v[188:191]
s_waitcnt lgkmcnt(4)
buffer_load_dwordx4 v2, s[8:11], s25 offen sc1 lds
v_mfma_f32_16x16x32_bf16 v[192:195], a[144:147], a[80:83], v[192:195]
s_add_u32 s25, s25, 4096
ds_read_b128 a[164:167], v11 offset:43232
v_lshlrev_b32 v10, 16, v69
v_mfma_f32_16x16x32_bf16 v[196:199], a[144:147], a[84:87], v[196:199]
s_waitcnt lgkmcnt(4)
v_add_f32 v166, v166, v10
v_and_b32 v10, 0xffff0000, v69
v_mfma_f32_16x16x32_bf16 v[184:187], a[148:151], a[88:91], v[184:187]
s_add_u32 m0, s26, 114048
s_waitcnt vmcnt(23)
s_barrier
ds_read_b128 a[168:171], v11 offset:52736
v_add_f32 v167, v167, v10
v_mfma_f32_16x16x32_bf16 v[188:191], a[148:151], a[92:95], v[188:191]
s_waitcnt lgkmcnt(4)
buffer_load_dwordx4 v2, s[8:11], s25 offen sc1 lds
v_mfma_f32_16x16x32_bf16 v[192:195], a[152:155], a[88:91], v[192:195]
s_add_u32 s25, s25, 4096
ds_read_b128 a[172:175], v11 offset:53792
v_and_b32 v10, 15, v0
v_mfma_f32_16x16x32_bf16 v[196:199], a[152:155], a[92:95], v[196:199]
s_waitcnt lgkmcnt(4)
v_mul_u32_u24 v10, 2304, v10
v_add_u32 v80, v10, v9
v_mfma_f32_16x16x32_bf16 v[184:187], a[156:159], a[96:99], v[184:187]
s_add_u32 m0, s26, 0
ds_read_b128 a[144:147], v11 offset:54848
v_add_u32 v10, v10, v83
s_mul_i32 s91, s35, 1152
s_lshl_b32 s51, s23, 5
s_add_u32 s91, s91, s51
v_mfma_f32_16x16x32_bf16 v[188:191], a[156:159], a[100:103], v[188:191]
s_waitcnt lgkmcnt(4)
buffer_load_dwordx4 v2, s[8:11], s25 offen sc1 lds
v_mfma_f32_16x16x32_bf16 v[192:195], a[160:163], a[96:99], v[192:195]
s_add_u32 s25, s25, 4096
ds_read_b128 a[148:151], v11 offset:55904
v_cvt_pk_bf16_f32 v168, v168, v169
v_mfma_f32_16x16x32_bf16 v[196:199], a[160:163], a[100:103], v[196:199]
s_waitcnt lgkmcnt(4)
v_cvt_pk_bf16_f32 v169, v170, v171
v_cvt_pk_bf16_f32 v170, v176, v177
v_mfma_f32_16x16x32_bf16 v[184:187], a[164:167], a[104:107], v[184:187]
s_add_u32 m0, s26, 4224
ds_read_b128 a[152:155], v11 offset:56960
v_cvt_pk_bf16_f32 v171, v178, v179
v_mfma_f32_16x16x32_bf16 v[188:191], a[164:167], a[108:111], v[188:191]
s_waitcnt lgkmcnt(4)
buffer_load_dwordx4 v2, s[8:11], s25 offen sc1 lds
v_mfma_f32_16x16x32_bf16 v[192:195], a[168:171], a[104:107], v[192:195]
s_add_u32 s25, s25, 4096
ds_read_b128 a[156:159], v11 offset:58016
buffer_store_dwordx4 v[168:171], v1, s[8:11], s53 offen offset:0 sc1
v_mfma_f32_16x16x32_bf16 v[196:199], a[168:171], a[108:111], v[196:199]
s_waitcnt lgkmcnt(4)
v_cvt_pk_bf16_f32 v172, v172, v173
v_cvt_pk_bf16_f32 v173, v174, v175
v_mfma_f32_16x16x32_bf16 v[184:187], a[172:175], a[112:115], v[184:187]
s_add_u32 m0, s26, 33792
ds_read_b128 a[160:163], v11 offset:59072
v_cvt_pk_bf16_f32 v174, v180, v181
v_mfma_f32_16x16x32_bf16 v[188:191], a[172:175], a[116:119], v[188:191]
s_waitcnt lgkmcnt(4)
buffer_load_dwordx4 v2, s[8:11], s25 offen sc1 lds
v_mfma_f32_16x16x32_bf16 v[192:195], a[144:147], a[112:115], v[192:195]
s_add_u32 s25, s25, 4096
ds_read_b128 a[164:167], v11 offset:60128
v_cvt_pk_bf16_f32 v175, v182, v183
v_mfma_f32_16x16x32_bf16 v[196:199], a[144:147], a[116:119], v[196:199]
s_waitcnt lgkmcnt(4)
buffer_store_dwordx4 v[172:175], v1, s[8:11], s53 offen offset:1024 sc1
v_mfma_f32_16x16x32_bf16 v[184:187], a[148:151], a[120:123], v[184:187]
ds_read_b128 a[168:171], v11 offset:61184
v_mfma_f32_16x16x32_bf16 v[188:191], a[148:151], a[124:127], v[188:191]
s_waitcnt lgkmcnt(4)
v_mfma_f32_16x16x32_bf16 v[192:195], a[152:155], a[120:123], v[192:195]
ds_read_b128 a[172:175], v11 offset:62240
v_mfma_f32_16x16x32_bf16 v[196:199], a[152:155], a[124:127], v[196:199]
s_waitcnt lgkmcnt(4)
v_mfma_f32_16x16x32_bf16 v[184:187], a[156:159], a[128:131], v[184:187]
ds_read_b128 a[144:147], v11 offset:63296
v_mfma_f32_16x16x32_bf16 v[188:191], a[156:159], a[132:135], v[188:191]
s_waitcnt lgkmcnt(4)
v_mfma_f32_16x16x32_bf16 v[192:195], a[160:163], a[128:131], v[192:195]
ds_read_b128 a[148:151], v11 offset:64352
v_mfma_f32_16x16x32_bf16 v[196:199], a[160:163], a[132:135], v[196:199]
s_waitcnt lgkmcnt(4)
v_mfma_f32_16x16x32_bf16 v[200:203], a[164:167], a[16:19], v[200:203]
ds_read_b128 a[152:155], v11 offset:65408
v_mfma_f32_16x16x32_bf16 v[204:207], a[164:167], a[20:23], v[204:207]
s_waitcnt lgkmcnt(4)
v_mfma_f32_16x16x32_bf16 v[208:211], a[168:171], a[16:19], v[208:211]
v_add_u32 v11, 65536, v11
ds_read_b128 a[156:159], v11 offset:928
v_mfma_f32_16x16x32_bf16 v[212:215], a[168:171], a[20:23], v[212:215]
s_waitcnt lgkmcnt(4)
v_mfma_f32_16x16x32_bf16 v[200:203], a[172:175], a[24:27], v[200:203]
ds_read_b128 a[160:163], v11 offset:1984
v_mfma_f32_16x16x32_bf16 v[204:207], a[172:175], a[28:31], v[204:207]
s_waitcnt lgkmcnt(4)
v_mfma_f32_16x16x32_bf16 v[208:211], a[144:147], a[24:27], v[208:211]
ds_read_b128 a[164:167], v11 offset:3040
v_cvt_pk_bf16_f32 v184, v184, v185
v_mfma_f32_16x16x32_bf16 v[212:215], a[144:147], a[28:31], v[212:215]
s_waitcnt lgkmcnt(4)
v_cvt_pk_bf16_f32 v185, v186, v187
v_cvt_pk_bf16_f32 v186, v192, v193
v_mfma_f32_16x16x32_bf16 v[200:203], a[148:151], a[32:35], v[200:203]
s_waitcnt vmcnt(25)
s_barrier
ds_read_b128 a[168:171], v11 offset:4096
v_cvt_pk_bf16_f32 v187, v194, v195
v_mfma_f32_16x16x32_bf16 v[204:207], a[148:151], a[36:39], v[204:207]
s_waitcnt lgkmcnt(4)
buffer_store_dwordx4 v[184:187], v1, s[8:11], s54 offen offset:0 sc1
v_cvt_pk_bf16_f32 v188, v188, v189
v_mfma_f32_16x16x32_bf16 v[208:211], a[152:155], a[32:35], v[208:211]
ds_read_b128 a[172:175], v11 offset:5152
v_cvt_pk_bf16_f32 v189, v190, v191
v_mfma_f32_16x16x32_bf16 v[212:215], a[152:155], a[36:39], v[212:215]
s_waitcnt lgkmcnt(4)
v_cvt_pk_bf16_f32 v190, v196, v197
v_cvt_pk_bf16_f32 v191, v198, v199
v_mfma_f32_16x16x32_bf16 v[200:203], a[156:159], a[40:43], v[200:203]
ds_read_b128 a[144:147], v11 offset:6208
v_mfma_f32_16x16x32_bf16 v[204:207], a[156:159], a[44:47], v[204:207]
s_waitcnt lgkmcnt(4)
v_mfma_f32_16x16x32_bf16 v[208:211], a[160:163], a[40:43], v[208:211]
ds_read_b128 a[148:151], v11 offset:7264
v_mfma_f32_16x16x32_bf16 v[212:215], a[160:163], a[44:47], v[212:215]
s_waitcnt lgkmcnt(4)
v_mfma_f32_16x16x32_bf16 v[200:203], a[164:167], a[48:51], v[200:203]
ds_read_b128 a[152:155], v11 offset:8320
v_mfma_f32_16x16x32_bf16 v[204:207], a[164:167], a[52:55], v[204:207]
s_waitcnt lgkmcnt(4)
v_mfma_f32_16x16x32_bf16 v[208:211], a[168:171], a[48:51], v[208:211]
ds_read_b128 a[156:159], v11 offset:9376
v_mfma_f32_16x16x32_bf16 v[212:215], a[168:171], a[52:55], v[212:215]
s_waitcnt lgkmcnt(4)
v_mfma_f32_16x16x32_bf16 v[200:203], a[172:175], a[56:59], v[200:203]
ds_read_b128 a[160:163], v11 offset:10432
v_mfma_f32_16x16x32_bf16 v[204:207], a[172:175], a[60:63], v[204:207]
s_waitcnt lgkmcnt(4)
v_mfma_f32_16x16x32_bf16 v[208:211], a[144:147], a[56:59], v[208:211]
ds_read_b128 a[164:167], v11 offset:11488
v_mfma_f32_16x16x32_bf16 v[212:215], a[144:147], a[60:63], v[212:215]
s_waitcnt lgkmcnt(4)
v_mfma_f32_16x16x32_bf16 v[200:203], a[148:151], a[64:67], v[200:203]
ds_read_b128 a[168:171], v11 offset:12544
v_mfma_f32_16x16x32_bf16 v[204:207], a[148:151], a[68:71], v[204:207]
s_waitcnt lgkmcnt(4)
v_mfma_f32_16x16x32_bf16 v[208:211], a[152:155], a[64:67], v[208:211]
ds_read_b128 a[172:175], v11 offset:13600
v_mfma_f32_16x16x32_bf16 v[212:215], a[152:155], a[68:71], v[212:215]
s_waitcnt lgkmcnt(4)
v_mfma_f32_16x16x32_bf16 v[200:203], a[156:159], a[72:75], v[200:203]
ds_read_b128 a[144:147], v11 offset:14656
v_mfma_f32_16x16x32_bf16 v[204:207], a[156:159], a[76:79], v[204:207]
s_waitcnt lgkmcnt(4)
v_mfma_f32_16x16x32_bf16 v[208:211], a[160:163], a[72:75], v[208:211]
ds_read_b128 a[148:151], v11 offset:15712
v_mfma_f32_16x16x32_bf16 v[212:215], a[160:163], a[76:79], v[212:215]
s_waitcnt lgkmcnt(4)
v_mfma_f32_16x16x32_bf16 v[200:203], a[164:167], a[80:83], v[200:203]
ds_read_b128 a[152:155], v11 offset:16768
v_mfma_f32_16x16x32_bf16 v[204:207], a[164:167], a[84:87], v[204:207]
s_waitcnt lgkmcnt(4)
v_mfma_f32_16x16x32_bf16 v[208:211], a[168:171], a[80:83], v[208:211]
ds_read_b128 a[156:159], v11 offset:17824
buffer_store_dwordx4 v[188:191], v1, s[8:11], s54 offen offset:1024 sc1
v_mfma_f32_16x16x32_bf16 v[212:215], a[168:171], a[84:87], v[212:215]
s_waitcnt lgkmcnt(4)
v_mfma_f32_16x16x32_bf16 v[200:203], a[172:175], a[88:91], v[200:203]
ds_read_b128 a[160:163], v11 offset:18880
v_mfma_f32_16x16x32_bf16 v[204:207], a[172:175], a[92:95], v[204:207]
s_waitcnt lgkmcnt(4)
v_mfma_f32_16x16x32_bf16 v[208:211], a[144:147], a[88:91], v[208:211]
ds_read_b128 a[164:167], v11 offset:19936
v_mfma_f32_16x16x32_bf16 v[212:215], a[144:147], a[92:95], v[212:215]
s_waitcnt lgkmcnt(4)
v_mfma_f32_16x16x32_bf16 v[200:203], a[148:151], a[96:99], v[200:203]
s_waitcnt vmcnt(23)
s_barrier
v_add_u32 v11, 4294836224, v11
ds_read_b128 a[168:171], v11 offset:8448
v_mfma_f32_16x16x32_bf16 v[204:207], a[148:151], a[100:103], v[204:207]
s_waitcnt lgkmcnt(4)
v_mfma_f32_16x16x32_bf16 v[208:211], a[152:155], a[96:99], v[208:211]
ds_read_b128 a[172:175], v11 offset:9504
v_mfma_f32_16x16x32_bf16 v[212:215], a[152:155], a[100:103], v[212:215]
s_waitcnt lgkmcnt(4)
v_mfma_f32_16x16x32_bf16 v[200:203], a[156:159], a[104:107], v[200:203]
ds_read_b128 a[144:147], v11 offset:10560
v_mfma_f32_16x16x32_bf16 v[204:207], a[156:159], a[108:111], v[204:207]
s_waitcnt lgkmcnt(4)
v_mfma_f32_16x16x32_bf16 v[208:211], a[160:163], a[104:107], v[208:211]
ds_read_b128 a[148:151], v11 offset:11616
v_mfma_f32_16x16x32_bf16 v[212:215], a[160:163], a[108:111], v[212:215]
s_waitcnt lgkmcnt(4)
v_mfma_f32_16x16x32_bf16 v[200:203], a[164:167], a[112:115], v[200:203]
ds_read_b128 a[152:155], v11 offset:12672
v_mfma_f32_16x16x32_bf16 v[204:207], a[164:167], a[116:119], v[204:207]
s_waitcnt lgkmcnt(4)
v_mfma_f32_16x16x32_bf16 v[208:211], a[168:171], a[112:115], v[208:211]
ds_read_b128 a[156:159], v11 offset:13728
v_mfma_f32_16x16x32_bf16 v[212:215], a[168:171], a[116:119], v[212:215]
s_waitcnt lgkmcnt(4)
v_mfma_f32_16x16x32_bf16 v[200:203], a[172:175], a[120:123], v[200:203]
ds_read_b128 a[160:163], v11 offset:14784
v_mfma_f32_16x16x32_bf16 v[204:207], a[172:175], a[124:127], v[204:207]
s_waitcnt lgkmcnt(4)
v_mfma_f32_16x16x32_bf16 v[208:211], a[144:147], a[120:123], v[208:211]
ds_read_b128 a[164:167], v11 offset:15840
v_mfma_f32_16x16x32_bf16 v[212:215], a[144:147], a[124:127], v[212:215]
s_waitcnt lgkmcnt(4)
v_mfma_f32_16x16x32_bf16 v[200:203], a[148:151], a[128:131], v[200:203]
ds_read_b128 a[168:171], v11 offset:16896
v_mfma_f32_16x16x32_bf16 v[204:207], a[148:151], a[132:135], v[204:207]
s_waitcnt lgkmcnt(4)
v_mfma_f32_16x16x32_bf16 v[208:211], a[152:155], a[128:131], v[208:211]
ds_read_b128 a[172:175], v11 offset:17952
v_mfma_f32_16x16x32_bf16 v[212:215], a[152:155], a[132:135], v[212:215]
s_waitcnt lgkmcnt(4)
v_mfma_f32_16x16x32_bf16 v[232:235], a[156:159], a[16:19], v[232:235]
ds_read_b128 a[144:147], v11 offset:19008
v_mfma_f32_16x16x32_bf16 v[236:239], a[156:159], a[20:23], v[236:239]
s_waitcnt lgkmcnt(4)
v_mfma_f32_16x16x32_bf16 v[232:235], a[160:163], a[24:27], v[232:235]
ds_read_b128 a[148:151], v11 offset:20064
v_mfma_f32_16x16x32_bf16 v[236:239], a[160:163], a[28:31], v[236:239]
s_waitcnt lgkmcnt(4)
v_mfma_f32_16x16x32_bf16 v[232:235], a[164:167], a[32:35], v[232:235]
ds_read_b128 a[152:155], v11 offset:21120
v_mfma_f32_16x16x32_bf16 v[236:239], a[164:167], a[36:39], v[236:239]
s_waitcnt lgkmcnt(4)
v_mfma_f32_16x16x32_bf16 v[232:235], a[168:171], a[40:43], v[232:235]
ds_read_b128 a[156:159], v11 offset:22176
v_cvt_pk_bf16_f32 v200, v200, v201
v_mfma_f32_16x16x32_bf16 v[236:239], a[168:171], a[44:47], v[236:239]
s_waitcnt lgkmcnt(4)
v_cvt_pk_bf16_f32 v201, v202, v203
v_cvt_pk_bf16_f32 v202, v208, v209
v_mfma_f32_16x16x32_bf16 v[232:235], a[172:175], a[48:51], v[232:235]
ds_read_b128 a[160:163], v11 offset:23232
v_cvt_pk_bf16_f32 v203, v210, v211
v_mfma_f32_16x16x32_bf16 v[236:239], a[172:175], a[52:55], v[236:239]
s_waitcnt lgkmcnt(4)
buffer_store_dwordx4 v[200:203], v1, s[8:11], s55 offen offset:0 sc1
v_cvt_pk_bf16_f32 v204, v204, v205
v_mfma_f32_16x16x32_bf16 v[232:235], a[144:147], a[56:59], v[232:235]
ds_read_b128 a[164:167], v11 offset:24288
v_cvt_pk_bf16_f32 v205, v206, v207
v_mfma_f32_16x16x32_bf16 v[236:239], a[144:147], a[60:63], v[236:239]
s_waitcnt lgkmcnt(4)
v_cvt_pk_bf16_f32 v206, v212, v213
v_cvt_pk_bf16_f32 v207, v214, v215
v_mfma_f32_16x16x32_bf16 v[232:235], a[148:151], a[64:67], v[232:235]
s_waitcnt vmcnt(20)
s_barrier
ds_read_b128 a[168:171], v11 offset:25344
v_mfma_f32_16x16x32_bf16 v[236:239], a[148:151], a[68:71], v[236:239]
s_waitcnt lgkmcnt(4)
v_mfma_f32_16x16x32_bf16 v[232:235], a[152:155], a[72:75], v[232:235]
ds_read_b128 a[172:175], v11 offset:26400
v_mfma_f32_16x16x32_bf16 v[236:239], a[152:155], a[76:79], v[236:239]
s_waitcnt lgkmcnt(4)
v_mfma_f32_16x16x32_bf16 v[232:235], a[156:159], a[80:83], v[232:235]
ds_read_b128 a[144:147], v11 offset:27456
v_mfma_f32_16x16x32_bf16 v[236:239], a[156:159], a[84:87], v[236:239]
s_waitcnt lgkmcnt(4)
v_mfma_f32_16x16x32_bf16 v[232:235], a[160:163], a[88:91], v[232:235]
ds_read_b128 a[148:151], v11 offset:28512
v_mfma_f32_16x16x32_bf16 v[236:239], a[160:163], a[92:95], v[236:239]
s_waitcnt lgkmcnt(4)
v_mfma_f32_16x16x32_bf16 v[232:235], a[164:167], a[96:99], v[232:235]
ds_read_b128 a[152:155], v11 offset:29568
v_mfma_f32_16x16x32_bf16 v[236:239], a[164:167], a[100:103], v[236:239]
s_waitcnt lgkmcnt(4)
v_mfma_f32_16x16x32_bf16 v[232:235], a[168:171], a[104:107], v[232:235]
ds_read_b128 a[156:159], v11 offset:30624
v_mfma_f32_16x16x32_bf16 v[236:239], a[168:171], a[108:111], v[236:239]
s_waitcnt lgkmcnt(4)
v_mfma_f32_16x16x32_bf16 v[232:235], a[172:175], a[112:115], v[232:235]
ds_read_b128 a[160:163], v11 offset:31680
v_mfma_f32_16x16x32_bf16 v[236:239], a[172:175], a[116:119], v[236:239]
s_waitcnt lgkmcnt(4)
v_mfma_f32_16x16x32_bf16 v[232:235], a[144:147], a[120:123], v[232:235]
ds_read_b128 a[164:167], v11 offset:32736
v_mfma_f32_16x16x32_bf16 v[236:239], a[144:147], a[124:127], v[236:239]
s_waitcnt lgkmcnt(4)
v_mfma_f32_16x16x32_bf16 v[232:235], a[148:151], a[128:131], v[232:235]
ds_read_b128 a[168:171], v11 offset:42240
v_mfma_f32_16x16x32_bf16 v[236:239], a[148:151], a[132:135], v[236:239]
s_waitcnt lgkmcnt(4)
v_mfma_f32_16x16x32_bf16 v[216:219], a[152:155], v[24:27], 0
ds_read_b128 a[172:175], v11 offset:43296
v_mfma_f32_16x16x32_bf16 v[220:223], a[152:155], v[28:31], 0
s_waitcnt lgkmcnt(4)
v_mfma_f32_16x16x32_bf16 v[224:227], a[156:159], v[24:27], 0
ds_read_b128 a[144:147], v11 offset:44352
v_mfma_f32_16x16x32_bf16 v[228:231], a[156:159], v[28:31], 0
s_waitcnt lgkmcnt(4)
v_mfma_f32_16x16x32_bf16 v[216:219], a[160:163], v[40:43], v[216:219]
ds_read_b128 a[148:151], v11 offset:45408
buffer_store_dwordx4 v[204:207], v1, s[8:11], s55 offen offset:1024 sc1
v_mfma_f32_16x16x32_bf16 v[220:223], a[160:163], v[44:47], v[220:223]
s_waitcnt lgkmcnt(4)
v_mfma_f32_16x16x32_bf16 v[224:227], a[164:167], v[40:43], v[224:227]
ds_read_b128 a[152:155], v11 offset:46464
v_cvt_pk_bf16_f32 v32, v232, v233
v_mfma_f32_16x16x32_bf16 v[228:231], a[164:167], v[44:47], v[228:231]
s_waitcnt lgkmcnt(4)
v_cvt_pk_bf16_f32 v33, v234, v235
v_cvt_pk_bf16_f32 v34, v236, v237
v_mfma_f32_16x16x32_bf16 v[216:219], a[168:171], v[56:59], v[216:219]
ds_read_b128 a[156:159], v11 offset:47520
v_cvt_pk_bf16_f32 v35, v238, v239
v_mfma_f32_16x16x32_bf16 v[220:223], a[168:171], v[60:63], v[220:223]
s_waitcnt lgkmcnt(4)
buffer_store_dwordx4 v[32:35], v1, s[8:11], s57 offen sc1
v_mfma_f32_16x16x32_bf16 v[224:227], a[172:175], v[56:59], v[224:227]
ds_read_b128 a[160:163], v11 offset:48576
v_mfma_f32_16x16x32_bf16 v[228:231], a[172:175], v[60:63], v[228:231]
s_waitcnt lgkmcnt(4)
v_mfma_f32_16x16x32_bf16 v[216:219], a[144:147], v[72:75], v[216:219]
ds_read_b128 a[164:167], v11 offset:49632
v_mfma_f32_16x16x32_bf16 v[220:223], a[144:147], v[76:79], v[220:223]
s_waitcnt lgkmcnt(4)
v_mfma_f32_16x16x32_bf16 v[224:227], a[148:151], v[72:75], v[224:227]
s_waitcnt vmcnt(18)
s_barrier
ds_read_b128 a[168:171], v11 offset:50688
v_mfma_f32_16x16x32_bf16 v[228:231], a[148:151], v[76:79], v[228:231]
s_waitcnt lgkmcnt(4)
v_mfma_f32_16x16x32_bf16 v[216:219], a[152:155], v[88:91], v[216:219]
ds_read_b128 a[172:175], v11 offset:51744
v_mfma_f32_16x16x32_bf16 v[220:223], a[152:155], v[92:95], v[220:223]
s_waitcnt lgkmcnt(4)
v_mfma_f32_16x16x32_bf16 v[224:227], a[156:159], v[88:91], v[224:227]
ds_read_b128 a[144:147], v11 offset:52800
v_mfma_f32_16x16x32_bf16 v[228:231], a[156:159], v[92:95], v[228:231]
s_waitcnt lgkmcnt(4)
v_mfma_f32_16x16x32_bf16 v[216:219], a[160:163], v[104:107], v[216:219]
ds_read_b128 a[148:151], v11 offset:53856
v_mfma_f32_16x16x32_bf16 v[220:223], a[160:163], v[108:111], v[220:223]
s_waitcnt lgkmcnt(4)
v_mfma_f32_16x16x32_bf16 v[224:227], a[164:167], v[104:107], v[224:227]
ds_read_b128 a[152:155], v11 offset:54912
v_mfma_f32_16x16x32_bf16 v[228:231], a[164:167], v[108:111], v[228:231]
s_waitcnt lgkmcnt(4)
v_mfma_f32_16x16x32_bf16 v[216:219], a[168:171], v[120:123], v[216:219]
ds_read_b128 a[156:159], v11 offset:55968
v_mfma_f32_16x16x32_bf16 v[220:223], a[168:171], v[124:127], v[220:223]
s_waitcnt lgkmcnt(4)
v_mfma_f32_16x16x32_bf16 v[224:227], a[172:175], v[120:123], v[224:227]
ds_read_b128 a[160:163], v11 offset:57024
v_mfma_f32_16x16x32_bf16 v[228:231], a[172:175], v[124:127], v[228:231]
s_waitcnt lgkmcnt(4)
v_mfma_f32_16x16x32_bf16 v[216:219], a[144:147], v[136:139], v[216:219]
ds_read_b128 a[164:167], v11 offset:58080
v_mfma_f32_16x16x32_bf16 v[220:223], a[144:147], v[140:143], v[220:223]
s_waitcnt lgkmcnt(4)
buffer_load_dword v7, v15, s[8:11], s34 offen sc1
v_mfma_f32_16x16x32_bf16 v[224:227], a[148:151], v[136:139], v[224:227]
ds_read_b128 a[168:171], v11 offset:59136
v_mfma_f32_16x16x32_bf16 v[228:231], a[148:151], v[140:143], v[228:231]
s_waitcnt lgkmcnt(4)
v_mfma_f32_16x16x32_bf16 v[216:219], a[152:155], v[152:155], v[216:219]
ds_read_b128 a[172:175], v11 offset:60192
v_mfma_f32_16x16x32_bf16 v[220:223], a[152:155], v[156:159], v[220:223]
s_waitcnt lgkmcnt(4)
v_mfma_f32_16x16x32_bf16 v[224:227], a[156:159], v[152:155], v[224:227]
ds_read_b128 a[144:147], v11 offset:61248
v_mfma_f32_16x16x32_bf16 v[228:231], a[156:159], v[156:159], v[228:231]
s_waitcnt lgkmcnt(4)
v_mfma_f32_16x16x32_bf16 v[216:219], a[160:163], a[176:179], v[216:219]
ds_read_b128 a[148:151], v11 offset:62304
v_mfma_f32_16x16x32_bf16 v[220:223], a[160:163], a[180:183], v[220:223]
s_waitcnt lgkmcnt(4)
v_mfma_f32_16x16x32_bf16 v[224:227], a[164:167], a[176:179], v[224:227]
ds_read_b128 a[152:155], v11 offset:63360
v_mfma_f32_16x16x32_bf16 v[228:231], a[164:167], a[180:183], v[228:231]
s_waitcnt lgkmcnt(4)
v_mfma_f32_16x16x32_bf16 v[216:219], a[168:171], a[184:187], v[216:219]
ds_read_b128 a[156:159], v11 offset:64416
v_mfma_f32_16x16x32_bf16 v[220:223], a[168:171], a[188:191], v[220:223]
s_waitcnt lgkmcnt(4)
v_mfma_f32_16x16x32_bf16 v[224:227], a[172:175], a[184:187], v[224:227]
ds_read_b128 a[160:163], v11 offset:65472
v_mfma_f32_16x16x32_bf16 v[228:231], a[172:175], a[188:191], v[228:231]
s_waitcnt lgkmcnt(4)
v_mfma_f32_16x16x32_bf16 v[216:219], a[144:147], a[192:195], v[216:219]
v_add_u32 v11, 65536, v11
ds_read_b128 a[164:167], v11 offset:992
v_mfma_f32_16x16x32_bf16 v[220:223], a[144:147], a[196:199], v[220:223]
s_waitcnt lgkmcnt(4)
v_mfma_f32_16x16x32_bf16 v[224:227], a[148:151], a[192:195], v[224:227]
s_waitcnt vmcnt(15)
s_barrier
ds_read_b128 a[168:171], v11 offset:10496
v_mfma_f32_16x16x32_bf16 v[228:231], a[148:151], a[196:199], v[228:231]
s_waitcnt lgkmcnt(4)
v_mfma_f32_16x16x32_bf16 v[216:219], a[152:155], a[200:203], v[216:219]
ds_read_b128 a[172:175], v11 offset:11552
v_mfma_f32_16x16x32_bf16 v[220:223], a[152:155], a[204:207], v[220:223]
s_waitcnt lgkmcnt(4)
v_mfma_f32_16x16x32_bf16 v[224:227], a[156:159], a[200:203], v[224:227]
ds_read_b128 a[144:147], v11 offset:12608
v_mfma_f32_16x16x32_bf16 v[228:231], a[156:159], a[204:207], v[228:231]
s_waitcnt lgkmcnt(4)
v_mfma_f32_16x16x32_bf16 v[216:219], a[160:163], a[208:211], v[216:219]
ds_read_b128 a[148:151], v11 offset:13664
v_mfma_f32_16x16x32_bf16 v[220:223], a[160:163], a[212:215], v[220:223]
s_waitcnt lgkmcnt(4)
v_mfma_f32_16x16x32_bf16 v[224:227], a[164:167], a[208:211], v[224:227]
ds_read_b128 a[152:155], v11 offset:14720
v_mfma_f32_16x16x32_bf16 v[228:231], a[164:167], a[212:215], v[228:231]
s_waitcnt lgkmcnt(4)
v_mfma_f32_16x16x32_bf16 v[216:219], a[168:171], a[216:219], v[216:219]
ds_read_b128 a[156:159], v11 offset:15776
v_mfma_f32_16x16x32_bf16 v[220:223], a[168:171], a[220:223], v[220:223]
s_waitcnt lgkmcnt(4)
v_mfma_f32_16x16x32_bf16 v[224:227], a[172:175], a[216:219], v[224:227]
ds_read_b128 a[160:163], v11 offset:16832
v_mfma_f32_16x16x32_bf16 v[228:231], a[172:175], a[220:223], v[228:231]
s_waitcnt lgkmcnt(4)
s_waitcnt vmcnt(1)
v_mov_b32 v14, s7
buffer_store_dword v14, v4, s[8:11], s32 offen sc1
v_mfma_f32_16x16x32_bf16 v[216:219], a[144:147], a[224:227], v[216:219]
s_waitcnt vmcnt(1)
v_cmp_ne_u32 vcc, s7, v7
s_cbranch_vccz L3_try0
L3_try0_ret:
ds_read_b128 a[164:167], v11 offset:17888
v_mfma_f32_16x16x32_bf16 v[220:223], a[144:147], a[228:231], v[220:223]
s_waitcnt lgkmcnt(4)
v_mfma_f32_16x16x32_bf16 v[224:227], a[148:151], a[224:227], v[224:227]
ds_read_b128 a[168:171], v11 offset:18944
v_mfma_f32_16x16x32_bf16 v[228:231], a[148:151], a[228:231], v[228:231]
s_waitcnt lgkmcnt(4)
v_mfma_f32_16x16x32_bf16 v[216:219], a[152:155], a[232:235], v[216:219]
ds_read_b128 a[172:175], v11 offset:20000
v_mfma_f32_16x16x32_bf16 v[220:223], a[152:155], a[236:239], v[220:223]
s_waitcnt lgkmcnt(4)
v_mfma_f32_16x16x32_bf16 v[224:227], a[156:159], a[232:235], v[224:227]
ds_read_b128 a[144:147], v11 offset:21056
v_mfma_f32_16x16x32_bf16 v[228:231], a[156:159], a[236:239], v[228:231]
s_waitcnt lgkmcnt(4)
v_mfma_f32_16x16x32_bf16 v[216:219], a[160:163], a[240:243], v[216:219]
ds_read_b128 a[148:151], v11 offset:22112
v_mfma_f32_16x16x32_bf16 v[220:223], a[160:163], a[244:247], v[220:223]
s_waitcnt lgkmcnt(4)
v_mfma_f32_16x16x32_bf16 v[224:227], a[164:167], a[240:243], v[224:227]
ds_read_b128 a[152:155], v11 offset:23168
v_mfma_f32_16x16x32_bf16 v[228:231], a[164:167], a[244:247], v[228:231]
s_waitcnt lgkmcnt(4)
v_mfma_f32_16x16x32_bf16 v[216:219], a[168:171], a[248:251], v[216:219]
ds_read_b128 a[156:159], v11 offset:24224
v_mfma_f32_16x16x32_bf16 v[220:223], a[168:171], a[252:255], v[220:223]
s_waitcnt lgkmcnt(4)
v_mfma_f32_16x16x32_bf16 v[224:227], a[172:175], a[248:251], v[224:227]
ds_read_b128 a[160:163], v11 offset:25280
v_mfma_f32_16x16x32_bf16 v[228:231], a[172:175], a[252:255], v[228:231]
s_waitcnt lgkmcnt(4)
v_mfma_f32_16x16x32_bf16 v[216:219], a[144:147], a[0:3], v[216:219]
ds_read_b128 a[164:167], v11 offset:26336
v_mfma_f32_16x16x32_bf16 v[220:223], a[144:147], a[4:7], v[220:223]
s_waitcnt lgkmcnt(4)
v_mfma_f32_16x16x32_bf16 v[224:227], a[148:151], a[0:3], v[224:227]
s_barrier
ds_read_b128 a[168:171], v11 offset:27392
v_mfma_f32_16x16x32_bf16 v[228:231], a[148:151], a[4:7], v[228:231]
s_waitcnt lgkmcnt(4)
v_mfma_f32_16x16x32_bf16 v[216:219], a[152:155], a[8:11], v[216:219]
PAD7:
s_cbranch_execz PAD_ret
ds_read_b128 a[172:175], v11 offset:28448
v_mfma_f32_16x16x32_bf16 v[220:223], a[152:155], a[12:15], v[220:223]
s_waitcnt lgkmcnt(4)
v_mfma_f32_16x16x32_bf16 v[224:227], a[156:159], a[8:11], v[224:227]
ds_read_b128 a[144:147], v11 offset:29504
v_mfma_f32_16x16x32_bf16 v[228:231], a[156:159], a[12:15], v[228:231]
s_waitcnt lgkmcnt(4)
v_mfma_f32_16x16x32_bf16 v[216:219], a[160:163], a[16:19], v[216:219]
ds_read_b128 a[148:151], v11 offset:30560
v_mfma_f32_16x16x32_bf16 v[220:223], a[160:163], a[20:23], v[220:223]
s_waitcnt lgkmcnt(4)
v_mfma_f32_16x16x32_bf16 v[224:227], a[164:167], a[16:19], v[224:227]
ds_read_b128 a[152:155], v11 offset:31616
v_mfma_f32_16x16x32_bf16 v[228:231], a[164:167], a[20:23], v[228:231]
s_waitcnt lgkmcnt(4)
v_mfma_f32_16x16x32_bf16 v[216:219], a[168:171], a[24:27], v[216:219]
ds_read_b128 a[156:159], v11 offset:32672
v_mfma_f32_16x16x32_bf16 v[220:223], a[168:171], a[28:31], v[220:223]
s_waitcnt lgkmcnt(4)
v_mfma_f32_16x16x32_bf16 v[224:227], a[172:175], a[24:27], v[224:227]
ds_read_b128 a[160:163], v11 offset:33728
v_mfma_f32_16x16x32_bf16 v[228:231], a[172:175], a[28:31], v[228:231]
s_waitcnt lgkmcnt(4)
v_mfma_f32_16x16x32_bf16 v[216:219], a[144:147], a[32:35], v[216:219]
ds_read_b128 a[164:167], v11 offset:34784
v_mfma_f32_16x16x32_bf16 v[220:223], a[144:147], a[36:39], v[220:223]
s_waitcnt lgkmcnt(4)
v_mfma_f32_16x16x32_bf16 v[224:227], a[148:151], a[32:35], v[224:227]
ds_read_b128 a[168:171], v11 offset:44288
v_mfma_f32_16x16x32_bf16 v[228:231], a[148:151], a[36:39], v[228:231]
s_waitcnt lgkmcnt(4)
v_mfma_f32_16x16x32_bf16 v[216:219], a[152:155], a[40:43], v[216:219]
ds_read_b128 a[172:175], v11 offset:45344
v_mfma_f32_16x16x32_bf16 v[220:223], a[152:155], a[44:47], v[220:223]
s_waitcnt lgkmcnt(4)
v_mfma_f32_16x16x32_bf16 v[224:227], a[156:159], a[40:43], v[224:227]
ds_read_b128 a[144:147], v11 offset:46400
v_mfma_f32_16x16x32_bf16 v[228:231], a[156:159], a[44:47], v[228:231]
s_waitcnt lgkmcnt(4)
v_mfma_f32_16x16x32_bf16 v[216:219], a[160:163], a[48:51], v[216:219]
ds_read_b128 a[148:151], v11 offset:47456
v_mfma_f32_16x16x32_bf16 v[220:223], a[160:163], a[52:55], v[220:223]
s_waitcnt lgkmcnt(4)
v_mfma_f32_16x16x32_bf16 v[224:227], a[164:167], a[48:51], v[224:227]
ds_read_b128 a[152:155], v11 offset:48512
v_mfma_f32_16x16x32_bf16 v[228:231], a[164:167], a[52:55], v[228:231]
s_waitcnt lgkmcnt(4)
v_mfma_f32_16x16x32_bf16 v[216:219], a[168:171], a[56:59], v[216:219]
ds_read_b128 a[156:159], v11 offset:49568
v_mfma_f32_16x16x32_bf16 v[220:223], a[168:171], a[60:63], v[220:223]
s_waitcnt lgkmcnt(4)
v_mfma_f32_16x16x32_bf16 v[224:227], a[172:175], a[56:59], v[224:227]
ds_read_b128 a[160:163], v11 offset:50624
v_mfma_f32_16x16x32_bf16 v[228:231], a[172:175], a[60:63], v[228:231]
s_waitcnt lgkmcnt(4)
v_mfma_f32_16x16x32_bf16 v[216:219], a[144:147], a[64:67], v[216:219]
ds_read_b128 a[164:167], v11 offset:51680
v_mfma_f32_16x16x32_bf16 v[220:223], a[144:147], a[68:71], v[220:223]
s_waitcnt lgkmcnt(4)
buffer_load_dword v7, v15, s[8:11], s34 offen sc1
v_mfma_f32_16x16x32_bf16 v[224:227], a[148:151], a[64:67], v[224:227]
s_barrier
v_add_u32 v11, 4294901760, v11
ds_read_b128 a[168:171], v11 offset:0
v_mfma_f32_16x16x32_bf16 v[228:231], a[148:151], a[68:71], v[228:231]
s_waitcnt lgkmcnt(4)
v_mfma_f32_16x16x32_bf16 v[216:219], a[152:155], a[72:75], v[216:219]
ds_read_b128 a[172:175], v11 offset:1056
v_mfma_f32_16x16x32_bf16 v[220:223], a[152:155], a[76:79], v[220:223]
s_waitcnt lgkmcnt(4)
v_mfma_f32_16x16x32_bf16 v[224:227], a[156:159], a[72:75], v[224:227]
ds_read_b128 a[144:147], v11 offset:2112
v_mfma_f32_16x16x32_bf16 v[228:231], a[156:159], a[76:79], v[228:231]
s_waitcnt lgkmcnt(4)
v_mfma_f32_16x16x32_bf16 v[216:219], a[160:163], a[80:83], v[216:219]
ds_read_b128 a[148:151], v11 offset:3168
v_mfma_f32_16x16x32_bf16 v[220:223], a[160:163], a[84:87], v[220:223]
s_waitcnt lgkmcnt(4)
v_mfma_f32_16x16x32_bf16 v[224:227], a[164:167], a[80:83], v[224:227]
ds_read_b128 a[152:155], v11 offset:4224
v_mfma_f32_16x16x32_bf16 v[228:231], a[164:167], a[84:87], v[228:231]
s_waitcnt lgkmcnt(4)
v_mfma_f32_16x16x32_bf16 v[216:219], a[168:171], a[88:91], v[216:219]
ds_read_b128 a[156:159], v11 offset:5280
v_mfma_f32_16x16x32_bf16 v[220:223], a[168:171], a[92:95], v[220:223]
s_waitcnt lgkmcnt(4)
v_mfma_f32_16x16x32_bf16 v[224:227], a[172:175], a[88:91], v[224:227]
ds_read_b128 a[160:163], v11 offset:6336
v_mfma_f32_16x16x32_bf16 v[228:231], a[172:175], a[92:95], v[228:231]
s_waitcnt lgkmcnt(4)
v_mfma_f32_16x16x32_bf16 v[216:219], a[144:147], a[96:99], v[216:219]
ds_read_b128 a[164:167], v11 offset:7392
v_mfma_f32_16x16x32_bf16 v[220:223], a[144:147], a[100:103], v[220:223]
s_waitcnt lgkmcnt(4)
v_mfma_f32_16x16x32_bf16 v[224:227], a[148:151], a[96:99], v[224:227]
ds_read_b128 a[168:171], v11 offset:33792
v_mfma_f32_16x16x32_bf16 v[228:231], a[148:151], a[100:103], v[228:231]
s_waitcnt lgkmcnt(4)
v_mfma_f32_16x16x32_bf16 v[216:219], a[152:155], a[104:107], v[216:219]
ds_read_b128 a[172:175], v11 offset:34848
v_mfma_f32_16x16x32_bf16 v[220:223], a[152:155], a[108:111], v[220:223]
s_waitcnt lgkmcnt(4)
v_mfma_f32_16x16x32_bf16 v[224:227], a[156:159], a[104:107], v[224:227]
ds_read_b128 a[144:147], v11 offset:35904
v_mfma_f32_16x16x32_bf16 v[228:231], a[156:159], a[108:111], v[228:231]
s_waitcnt lgkmcnt(4)
v_mfma_f32_16x16x32_bf16 v[216:219], a[160:163], a[112:115], v[216:219]
ds_read_b128 a[148:151], v11 offset:36960
v_mfma_f32_16x16x32_bf16 v[220:223], a[160:163], a[116:119], v[220:223]
s_waitcnt lgkmcnt(4)
v_mfma_f32_16x16x32_bf16 v[224:227], a[164:167], a[112:115], v[224:227]
v_mfma_f32_16x16x32_bf16 v[228:231], a[164:167], a[116:119], v[228:231]
s_waitcnt lgkmcnt(3)
v_mfma_f32_16x16x32_bf16 v[216:219], a[168:171], a[120:123], v[216:219]
v_mfma_f32_16x16x32_bf16 v[220:223], a[168:171], a[124:127], v[220:223]
s_waitcnt lgkmcnt(2)
v_mfma_f32_16x16x32_bf16 v[224:227], a[172:175], a[120:123], v[224:227]
v_mfma_f32_16x16x32_bf16 v[228:231], a[172:175], a[124:127], v[228:231]
s_waitcnt lgkmcnt(1)
s_cmp_lg_u32 s88, 0
s_cbranch_scc1 L3_have
s_waitcnt vmcnt(0)
v_subrev_u32 v7, s7, v7
v_cmp_lt_u32 vcc, 0, v7
s_cbranch_vccnz L3_poll4
L3_poll4_ret:
buffer_load_dwordx4 v[84:87], v1, s[8:11], s56 offen offset:0 sc1
buffer_load_dwordx4 v[96:99], v1, s[8:11], s56 offen offset:1024 sc1
s_add_u32 s56, s56, 8192
buffer_load_dwordx4 v[100:103], v1, s[8:11], s56 offen offset:0 sc1
buffer_load_dwordx4 v[112:115], v1, s[8:11], s56 offen offset:1024 sc1
s_add_u32 s56, s56, 8192
buffer_load_dwordx4 v[116:119], v1, s[8:11], s56 offen offset:0 sc1
buffer_load_dwordx4 v[128:131], v1, s[8:11], s56 offen offset:1024 sc1
s_cmp_lg_u32 s20, s22
s_cbranch_scc1 L3_no8a0
s_add_u32 s50, s22, 1
s_and_b32 s50, s50, 3
s_lshl_b32 s50, s50, 10
s_add_u32 s50, s50, s58
buffer_load_dwordx4 v[132:135], v1, s[8:11], s50 offen sc1
s_add_u32 s50, s22, 2
s_and_b32 s50, s50, 3
s_lshl_b32 s50, s50, 10
s_add_u32 s50, s50, s58
buffer_load_dwordx4 v[144:147], v1, s[8:11], s50 offen sc1
s_add_u32 s50, s22, 3
s_and_b32 s50, s50, 3
s_lshl_b32 s50, s50, 10
s_add_u32 s50, s50, s58
buffer_load_dwordx4 v[148:151], v1, s[8:11], s50 offen sc1
L3_no8a0:
L3_have:
v_mfma_f32_16x16x32_bf16 v[216:219], a[144:147], a[128:131], v[216:219]
v_mfma_f32_16x16x32_bf16 v[220:223], a[144:147], a[132:135], v[220:223]
s_waitcnt lgkmcnt(0)
v_mfma_f32_16x16x32_bf16 v[224:227], a[148:151], a[128:131], v[224:227]
v_mfma_f32_16x16x32_bf16 v[228:231], a[148:151], a[132:135], v[228:231]
s_nop 7
s_waitcnt vmcnt(0) lgkmcnt(0)
s_cmp_lg_u32 s20, s22
s_cbranch_scc1 L3_no8b
v_dot2_f32_bf16 v232, v132, s48, v232
v_dot2_f32_bf16 v233, v132, s49, v233
v_dot2_f32_bf16 v234, v133, s48, v234
v_dot2_f32_bf16 v235, v133, s49, v235
v_dot2_f32_bf16 v232, v144, s48, v232
v_dot2_f32_bf16 v233, v144, s49, v233
v_dot2_f32_bf16 v234, v145, s48, v234
v_dot2_f32_bf16 v235, v145, s49, v235
v_dot2_f32_bf16 v232, v148, s48, v232
v_dot2_f32_bf16 v233, v148, s49, v233
v_dot2_f32_bf16 v234, v149, s48, v234
v_dot2_f32_bf16 v235, v149, s49, v235
s_nop 2
v_fma_f32 v232, v232, v8, v160
v_fma_f32 v233, v233, v8, v161
v_fma_f32 v234, v234, v8, v162
v_fma_f32 v235, v235, v8, v163
v_cvt_pk_bf16_f32 v232, v232, v233
v_cvt_pk_bf16_f32 v233, v234, v235
buffer_store_dwordx2 v[232:233], v10, s[12:15], s91 offen offset:1024 sc1
v_dot2_f32_bf16 v236, v134, s48, v236
v_dot2_f32_bf16 v237, v134, s49, v237
v_dot2_f32_bf16 v238, v135, s48, v238
v_dot2_f32_bf16 v239, v135, s49, v239
v_dot2_f32_bf16 v236, v146, s48, v236
v_dot2_f32_bf16 v237, v146, s49, v237
v_dot2_f32_bf16 v238, v147, s48, v238
v_dot2_f32_bf16 v239, v147, s49, v239
v_dot2_f32_bf16 v236, v150, s48, v236
v_dot2_f32_bf16 v237, v150, s49, v237
v_dot2_f32_bf16 v238, v151, s48, v238
v_dot2_f32_bf16 v239, v151, s49, v239
s_nop 2
v_fma_f32 v236, v236, v6, v164
v_fma_f32 v237, v237, v6, v165
v_fma_f32 v238, v238, v6, v166
v_fma_f32 v239, v239, v6, v167
v_cvt_pk_bf16_f32 v236, v236, v237
v_cvt_pk_bf16_f32 v237, v238, v239
buffer_store_dwordx2 v[236:237], v10, s[12:15], s91 offen offset:2176 sc1
L3_no8b:
v_dot2_f32_bf16 v216, v84, s48, v216
v_dot2_f32_bf16 v217, v84, s49, v217
v_dot2_f32_bf16 v218, v85, s48, v218
v_dot2_f32_bf16 v219, v85, s49, v219
v_dot2_f32_bf16 v224, v86, s48, v224
v_dot2_f32_bf16 v225, v86, s49, v225
v_dot2_f32_bf16 v226, v87, s48, v226
v_dot2_f32_bf16 v227, v87, s49, v227
v_dot2_f32_bf16 v216, v100, s48, v216
v_dot2_f32_bf16 v217, v100, s49, v217
v_dot2_f32_bf16 v218, v101, s48, v218
v_dot2_f32_bf16 v219, v101, s49, v219
v_dot2_f32_bf16 v224, v102, s48, v224
v_dot2_f32_bf16 v225, v102, s49, v225
v_dot2_f32_bf16 v226, v103, s48, v226
v_dot2_f32_bf16 v227, v103, s49, v227
v_dot2_f32_bf16 v216, v116, s48, v216
v_dot2_f32_bf16 v217, v116, s49, v217
v_dot2_f32_bf16 v218, v117, s48, v218
v_dot2_f32_bf16 v219, v117, s49, v219
v_dot2_f32_bf16 v224, v118, s48, v224
v_dot2_f32_bf16 v225, v118, s49, v225
v_dot2_f32_bf16 v226, v119, s48, v226
v_dot2_f32_bf16 v227, v119, s49, v227
s_nop 2
v_fma_f32 v216, v216, v8, v240
v_fma_f32 v217, v217, v8, v241
v_fma_f32 v218, v218, v8, v242
v_fma_f32 v219, v219, v8, v243
v_fma_f32 v224, v224, v8, v244
v_fma_f32 v225, v225, v8, v245
v_fma_f32 v226, v226, v8, v246
v_fma_f32 v227, v227, v8, v247
v_cvt_pk_bf16_f32 v216, v216, v217
v_cvt_pk_bf16_f32 v217, v218, v219
v_cvt_pk_bf16_f32 v218, v224, v225
v_cvt_pk_bf16_f32 v219, v226, v227
buffer_store_dwordx4 v[216:219], v80, s[12:15], s59 offen offset:0 sc1
v_dot2_f32_bf16 v220, v96, s48, v220
v_dot2_f32_bf16 v221, v96, s49, v221
v_dot2_f32_bf16 v222, v97, s48, v222
v_dot2_f32_bf16 v223, v97, s49, v223
v_dot2_f32_bf16 v228, v98, s48, v228
v_dot2_f32_bf16 v229, v98, s49, v229
v_dot2_f32_bf16 v230, v99, s48, v230
v_dot2_f32_bf16 v231, v99, s49, v231
v_dot2_f32_bf16 v220, v112, s48, v220
v_dot2_f32_bf16 v221, v112, s49, v221
v_dot2_f32_bf16 v222, v113, s48, v222
v_dot2_f32_bf16 v223, v113, s49, v223
v_dot2_f32_bf16 v228, v114, s48, v228
v_dot2_f32_bf16 v229, v114, s49, v229
v_dot2_f32_bf16 v230, v115, s48, v230
v_dot2_f32_bf16 v231, v115, s49, v231
v_dot2_f32_bf16 v220, v128, s48, v220
v_dot2_f32_bf16 v221, v128, s49, v221
v_dot2_f32_bf16 v222, v129, s48, v222
v_dot2_f32_bf16 v223, v129, s49, v223
v_dot2_f32_bf16 v228, v130, s48, v228
v_dot2_f32_bf16 v229, v130, s49, v229
v_dot2_f32_bf16 v230, v131, s48, v230
v_dot2_f32_bf16 v231, v131, s49, v231
s_nop 2
v_fma_f32 v220, v220, v6, v248
v_fma_f32 v221, v221, v6, v249
v_fma_f32 v222, v222, v6, v250
v_fma_f32 v223, v223, v6, v251
v_fma_f32 v228, v228, v6, v252
v_fma_f32 v229, v229, v6, v253
v_fma_f32 v230, v230, v6, v254
v_fma_f32 v231, v231, v6, v255
v_cvt_pk_bf16_f32 v220, v220, v221
v_cvt_pk_bf16_f32 v221, v222, v223
v_cvt_pk_bf16_f32 v222, v228, v229
v_cvt_pk_bf16_f32 v223, v230, v231
buffer_store_dwordx4 v[220:223], v80, s[12:15], s59 offen offset:1152 sc1
L3_end:
s_endpgm
L3_poll0:
s_mov_b32 s52, 0
L3_poll0_l:
buffer_load_dword v7, v187, s[8:11], s47 offen sc1
s_waitcnt vmcnt(0)
v_subrev_u32 v7, s38, v7
v_cmp_lt_u32 vcc, 4, v7
s_cbranch_vccz L3_poll0_ret
s_add_u32 s52, s52, 1
s_cmp_lt_u32 s52, 0x40000
s_cbranch_scc1 L3_poll0_l
s_branch L3_poll0_ret
L3_poll1:
s_mov_b32 s52, 0
L3_poll1_l:
buffer_load_dword v7, v5, s[8:11], s33 offen sc1
s_waitcnt vmcnt(0)
v_subrev_u32 v7, s4, v7
v_cmp_lt_u32 vcc, 3, v7
s_cbranch_vccz L3_poll1_ret
s_add_u32 s52, s52, 1
s_cmp_lt_u32 s52, 0x40000
s_cbranch_scc1 L3_poll1_l
s_branch L3_poll1_ret
L3_poll2:
s_mov_b32 s52, 0
L3_poll2_l:
buffer_load_dword v7, v5, s[8:11], s33 offen sc1
s_waitcnt vmcnt(0)
v_subrev_u32 v7, s5, v7
v_cmp_lt_u32 vcc, 2, v7
s_cbranch_vccz L3_poll2_ret
s_add_u32 s52, s52, 1
s_cmp_lt_u32 s52, 0x40000
s_cbranch_scc1 L3_poll2_l
s_branch L3_poll2_ret
L3_poll3:
s_mov_b32 s52, 0
L3_poll3_l:
buffer_load_dword v7, v5, s[8:11], s33 offen sc1
s_waitcnt vmcnt(0)
v_subrev_u32 v7, s6, v7
v_cmp_lt_u32 vcc, 1, v7
s_cbranch_vccz L3_poll3_ret
s_add_u32 s52, s52, 1
s_cmp_lt_u32 s52, 0x40000
s_cbranch_scc1 L3_poll3_l
s_branch L3_poll3_ret
L3_poll4:
s_mov_b32 s52, 0
L3_poll4_l:
buffer_load_dword v7, v15, s[8:11], s34 offen sc1
s_waitcnt vmcnt(0)
v_subrev_u32 v7, s7, v7
v_cmp_lt_u32 vcc, 0, v7
s_cbranch_vccz L3_poll4_ret
s_add_u32 s52, s52, 1
s_cmp_lt_u32 s52, 0x40000
s_cbranch_scc1 L3_poll4_l
s_branch L3_poll4_ret
L3_f2:
s_mov_b32 s52, 0
L3_f2l:
buffer_load_dword v213, v215, s[8:11], s65 offen sc1
s_waitcnt vmcnt(0)
v_cmp_ne_u32 vcc, v212, v213
s_cbranch_vccz L3_f2_ret
s_add_u32 s52, s52, 1
s_cmp_lt_u32 s52, 0x40000
s_cbranch_scc1 L3_f2l
s_branch L3_f2_ret
L3_try0:
s_mov_b32 s88, 1
buffer_load_dwordx4 v[84:87], v1, s[8:11], s56 offen offset:0 sc1
buffer_load_dwordx4 v[96:99], v1, s[8:11], s56 offen offset:1024 sc1
s_add_u32 s56, s56, 8192
buffer_load_dwordx4 v[100:103], v1, s[8:11], s56 offen offset:0 sc1
buffer_load_dwordx4 v[112:115], v1, s[8:11], s56 offen offset:1024 sc1
s_add_u32 s56, s56, 8192
buffer_load_dwordx4 v[116:119], v1, s[8:11], s56 offen offset:0 sc1
buffer_load_dwordx4 v[128:131], v1, s[8:11], s56 offen offset:1024 sc1
s_cmp_lg_u32 s20, s22
s_cbranch_scc1 L3_no8a1
s_add_u32 s50, s22, 1
s_and_b32 s50, s50, 3
s_lshl_b32 s50, s50, 10
s_add_u32 s50, s50, s58
buffer_load_dwordx4 v[132:135], v1, s[8:11], s50 offen sc1
s_add_u32 s50, s22, 2
s_and_b32 s50, s50, 3
s_lshl_b32 s50, s50, 10
s_add_u32 s50, s50, s58
buffer_load_dwordx4 v[144:147], v1, s[8:11], s50 offen sc1
s_add_u32 s50, s22, 3
s_and_b32 s50, s50, 3
s_lshl_b32 s50, s50, 10
s_add_u32 s50, s50, s58
buffer_load_dwordx4 v[148:151], v1, s[8:11], s50 offen sc1
L3_no8a1:
s_branch L3_try0_ret
L3_codeend:
.p2align 7
.type T_w,@object
T_w:
.long 0, 65, 2379776, 2380800, 2381824, 2382848, 2383872, 2384896, 2637824, 2638848, 2385920, 2386944, 2387968, 2388992, 2390016, 2391040, 2392064, 2639872, 2640896, 2393088, 2394112, 2395136, 2396160, 2397184, 2398208, 2399232, 2641920, 2642944, 2400256, 0, 0, 0
.long 0, 65, 2814976, 2816000, 2817024, 2818048, 2819072, 2820096, 3016704, 3017728, 2821120, 2836480, 2837504, 2838528, 2839552, 2840576, 2841600, 3022848, 3023872, 2842624, 2857984, 2859008, 2860032, 2861056, 2862080, 2863104, 3028992, 3030016, 2864128, 0, 0, 0
.long 0, 65, 3164160, 3165184, 3166208, 3167232, 3168256, 3169280, 3371008, 3372032, 3170304, 3185664, 3186688, 3187712, 3188736, 3189760, 3190784, 3377152, 3378176, 3191808, 3207168, 3208192, 3209216, 3210240, 3211264, 3212288, 3383296, 3384320, 3213312, 0, 0, 0
.long 0, 65, 3513344, 3514368, 3515392, 3516416, 3517440, 3518464, 3725312, 3726336, 3519488, 3534848, 3535872, 3536896, 3537920, 3538944, 3539968, 3731456, 3732480, 3540992, 3556352, 3557376, 3558400, 3559424, 3560448, 3561472, 3737600, 3738624, 3562496, 0, 0, 0
.long 110592, 65, 2401280, 2402304, 2403328, 2404352, 2405376, 2406400, 2643968, 2644992, 2407424, 2408448, 2409472, 2410496, 2411520, 2412544, 2413568, 2646016, 2647040, 2414592, 2415616, 2416640, 2417664, 2418688, 2419712, 2420736, 2648064, 2649088, 2421760, 0, 0, 0
.long 110592, 65, 2879488, 2880512, 2881536, 2882560, 2883584, 2884608, 3035136, 3036160, 2885632, 2890752, 2891776, 2921472, 2922496, 2952192, 2953216, 3041280, 3042304, 2980864, 2896896, 2897920, 2927616, 2928640, 2958336, 2959360, 3047424, 3048448, 2983936, 0, 0, 0
.long 110592, 65, 3228672, 3229696, 3230720, 3231744, 3232768, 3233792, 3389440, 3390464, 3234816, 3245056, 3246080, 3275776, 3276800, 3306496, 3307520, 3395584, 3396608, 3336192, 3251200, 3252224, 3281920, 3282944, 3312640, 3313664, 3401728, 3402752, 3339264, 0, 0, 0
.long 110592, 65, 3577856, 3578880, 3579904, 3580928, 3581952, 3582976, 3743744, 3744768, 3584000, 3599360, 3600384, 3630080, 3631104, 3660800, 3661824, 3749888, 3750912, 3691520, 3605504, 3606528, 3636224, 3637248, 3666944, 3667968, 3756032, 3757056, 3694592, 0, 0, 0
.long 221184, 65, 2429952, 2430976, 2432000, 2433024, 2434048, 2435072, 2652160, 2653184, 2436096, 2437120, 2438144, 2439168, 2440192, 2441216, 2442240, 2654208, 2655232, 2443264, 2422784, 2423808, 2424832, 2425856, 2426880, 2427904, 2650112, 2651136, 2428928, 0, 0, 0
.long 221184, 65, 2909184, 2910208, 2939904, 2940928, 2970624, 2971648, 3059712, 3060736, 2990080, 2915328, 2916352, 2946048, 2947072, 2976768, 2977792, 3065856, 3066880, 2993152, 2903040, 2904064, 2933760, 2934784, 2964480, 2965504, 3053568, 3054592, 2987008, 0, 0, 0
.long 221184, 65, 3263488, 3264512, 3294208, 3295232, 3324928, 3325952, 3414016, 3415040, 3345408, 3269632, 3270656, 3300352, 3301376, 3331072, 3332096, 3420160, 3421184, 3348480, 3257344, 3258368, 3288064, 3289088, 3318784, 3319808, 3407872, 3408896, 3342336, 0, 0, 0
.long 221184, 65, 3617792, 3618816, 3648512, 3649536, 3679232, 3680256, 3768320, 3769344, 3700736, 3623936, 3624960, 3654656, 3655680, 3685376, 3686400, 3774464, 3775488, 3703808, 3611648, 3612672, 3642368, 3643392, 3673088, 3674112, 3762176, 3763200, 3697664, 0, 0, 0
.long 331776, 65, 2542592, 2543616, 2573312, 2574336, 2604032, 2605056, 2693120, 2694144, 2628608, 2444288, 2445312, 2446336, 2447360, 2448384, 2449408, 2656256, 2657280, 2450432, 2465792, 2466816, 2467840, 2468864, 2469888, 2470912, 2662400, 2663424, 2471936, 0, 0, 0
.long 331776, 65, 2779136, 2780160, 2781184, 2782208, 2783232, 2784256, 3006464, 3007488, 2785280, 2736128, 2737152, 2738176, 2739200, 2740224, 2741248, 2994176, 2995200, 2742272, 2743296, 2744320, 2745344, 2746368, 2747392, 2748416, 2996224, 2997248, 2749440, 0, 0, 0
.long 331776, 65, 3259392, 3260416, 3290112, 3291136, 3320832, 3321856, 3409920, 3410944, 3343360, 3171328, 3172352, 3173376, 3174400, 3175424, 3176448, 3373056, 3374080, 3177472, 3192832, 3193856, 3194880, 3195904, 3196928, 3197952, 3379200, 3380224, 3198976, 0, 0, 0
.long 331776, 65, 3613696, 3614720, 3644416, 3645440, 3675136, 3676160, 3764224, 3765248, 3698688, 3520512, 3521536, 3522560, 3523584, 3524608, 3525632, 3727360, 3728384, 3526656, 3542016, 3543040, 3544064, 3545088, 3546112, 3547136, 3733504, 3734528, 3548160, 0, 0, 0
.long 442368, 65, 2487296, 2488320, 2489344, 2490368, 2491392, 2492416, 2668544, 2669568, 2493440, 2508800, 2509824, 2510848, 2511872, 2512896, 2513920, 2674688, 2675712, 2514944, 2530304, 2531328, 2561024, 2562048, 2591744, 2592768, 2680832, 2681856, 2622464, 0, 0, 0
.long 442368, 65, 2750464, 2751488, 2752512, 2753536, 2754560, 2755584, 2998272, 2999296, 2756608, 2757632, 2758656, 2759680, 2760704, 2761728, 2762752, 3000320, 3001344, 2763776, 2764800, 2765824, 2766848, 2767872, 2768896, 2769920, 3002368, 3003392, 2770944, 0, 0, 0
.long 442368, 65, 3214336, 3215360, 3216384, 3217408, 3218432, 3219456, 3385344, 3386368, 3220480, 3235840, 3236864, 3237888, 3238912, 3239936, 3240960, 3391488, 3392512, 3241984, 3247104, 3248128, 3277824, 3278848, 3308544, 3309568, 3397632, 3398656, 3337216, 0, 0, 0
.long 442368, 65, 3563520, 3564544, 3565568, 3566592, 3567616, 3568640, 3739648, 3740672, 3569664, 3585024, 3586048, 3587072, 3588096, 3589120, 3590144, 3745792, 3746816, 3591168, 3601408, 3602432, 3632128, 3633152, 3662848, 3663872, 3751936, 3752960, 3692544, 0, 0, 0
.long 552960, 65, 2536448, 2537472, 2567168, 2568192, 2597888, 2598912, 2686976, 2688000, 2625536, 2548736, 2549760, 2579456, 2580480, 2610176, 2611200, 2699264, 2700288, 2631680, 2554880, 2555904, 2585600, 2586624, 2616320, 2617344, 2705408, 2706432, 2634752, 0, 0, 0
.long 552960, 65, 2771968, 2772992, 2774016, 2775040, 2776064, 2777088, 3004416, 3005440, 2778112, 2786304, 2787328, 2788352, 2789376, 2790400, 2791424, 3008512, 3009536, 2792448, 2793472, 2794496, 2795520, 2796544, 2797568, 2798592, 3010560, 3011584, 2799616, 0, 0, 0
.long 552960, 65, 3253248, 3254272, 3283968, 3284992, 3314688, 3315712, 3403776, 3404800, 3340288, 3265536, 3266560, 3296256, 3297280, 3326976, 3328000, 3416064, 3417088, 3346432, 3271680, 3272704, 3302400, 3303424, 3333120, 3334144, 3422208, 3423232, 3349504, 0, 0, 0
.long 552960, 65, 3607552, 3608576, 3638272, 3639296, 3668992, 3670016, 3758080, 3759104, 3695616, 3619840, 3620864, 3650560, 3651584, 3681280, 3682304, 3770368, 3771392, 3701760, 3625984, 3627008, 3656704, 3657728, 3687424, 3688448, 3776512, 3777536, 3704832, 0, 0, 0
.long 663552, 65, 2451456, 2452480, 2453504, 2454528, 2455552, 2456576, 2658304, 2659328, 2457600, 2472960, 2473984, 2475008, 2476032, 2477056, 2478080, 2664448, 2665472, 2479104, 2494464, 2495488, 2496512, 2497536, 2498560, 2499584, 2670592, 2671616, 2500608, 0, 0, 0
.long 663552, 65, 2800640, 2801664, 2802688, 2803712, 2804736, 2805760, 3012608, 3013632, 2806784, 2822144, 2823168, 2824192, 2825216, 2826240, 2827264, 3018752, 3019776, 2828288, 2843648, 2844672, 2845696, 2846720, 2847744, 2848768, 3024896, 3025920, 2849792, 0, 0, 0
.long 663552, 65, 3092480, 3093504, 3094528, 3095552, 3096576, 3097600, 3350528, 3351552, 3098624, 3099648, 3100672, 3101696, 3102720, 3103744, 3104768, 3352576, 3353600, 3105792, 3106816, 3107840, 3108864, 3109888, 3110912, 3111936, 3354624, 3355648, 3112960, 0, 0, 0
.long 663552, 65, 3527680, 3528704, 3529728, 3530752, 3531776, 3532800, 3729408, 3730432, 3533824, 3549184, 3550208, 3551232, 3552256, 3553280, 3554304, 3735552, 3736576, 3555328, 3570688, 3571712, 3572736, 3573760, 3574784, 3575808, 3741696, 3742720, 3576832, 0, 0, 0
.long 774144, 65, 2515968, 2516992, 2518016, 2519040, 2520064, 2521088, 2676736, 2677760, 2522112, 2532352, 2533376, 2563072, 2564096, 2593792, 2594816, 2682880, 2683904, 2623488, 2538496, 2539520, 2569216, 2570240, 2599936, 2600960, 2689024, 2690048, 2626560, 0, 0, 0
.long 774144, 65, 2865152, 2866176, 2867200, 2868224, 2869248, 2870272, 3031040, 3032064, 2871296, 2886656, 2887680, 2917376, 2918400, 2948096, 2949120, 3037184, 3038208, 2978816, 2892800, 2893824, 2923520, 2924544, 2954240, 2955264, 3043328, 3044352, 2981888, 0, 0, 0
.long 774144, 65, 3113984, 3115008, 3116032, 3117056, 3118080, 3119104, 3356672, 3357696, 3120128, 3121152, 3122176, 3123200, 3124224, 3125248, 3126272, 3358720, 3359744, 3127296, 3128320, 3129344, 3130368, 3131392, 3132416, 3133440, 3360768, 3361792, 3134464, 0, 0, 0
.long 774144, 65, 3592192, 3593216, 3594240, 3595264, 3596288, 3597312, 3747840, 3748864, 3598336, 3603456, 3604480, 3634176, 3635200, 3664896, 3665920, 3753984, 3755008, 3693568, 3609600, 3610624, 3640320, 3641344, 3671040, 3672064, 3760128, 3761152, 3696640, 0, 0, 0
.long 884736, 65, 2550784, 2551808, 2581504, 2582528, 2612224, 2613248, 2701312, 2702336, 2632704, 2556928, 2557952, 2587648, 2588672, 2618368, 2619392, 2707456, 2708480, 2635776, 2544640, 2545664, 2575360, 2576384, 2606080, 2607104, 2695168, 2696192, 2629632, 0, 0, 0
.long 884736, 65, 2905088, 2906112, 2935808, 2936832, 2966528, 2967552, 3055616, 3056640, 2988032, 2911232, 2912256, 2941952, 2942976, 2972672, 2973696, 3061760, 3062784, 2991104, 2898944, 2899968, 2929664, 2930688, 2960384, 2961408, 3049472, 3050496, 2984960, 0, 0, 0
.long 884736, 65, 3142656, 3143680, 3144704, 3145728, 3146752, 3147776, 3364864, 3365888, 3148800, 3149824, 3150848, 3151872, 3152896, 3153920, 3154944, 3366912, 3367936, 3155968, 3135488, 3136512, 3137536, 3138560, 3139584, 3140608, 3362816, 3363840, 3141632, 0, 0, 0
.long 884736, 65, 3621888, 3622912, 3652608, 3653632, 3683328, 3684352, 3772416, 3773440, 3702784, 3628032, 3629056, 3658752, 3659776, 3689472, 3690496, 3778560, 3779584, 3705856, 3615744, 3616768, 3646464, 3647488, 3677184, 3678208, 3766272, 3767296, 3699712, 0, 0, 0
.long 995328, 65, 2546688, 2547712, 2577408, 2578432, 2608128, 2609152, 2697216, 2698240, 2630656, 2458624, 2459648, 2460672, 2461696, 2462720, 2463744, 2660352, 2661376, 2464768, 2480128, 2481152, 2482176, 2483200, 2484224, 2485248, 2666496, 2667520, 2486272, 0, 0, 0
.long 995328, 65, 2900992, 2902016, 2931712, 2932736, 2962432, 2963456, 3051520, 3052544, 2985984, 2807808, 2808832, 2809856, 2810880, 2811904, 2812928, 3014656, 3015680, 2813952, 2829312, 2830336, 2831360, 2832384, 2833408, 2834432, 3020800, 3021824, 2835456, 0, 0, 0
.long 995328, 65, 3255296, 3256320, 3286016, 3287040, 3316736, 3317760, 3405824, 3406848, 3341312, 3156992, 3158016, 3159040, 3160064, 3161088, 3162112, 3368960, 3369984, 3163136, 3178496, 3179520, 3180544, 3181568, 3182592, 3183616, 3375104, 3376128, 3184640, 0, 0, 0
.long 995328, 65, 3491840, 3492864, 3493888, 3494912, 3495936, 3496960, 3719168, 3720192, 3497984, 3448832, 3449856, 3450880, 3451904, 3452928, 3453952, 3706880, 3707904, 3454976, 3456000, 3457024, 3458048, 3459072, 3460096, 3461120, 3708928, 3709952, 3462144, 0, 0, 0
.long 1105920, 65, 2501632, 2502656, 2503680, 2504704, 2505728, 2506752, 2672640, 2673664, 2507776, 2523136, 2524160, 2525184, 2526208, 2527232, 2528256, 2678784, 2679808, 2529280, 2534400, 2535424, 2565120, 2566144, 2595840, 2596864, 2684928, 2685952, 2624512, 0, 0, 0
.long 1105920, 65, 2850816, 2851840, 2852864, 2853888, 2854912, 2855936, 3026944, 3027968, 2856960, 2872320, 2873344, 2874368, 2875392, 2876416, 2877440, 3033088, 3034112, 2878464, 2888704, 2889728, 2919424, 2920448, 2950144, 2951168, 3039232, 3040256, 2979840, 0, 0, 0
.long 1105920, 65, 3200000, 3201024, 3202048, 3203072, 3204096, 3205120, 3381248, 3382272, 3206144, 3221504, 3222528, 3223552, 3224576, 3225600, 3226624, 3387392, 3388416, 3227648, 3243008, 3244032, 3273728, 3274752, 3304448, 3305472, 3393536, 3394560, 3335168, 0, 0, 0
.long 1105920, 65, 3463168, 3464192, 3465216, 3466240, 3467264, 3468288, 3710976, 3712000, 3469312, 3470336, 3471360, 3472384, 3473408, 3474432, 3475456, 3713024, 3714048, 3476480, 3477504, 3478528, 3479552, 3480576, 3481600, 3482624, 3715072, 3716096, 3483648, 0, 0, 0
.long 1216512, 65, 2540544, 2541568, 2571264, 2572288, 2601984, 2603008, 2691072, 2692096, 2627584, 2552832, 2553856, 2583552, 2584576, 2614272, 2615296, 2703360, 2704384, 2633728, 2558976, 2560000, 2589696, 2590720, 2620416, 2621440, 2709504, 2710528, 2636800, 0, 0, 0
.long 1216512, 65, 2894848, 2895872, 2925568, 2926592, 2956288, 2957312, 3045376, 3046400, 2982912, 2907136, 2908160, 2937856, 2938880, 2968576, 2969600, 3057664, 3058688, 2989056, 2913280, 2914304, 2944000, 2945024, 2974720, 2975744, 3063808, 3064832, 2992128, 0, 0, 0
.long 1216512, 65, 3249152, 3250176, 3279872, 3280896, 3310592, 3311616, 3399680, 3400704, 3338240, 3261440, 3262464, 3292160, 3293184, 3322880, 3323904, 3411968, 3412992, 3344384, 3267584, 3268608, 3298304, 3299328, 3329024, 3330048, 3418112, 3419136, 3347456, 0, 0, 0
.long 1216512, 65, 3484672, 3485696, 3486720, 3487744, 3488768, 3489792, 3717120, 3718144, 3490816, 3499008, 3500032, 3501056, 3502080, 3503104, 3504128, 3721216, 3722240, 3505152, 3506176, 3507200, 3508224, 3509248, 3510272, 3511296, 3723264, 3724288, 3512320, 0, 0, 0
.long 1327104, 129, 3805184, 3806208, 3807232, 3808256, 3809280, 3810304, 4063232, 4064256, 3811328, 3812352, 3813376, 3814400, 3815424, 3816448, 3817472, 4065280, 4066304, 3818496, 3819520, 3820544, 3821568, 3822592, 3823616, 3824640, 4067328, 4068352, 3825664, 0, 0, 0
.long 1327104, 129, 4240384, 4241408, 4242432, 4243456, 4244480, 4245504, 4442112, 4443136, 4246528, 4261888, 4262912, 4263936, 4264960, 4265984, 4267008, 4448256, 4449280, 4268032, 4283392, 4284416, 4285440, 4286464, 4287488, 4288512, 4454400, 4455424, 4289536, 0, 0, 0
.long 1327104, 129, 4589568, 4590592, 4591616, 4592640, 4593664, 4594688, 4796416, 4797440, 4595712, 4611072, 4612096, 4613120, 4614144, 4615168, 4616192, 4802560, 4803584, 4617216, 4632576, 4633600, 4634624, 4635648, 4636672, 4637696, 4808704, 4809728, 4638720, 0, 0, 0
.long 1327104, 129, 4938752, 4939776, 4940800, 4941824, 4942848, 4943872, 5150720, 5151744, 4944896, 4960256, 4961280, 4962304, 4963328, 4964352, 4965376, 5156864, 5157888, 4966400, 4981760, 4982784, 4983808, 4984832, 4985856, 4986880, 5163008, 5164032, 4987904, 0, 0, 0
.long 1437696, 129, 3826688, 3827712, 3828736, 3829760, 3830784, 3831808, 4069376, 4070400, 3832832, 3833856, 3834880, 3835904, 3836928, 3837952, 3838976, 4071424, 4072448, 3840000, 3841024, 3842048, 3843072, 3844096, 3845120, 3846144, 4073472, 4074496, 3847168, 0, 0, 0
.long 1437696, 129, 4304896, 4305920, 4306944, 4307968, 4308992, 4310016, 4460544, 4461568, 4311040, 4316160, 4317184, 4346880, 4347904, 4377600, 4378624, 4466688, 4467712, 4406272, 4322304, 4323328, 4353024, 4354048, 4383744, 4384768, 4472832, 4473856, 4409344, 0, 0, 0
.long 1437696, 129, 4654080, 4655104, 4656128, 4657152, 4658176, 4659200, 4814848, 4815872, 4660224, 4670464, 4671488, 4701184, 4702208, 4731904, 4732928, 4820992, 4822016, 4761600, 4676608, 4677632, 4707328, 4708352, 4738048, 4739072, 4827136, 4828160, 4764672, 0, 0, 0
.long 1437696, 129, 5003264, 5004288, 5005312, 5006336, 5007360, 5008384, 5169152, 5170176, 5009408, 5024768, 5025792, 5055488, 5056512, 5086208, 5087232, 5175296, 5176320, 5116928, 5030912, 5031936, 5061632, 5062656, 5092352, 5093376, 5181440, 5182464, 5120000, 0, 0, 0
.long 1548288, 129, 3855360, 3856384, 3857408, 3858432, 3859456, 3860480, 4077568, 4078592, 3861504, 3862528, 3863552, 3864576, 3865600, 3866624, 3867648, 4079616, 4080640, 3868672, 3848192, 3849216, 3850240, 3851264, 3852288, 3853312, 4075520, 4076544, 3854336, 0, 0, 0
.long 1548288, 129, 4334592, 4335616, 4365312, 4366336, 4396032, 4397056, 4485120, 4486144, 4415488, 4340736, 4341760, 4371456, 4372480, 4402176, 4403200, 4491264, 4492288, 4418560, 4328448, 4329472, 4359168, 4360192, 4389888, 4390912, 4478976, 4480000, 4412416, 0, 0, 0
.long 1548288, 129, 4688896, 4689920, 4719616, 4720640, 4750336, 4751360, 4839424, 4840448, 4770816, 4695040, 4696064, 4725760, 4726784, 4756480, 4757504, 4845568, 4846592, 4773888, 4682752, 4683776, 4713472, 4714496, 4744192, 4745216, 4833280, 4834304, 4767744, 0, 0, 0
.long 1548288, 129, 5043200, 5044224, 5073920, 5074944, 5104640, 5105664, 5193728, 5194752, 5126144, 5049344, 5050368, 5080064, 5081088, 5110784, 5111808, 5199872, 5200896, 5129216, 5037056, 5038080, 5067776, 5068800, 5098496, 5099520, 5187584, 5188608, 5123072, 0, 0, 0
.long 1658880, 129, 3968000, 3969024, 3998720, 3999744, 4029440, 4030464, 4118528, 4119552, 4054016, 3869696, 3870720, 3871744, 3872768, 3873792, 3874816, 4081664, 4082688, 3875840, 3891200, 3892224, 3893248, 3894272, 3895296, 3896320, 4087808, 4088832, 3897344, 0, 0, 0
.long 1658880, 129, 4204544, 4205568, 4206592, 4207616, 4208640, 4209664, 4431872, 4432896, 4210688, 4161536, 4162560, 4163584, 4164608, 4165632, 4166656, 4419584, 4420608, 4167680, 4168704, 4169728, 4170752, 4171776, 4172800, 4173824, 4421632, 4422656, 4174848, 0, 0, 0
.long 1658880, 129, 4684800, 4685824, 4715520, 4716544, 4746240, 4747264, 4835328, 4836352, 4768768, 4596736, 4597760, 4598784, 4599808, 4600832, 4601856, 4798464, 4799488, 4602880, 4618240, 4619264, 4620288, 4621312, 4622336, 4623360, 4804608, 4805632, 4624384, 0, 0, 0
.long 1658880, 129, 5039104, 5040128, 5069824, 5070848, 5100544, 5101568, 5189632, 5190656, 5124096, 4945920, 4946944, 4947968, 4948992, 4950016, 4951040, 5152768, 5153792, 4952064, 4967424, 4968448, 4969472, 4970496, 4971520, 4972544, 5158912, 5159936, 4973568, 0, 0, 0
.long 1769472, 129, 3912704, 3913728, 3914752, 3915776, 3916800, 3917824, 4093952, 4094976, 3918848, 3934208, 3935232, 3936256, 3937280, 3938304, 3939328, 4100096, 4101120, 3940352, 3955712, 3956736, 3986432, 3987456, 4017152, 4018176, 4106240, 4107264, 4047872, 0, 0, 0
.long 1769472, 129, 4175872, 4176896, 4177920, 4178944, 4179968, 4180992, 4423680, 4424704, 4182016, 4183040, 4184064, 4185088, 4186112, 4187136, 4188160, 4425728, 4426752, 4189184, 4190208, 4191232, 4192256, 4193280, 4194304, 4195328, 4427776, 4428800, 4196352, 0, 0, 0
.long 1769472, 129, 4639744, 4640768, 4641792, 4642816, 4643840, 4644864, 4810752, 4811776, 4645888, 4661248, 4662272, 4663296, 4664320, 4665344, 4666368, 4816896, 4817920, 4667392, 4672512, 4673536, 4703232, 4704256, 4733952, 4734976, 4823040, 4824064, 4762624, 0, 0, 0
.long 1769472, 129, 4988928, 4989952, 4990976, 4992000, 4993024, 4994048, 5165056, 5166080, 4995072, 5010432, 5011456, 5012480, 5013504, 5014528, 5015552, 5171200, 5172224, 5016576, 5026816, 5027840, 5057536, 5058560, 5088256, 5089280, 5177344, 5178368, 5117952, 0, 0, 0
.long 1880064, 129, 3961856, 3962880, 3992576, 3993600, 4023296, 4024320, 4112384, 4113408, 4050944, 3974144, 3975168, 4004864, 4005888, 4035584, 4036608, 4124672, 4125696, 4057088, 3980288, 3981312, 4011008, 4012032, 4041728, 4042752, 4130816, 4131840, 4060160, 0, 0, 0
.long 1880064, 129, 4197376, 4198400, 4199424, 4200448, 4201472, 4202496, 4429824, 4430848, 4203520, 4211712, 4212736, 4213760, 4214784, 4215808, 4216832, 4433920, 4434944, 4217856, 4218880, 4219904, 4220928, 4221952, 4222976, 4224000, 4435968, 4436992, 4225024, 0, 0, 0
.long 1880064, 129, 4678656, 4679680, 4709376, 4710400, 4740096, 4741120, 4829184, 4830208, 4765696, 4690944, 4691968, 4721664, 4722688, 4752384, 4753408, 4841472, 4842496, 4771840, 4697088, 4698112, 4727808, 4728832, 4758528, 4759552, 4847616, 4848640, 4774912, 0, 0, 0
.long 1880064, 129, 5032960, 5033984, 5063680, 5064704, 5094400, 5095424, 5183488, 5184512, 5121024, 5045248, 5046272, 5075968, 5076992, 5106688, 5107712, 5195776, 5196800, 5127168, 5051392, 5052416, 5082112, 5083136, 5112832, 5113856, 5201920, 5202944, 5130240, 0, 0, 0
.long 1990656, 129, 3876864, 3877888, 3878912, 3879936, 3880960, 3881984, 4083712, 4084736, 3883008, 3898368, 3899392, 3900416, 3901440, 3902464, 3903488, 4089856, 4090880, 3904512, 3919872, 3920896, 3921920, 3922944, 3923968, 3924992, 4096000, 4097024, 3926016, 0, 0, 0
.long 1990656, 129, 4226048, 4227072, 4228096, 4229120, 4230144, 4231168, 4438016, 4439040, 4232192, 4247552, 4248576, 4249600, 4250624, 4251648, 4252672, 4444160, 4445184, 4253696, 4269056, 4270080, 4271104, 4272128, 4273152, 4274176, 4450304, 4451328, 4275200, 0, 0, 0
.long 1990656, 129, 4517888, 4518912, 4519936, 4520960, 4521984, 4523008, 4775936, 4776960, 4524032, 4525056, 4526080, 4527104, 4528128, 4529152, 4530176, 4777984, 4779008, 4531200, 4532224, 4533248, 4534272, 4535296, 4536320, 4537344, 4780032, 4781056, 4538368, 0, 0, 0
.long 1990656, 129, 4953088, 4954112, 4955136, 4956160, 4957184, 4958208, 5154816, 5155840, 4959232, 4974592, 4975616, 4976640, 4977664, 4978688, 4979712, 5160960, 5161984, 4980736, 4996096, 4997120, 4998144, 4999168, 5000192, 5001216, 5167104, 5168128, 5002240, 0, 0, 0
.long 2101248, 129, 3941376, 3942400, 3943424, 3944448, 3945472, 3946496, 4102144, 4103168, 3947520, 3957760, 3958784, 3988480, 3989504, 4019200, 4020224, 4108288, 4109312, 4048896, 3963904, 3964928, 3994624, 3995648, 4025344, 4026368, 4114432, 4115456, 4051968, 0, 0, 0
.long 2101248, 129, 4290560, 4291584, 4292608, 4293632, 4294656, 4295680, 4456448, 4457472, 4296704, 4312064, 4313088, 4342784, 4343808, 4373504, 4374528, 4462592, 4463616, 4404224, 4318208, 4319232, 4348928, 4349952, 4379648, 4380672, 4468736, 4469760, 4407296, 0, 0, 0
.long 2101248, 129, 4539392, 4540416, 4541440, 4542464, 4543488, 4544512, 4782080, 4783104, 4545536, 4546560, 4547584, 4548608, 4549632, 4550656, 4551680, 4784128, 4785152, 4552704, 4553728, 4554752, 4555776, 4556800, 4557824, 4558848, 4786176, 4787200, 4559872, 0, 0, 0
.long 2101248, 129, 5017600, 5018624, 5019648, 5020672, 5021696, 5022720, 5173248, 5174272, 5023744, 5028864, 5029888, 5059584, 5060608, 5090304, 5091328, 5179392, 5180416, 5118976, 5035008, 5036032, 5065728, 5066752, 5096448, 5097472, 5185536, 5186560, 5122048, 0, 0, 0
.long 2211840, 129, 3976192, 3977216, 4006912, 4007936, 4037632, 4038656, 4126720, 4127744, 4058112, 3982336, 3983360, 4013056, 4014080, 4043776, 4044800, 4132864, 4133888, 4061184, 3970048, 3971072, 4000768, 4001792, 4031488, 4032512, 4120576, 4121600, 4055040, 0, 0, 0
.long 2211840, 129, 4330496, 4331520, 4361216, 4362240, 4391936, 4392960, 4481024, 4482048, 4413440, 4336640, 4337664, 4367360, 4368384, 4398080, 4399104, 4487168, 4488192, 4416512, 4324352, 4325376, 4355072, 4356096, 4385792, 4386816, 4474880, 4475904, 4410368, 0, 0, 0
.long 2211840, 129, 4568064, 4569088, 4570112, 4571136, 4572160, 4573184, 4790272, 4791296, 4574208, 4575232, 4576256, 4577280, 4578304, 4579328, 4580352, 4792320, 4793344, 4581376, 4560896, 4561920, 4562944, 4563968, 4564992, 4566016, 4788224, 4789248, 4567040, 0, 0, 0
.long 2211840, 129, 5047296, 5048320, 5078016, 5079040, 5108736, 5109760, 5197824, 5198848, 5128192, 5053440, 5054464, 5084160, 5085184, 5114880, 5115904, 5203968, 5204992, 5131264, 5041152, 5042176, 5071872, 5072896, 5102592, 5103616, 5191680, 5192704, 5125120, 0, 0, 0
.long 2322432, 129, 3972096, 3973120, 4002816, 4003840, 4033536, 4034560, 4122624, 4123648, 4056064, 3884032, 3885056, 3886080, 3887104, 3888128, 3889152, 4085760, 4086784, 3890176, 3905536, 3906560, 3907584, 3908608, 3909632, 3910656, 4091904, 4092928, 3911680, 0, 0, 0
.long 2322432, 129, 4326400, 4327424, 4357120, 4358144, 4387840, 4388864, 4476928, 4477952, 4411392, 4233216, 4234240, 4235264, 4236288, 4237312, 4238336, 4440064, 4441088, 4239360, 4254720, 4255744, 4256768, 4257792, 4258816, 4259840, 4446208, 4447232, 4260864, 0, 0, 0
.long 2322432, 129, 4680704, 4681728, 4711424, 4712448, 4742144, 4743168, 4831232, 4832256, 4766720, 4582400, 4583424, 4584448, 4585472, 4586496, 4587520, 4794368, 4795392, 4588544, 4603904, 4604928, 4605952, 4606976, 4608000, 4609024, 4800512, 4801536, 4610048, 0, 0, 0
.long 2322432, 129, 4917248, 4918272, 4919296, 4920320, 4921344, 4922368, 5144576, 5145600, 4923392, 4874240, 4875264, 4876288, 4877312, 4878336, 4879360, 5132288, 5133312, 4880384, 4881408, 4882432, 4883456, 4884480, 4885504, 4886528, 5134336, 5135360, 4887552, 0, 0, 0
.long 2433024, 129, 3927040, 3928064, 3929088, 3930112, 3931136, 3932160, 4098048, 4099072, 3933184, 3948544, 3949568, 3950592, 3951616, 3952640, 3953664, 4104192, 4105216, 3954688, 3959808, 3960832, 3990528, 3991552, 4021248, 4022272, 4110336, 4111360, 4049920, 0, 0, 0
.long 2433024, 129, 4276224, 4277248, 4278272, 4279296, 4280320, 4281344, 4452352, 4453376, 4282368, 4297728, 4298752, 4299776, 4300800, 4301824, 4302848, 4458496, 4459520, 4303872, 4314112, 4315136, 4344832, 4345856, 4375552, 4376576, 4464640, 4465664, 4405248, 0, 0, 0
.long 2433024, 129, 4625408, 4626432, 4627456, 4628480, 4629504, 4630528, 4806656, 4807680, 4631552, 4646912, 4647936, 4648960, 4649984, 4651008, 4652032, 4812800, 4813824, 4653056, 4668416, 4669440, 4699136, 4700160, 4729856, 4730880, 4818944, 4819968, 4760576, 0, 0, 0
.long 2433024, 129, 4888576, 4889600, 4890624, 4891648, 4892672, 4893696, 5136384, 5137408, 4894720, 4895744, 4896768, 4897792, 4898816, 4899840, 4900864, 5138432, 5139456, 4901888, 4902912, 4903936, 4904960, 4905984, 4907008, 4908032, 5140480, 5141504, 4909056, 0, 0, 0
.long 2543616, 129, 3965952, 3966976, 3996672, 3997696, 4027392, 4028416, 4116480, 4117504, 4052992, 3978240, 3979264, 4008960, 4009984, 4039680, 4040704, 4128768, 4129792, 4059136, 3984384, 3985408, 4015104, 4016128, 4045824, 4046848, 4134912, 4135936, 4062208, 0, 0, 0
.long 2543616, 129, 4320256, 4321280, 4350976, 4352000, 4381696, 4382720, 4470784, 4471808, 4408320, 4332544, 4333568, 4363264, 4364288, 4393984, 4395008, 4483072, 4484096, 4414464, 4338688, 4339712, 4369408, 4370432, 4400128, 4401152, 4489216, 4490240, 4417536, 0, 0, 0
.long 2543616, 129, 4674560, 4675584, 4705280, 4706304, 4736000, 4737024, 4825088, 4826112, 4763648, 4686848, 4687872, 4717568, 4718592, 4748288, 4749312, 4837376, 4838400, 4769792, 4692992, 4694016, 4723712, 4724736, 4754432, 4755456, 4843520, 4844544, 4772864, 0, 0, 0
.long 2543616, 129, 4910080, 4911104, 4912128, 4913152, 4914176, 4915200, 5142528, 5143552, 4916224, 4924416, 4925440, 4926464, 4927488, 4928512, 4929536, 5146624, 5147648, 4930560, 4931584, 4932608, 4933632, 4934656, 4935680, 4936704, 5148672, 5149696, 4937728, 0, 0, 0
.long 2654208, 193, 5230592, 5231616, 5232640, 5233664, 5234688, 5235712, 5488640, 5489664, 5236736, 5237760, 5238784, 5239808, 5240832, 5241856, 5242880, 5490688, 5491712, 5243904, 5244928, 5245952, 5246976, 5248000, 5249024, 5250048, 5492736, 5493760, 5251072, 0, 0, 0
.long 2654208, 193, 5665792, 5666816, 5667840, 5668864, 5669888, 5670912, 5867520, 5868544, 5671936, 5687296, 5688320, 5689344, 5690368, 5691392, 5692416, 5873664, 5874688, 5693440, 5708800, 5709824, 5710848, 5711872, 5712896, 5713920, 5879808, 5880832, 5714944, 0, 0, 0
.long 2654208, 193, 6014976, 6016000, 6017024, 6018048, 6019072, 6020096, 6221824, 6222848, 6021120, 6036480, 6037504, 6038528, 6039552, 6040576, 6041600, 6227968, 6228992, 6042624, 6057984, 6059008, 6060032, 6061056, 6062080, 6063104, 6234112, 6235136, 6064128, 0, 0, 0
.long 2654208, 193, 6364160, 6365184, 6366208, 6367232, 6368256, 6369280, 6576128, 6577152, 6370304, 6385664, 6386688, 6387712, 6388736, 6389760, 6390784, 6582272, 6583296, 6391808, 6407168, 6408192, 6409216, 6410240, 6411264, 6412288, 6588416, 6589440, 6413312, 0, 0, 0
.long 2764800, 193, 5252096, 5253120, 5254144, 5255168, 5256192, 5257216, 5494784, 5495808, 5258240, 5259264, 5260288, 5261312, 5262336, 5263360, 5264384, 5496832, 5497856, 5265408, 5266432, 5267456, 5268480, 5269504, 5270528, 5271552, 5498880, 5499904, 5272576, 0, 0, 0
.long 2764800, 193, 5730304, 5731328, 5732352, 5733376, 5734400, 5735424, 5885952, 5886976, 5736448, 5741568, 5742592, 5772288, 5773312, 5803008, 5804032, 5892096, 5893120, 5831680, 5747712, 5748736, 5778432, 5779456, 5809152, 5810176, 5898240, 5899264, 5834752, 0, 0, 0
.long 2764800, 193, 6079488, 6080512, 6081536, 6082560, 6083584, 6084608, 6240256, 6241280, 6085632, 6095872, 6096896, 6126592, 6127616, 6157312, 6158336, 6246400, 6247424, 6187008, 6102016, 6103040, 6132736, 6133760, 6163456, 6164480, 6252544, 6253568, 6190080, 0, 0, 0
.long 2764800, 193, 6428672, 6429696, 6430720, 6431744, 6432768, 6433792, 6594560, 6595584, 6434816, 6450176, 6451200, 6480896, 6481920, 6511616, 6512640, 6600704, 6601728, 6542336, 6456320, 6457344, 6487040, 6488064, 6517760, 6518784, 6606848, 6607872, 6545408, 0, 0, 0
.long 2875392, 193, 5280768, 5281792, 5282816, 5283840, 5284864, 5285888, 5502976, 5504000, 5286912, 5287936, 5288960, 5289984, 5291008, 5292032, 5293056, 5505024, 5506048, 5294080, 5273600, 5274624, 5275648, 5276672, 5277696, 5278720, 5500928, 5501952, 5279744, 0, 0, 0
.long 2875392, 193, 5760000, 5761024, 5790720, 5791744, 5821440, 5822464, 5910528, 5911552, 5840896, 5766144, 5767168, 5796864, 5797888, 5827584, 5828608, 5916672, 5917696, 5843968, 5753856, 5754880, 5784576, 5785600, 5815296, 5816320, 5904384, 5905408, 5837824, 0, 0, 0
.long 2875392, 193, 6114304, 6115328, 6145024, 6146048, 6175744, 6176768, 6264832, 6265856, 6196224, 6120448, 6121472, 6151168, 6152192, 6181888, 6182912, 6270976, 6272000, 6199296, 6108160, 6109184, 6138880, 6139904, 6169600, 6170624, 6258688, 6259712, 6193152, 0, 0, 0
.long 2875392, 193, 6468608, 6469632, 6499328, 6500352, 6530048, 6531072, 6619136, 6620160, 6551552, 6474752, 6475776, 6505472, 6506496, 6536192, 6537216, 6625280, 6626304, 6554624, 6462464, 6463488, 6493184, 6494208, 6523904, 6524928, 6612992, 6614016, 6548480, 0, 0, 0
.long 2985984, 193, 5393408, 5394432, 5424128, 5425152, 5454848, 5455872, 5543936, 5544960, 5479424, 5295104, 5296128, 5297152, 5298176, 5299200, 5300224, 5507072, 5508096, 5301248, 5316608, 5317632, 5318656, 5319680, 5320704, 5321728, 5513216, 5514240, 5322752, 0, 0, 0
.long 2985984, 193, 5629952, 5630976, 5632000, 5633024, 5634048, 5635072, 5857280, 5858304, 5636096, 5586944, 5587968, 5588992, 5590016, 5591040, 5592064, 5844992, 5846016, 5593088, 5594112, 5595136, 5596160, 5597184, 5598208, 5599232, 5847040, 5848064, 5600256, 0, 0, 0
.long 2985984, 193, 6110208, 6111232, 6140928, 6141952, 6171648, 6172672, 6260736, 6261760, 6194176, 6022144, 6023168, 6024192, 6025216, 6026240, 6027264, 6223872, 6224896, 6028288, 6043648, 6044672, 6045696, 6046720, 6047744, 6048768, 6230016, 6231040, 6049792, 0, 0, 0
.long 2985984, 193, 6464512, 6465536, 6495232, 6496256, 6525952, 6526976, 6615040, 6616064, 6549504, 6371328, 6372352, 6373376, 6374400, 6375424, 6376448, 6578176, 6579200, 6377472, 6392832, 6393856, 6394880, 6395904, 6396928, 6397952, 6584320, 6585344, 6398976, 0, 0, 0
.long 3096576, 193, 5338112, 5339136, 5340160, 5341184, 5342208, 5343232, 5519360, 5520384, 5344256, 5359616, 5360640, 5361664, 5362688, 5363712, 5364736, 5525504, 5526528, 5365760, 5381120, 5382144, 5411840, 5412864, 5442560, 5443584, 5531648, 5532672, 5473280, 0, 0, 0
.long 3096576, 193, 5601280, 5602304, 5603328, 5604352, 5605376, 5606400, 5849088, 5850112, 5607424, 5608448, 5609472, 5610496, 5611520, 5612544, 5613568, 5851136, 5852160, 5614592, 5615616, 5616640, 5617664, 5618688, 5619712, 5620736, 5853184, 5854208, 5621760, 0, 0, 0
.long 3096576, 193, 6065152, 6066176, 6067200, 6068224, 6069248, 6070272, 6236160, 6237184, 6071296, 6086656, 6087680, 6088704, 6089728, 6090752, 6091776, 6242304, 6243328, 6092800, 6097920, 6098944, 6128640, 6129664, 6159360, 6160384, 6248448, 6249472, 6188032, 0, 0, 0
.long 3096576, 193, 6414336, 6415360, 6416384, 6417408, 6418432, 6419456, 6590464, 6591488, 6420480, 6435840, 6436864, 6437888, 6438912, 6439936, 6440960, 6596608, 6597632, 6441984, 6452224, 6453248, 6482944, 6483968, 6513664, 6514688, 6602752, 6603776, 6543360, 0, 0, 0
.long 3207168, 193, 5387264, 5388288, 5417984, 5419008, 5448704, 5449728, 5537792, 5538816, 5476352, 5399552, 5400576, 5430272, 5431296, 5460992, 5462016, 5550080, 5551104, 5482496, 5405696, 5406720, 5436416, 5437440, 5467136, 5468160, 5556224, 5557248, 5485568, 0, 0, 0
.long 3207168, 193, 5622784, 5623808, 5624832, 5625856, 5626880, 5627904, 5855232, 5856256, 5628928, 5637120, 5638144, 5639168, 5640192, 5641216, 5642240, 5859328, 5860352, 5643264, 5644288, 5645312, 5646336, 5647360, 5648384, 5649408, 5861376, 5862400, 5650432, 0, 0, 0
.long 3207168, 193, 6104064, 6105088, 6134784, 6135808, 6165504, 6166528, 6254592, 6255616, 6191104, 6116352, 6117376, 6147072, 6148096, 6177792, 6178816, 6266880, 6267904, 6197248, 6122496, 6123520, 6153216, 6154240, 6183936, 6184960, 6273024, 6274048, 6200320, 0, 0, 0
.long 3207168, 193, 6458368, 6459392, 6489088, 6490112, 6519808, 6520832, 6608896, 6609920, 6546432, 6470656, 6471680, 6501376, 6502400, 6532096, 6533120, 6621184, 6622208, 6552576, 6476800, 6477824, 6507520, 6508544, 6538240, 6539264, 6627328, 6628352, 6555648, 0, 0, 0
.long 3317760, 193, 5302272, 5303296, 5304320, 5305344, 5306368, 5307392, 5509120, 5510144, 5308416, 5323776, 5324800, 5325824, 5326848, 5327872, 5328896, 5515264, 5516288, 5329920, 5345280, 5346304, 5347328, 5348352, 5349376, 5350400, 5521408, 5522432, 5351424, 0, 0, 0
.long 3317760, 193, 5651456, 5652480, 5653504, 5654528, 5655552, 5656576, 5863424, 5864448, 5657600, 5672960, 5673984, 5675008, 5676032, 5677056, 5678080, 5869568, 5870592, 5679104, 5694464, 5695488, 5696512, 5697536, 5698560, 5699584, 5875712, 5876736, 5700608, 0, 0, 0
.long 3317760, 193, 5943296, 5944320, 5945344, 5946368, 5947392, 5948416, 6201344, 6202368, 5949440, 5950464, 5951488, 5952512, 5953536, 5954560, 5955584, 6203392, 6204416, 5956608, 5957632, 5958656, 5959680, 5960704, 5961728, 5962752, 6205440, 6206464, 5963776, 0, 0, 0
.long 3317760, 193, 6378496, 6379520, 6380544, 6381568, 6382592, 6383616, 6580224, 6581248, 6384640, 6400000, 6401024, 6402048, 6403072, 6404096, 6405120, 6586368, 6587392, 6406144, 6421504, 6422528, 6423552, 6424576, 6425600, 6426624, 6592512, 6593536, 6427648, 0, 0, 0
.long 3428352, 193, 5366784, 5367808, 5368832, 5369856, 5370880, 5371904, 5527552, 5528576, 5372928, 5383168, 5384192, 5413888, 5414912, 5444608, 5445632, 5533696, 5534720, 5474304, 5389312, 5390336, 5420032, 5421056, 5450752, 5451776, 5539840, 5540864, 5477376, 0, 0, 0
.long 3428352, 193, 5715968, 5716992, 5718016, 5719040, 5720064, 5721088, 5881856, 5882880, 5722112, 5737472, 5738496, 5768192, 5769216, 5798912, 5799936, 5888000, 5889024, 5829632, 5743616, 5744640, 5774336, 5775360, 5805056, 5806080, 5894144, 5895168, 5832704, 0, 0, 0
.long 3428352, 193, 5964800, 5965824, 5966848, 5967872, 5968896, 5969920, 6207488, 6208512, 5970944, 5971968, 5972992, 5974016, 5975040, 5976064, 5977088, 6209536, 6210560, 5978112, 5979136, 5980160, 5981184, 5982208, 5983232, 5984256, 6211584, 6212608, 5985280, 0, 0, 0
.long 3428352, 193, 6443008, 6444032, 6445056, 6446080, 6447104, 6448128, 6598656, 6599680, 6449152, 6454272, 6455296, 6484992, 6486016, 6515712, 6516736, 6604800, 6605824, 6544384, 6460416, 6461440, 6491136, 6492160, 6521856, 6522880, 6610944, 6611968, 6547456, 0, 0, 0
.long 3538944, 193, 5401600, 5402624, 5432320, 5433344, 5463040, 5464064, 5552128, 5553152, 5483520, 5407744, 5408768, 5438464, 5439488, 5469184, 5470208, 5558272, 5559296, 5486592, 5395456, 5396480, 5426176, 5427200, 5456896, 5457920, 5545984, 5547008, 5480448, 0, 0, 0
.long 3538944, 193, 5755904, 5756928, 5786624, 5787648, 5817344, 5818368, 5906432, 5907456, 5838848, 5762048, 5763072, 5792768, 5793792, 5823488, 5824512, 5912576, 5913600, 5841920, 5749760, 5750784, 5780480, 5781504, 5811200, 5812224, 5900288, 5901312, 5835776, 0, 0, 0
.long 3538944, 193, 5993472, 5994496, 5995520, 5996544, 5997568, 5998592, 6215680, 6216704, 5999616, 6000640, 6001664, 6002688, 6003712, 6004736, 6005760, 6217728, 6218752, 6006784, 5986304, 5987328, 5988352, 5989376, 5990400, 5991424, 6213632, 6214656, 5992448, 0, 0, 0
.long 3538944, 193, 6472704, 6473728, 6503424, 6504448, 6534144, 6535168, 6623232, 6624256, 6553600, 6478848, 6479872, 6509568, 6510592, 6540288, 6541312, 6629376, 6630400, 6556672, 6466560, 6467584, 6497280, 6498304, 6528000, 6529024, 6617088, 6618112, 6550528, 0, 0, 0
.long 3649536, 193, 5397504, 5398528, 5428224, 5429248, 5458944, 5459968, 5548032, 5549056, 5481472, 5309440, 5310464, 5311488, 5312512, 5313536, 5314560, 5511168, 5512192, 5315584, 5330944, 5331968, 5332992, 5334016, 5335040, 5336064, 5517312, 5518336, 5337088, 0, 0, 0
.long 3649536, 193, 5751808, 5752832, 5782528, 5783552, 5813248, 5814272, 5902336, 5903360, 5836800, 5658624, 5659648, 5660672, 5661696, 5662720, 5663744, 5865472, 5866496, 5664768, 5680128, 5681152, 5682176, 5683200, 5684224, 5685248, 5871616, 5872640, 5686272, 0, 0, 0
.long 3649536, 193, 6106112, 6107136, 6136832, 6137856, 6167552, 6168576, 6256640, 6257664, 6192128, 6007808, 6008832, 6009856, 6010880, 6011904, 6012928, 6219776, 6220800, 6013952, 6029312, 6030336, 6031360, 6032384, 6033408, 6034432, 6225920, 6226944, 6035456, 0, 0, 0
.long 3649536, 193, 6342656, 6343680, 6344704, 6345728, 6346752, 6347776, 6569984, 6571008, 6348800, 6299648, 6300672, 6301696, 6302720, 6303744, 6304768, 6557696, 6558720, 6305792, 6306816, 6307840, 6308864, 6309888, 6310912, 6311936, 6559744, 6560768, 6312960, 0, 0, 0
.long 3760128, 193, 5352448, 5353472, 5354496, 5355520, 5356544, 5357568, 5523456, 5524480, 5358592, 5373952, 5374976, 5376000, 5377024, 5378048, 5379072, 5529600, 5530624, 5380096, 5385216, 5386240, 5415936, 5416960, 5446656, 5447680, 5535744, 5536768, 5475328, 0, 0, 0
.long 3760128, 193, 5701632, 5702656, 5703680, 5704704, 5705728, 5706752, 5877760, 5878784, 5707776, 5723136, 5724160, 5725184, 5726208, 5727232, 5728256, 5883904, 5884928, 5729280, 5739520, 5740544, 5770240, 5771264, 5800960, 5801984, 5890048, 5891072, 5830656, 0, 0, 0
.long 3760128, 193, 6050816, 6051840, 6052864, 6053888, 6054912, 6055936, 6232064, 6233088, 6056960, 6072320, 6073344, 6074368, 6075392, 6076416, 6077440, 6238208, 6239232, 6078464, 6093824, 6094848, 6124544, 6125568, 6155264, 6156288, 6244352, 6245376, 6185984, 0, 0, 0
.long 3760128, 193, 6313984, 6315008, 6316032, 6317056, 6318080, 6319104, 6561792, 6562816, 6320128, 6321152, 6322176, 6323200, 6324224, 6325248, 6326272, 6563840, 6564864, 6327296, 6328320, 6329344, 6330368, 6331392, 6332416, 6333440, 6565888, 6566912, 6334464, 0, 0, 0
.long 3870720, 193, 5391360, 5392384, 5422080, 5423104, 5452800, 5453824, 5541888, 5542912, 5478400, 5403648, 5404672, 5434368, 5435392, 5465088, 5466112, 5554176, 5555200, 5484544, 5409792, 5410816, 5440512, 5441536, 5471232, 5472256, 5560320, 5561344, 5487616, 0, 0, 0
.long 3870720, 193, 5745664, 5746688, 5776384, 5777408, 5807104, 5808128, 5896192, 5897216, 5833728, 5757952, 5758976, 5788672, 5789696, 5819392, 5820416, 5908480, 5909504, 5839872, 5764096, 5765120, 5794816, 5795840, 5825536, 5826560, 5914624, 5915648, 5842944, 0, 0, 0
.long 3870720, 193, 6099968, 6100992, 6130688, 6131712, 6161408, 6162432, 6250496, 6251520, 6189056, 6112256, 6113280, 6142976, 6144000, 6173696, 6174720, 6262784, 6263808, 6195200, 6118400, 6119424, 6149120, 6150144, 6179840, 6180864, 6268928, 6269952, 6198272, 0, 0, 0
.long 3870720, 193, 6335488, 6336512, 6337536, 6338560, 6339584, 6340608, 6567936, 6568960, 6341632, 6349824, 6350848, 6351872, 6352896, 6353920, 6354944, 6572032, 6573056, 6355968, 6356992, 6358016, 6359040, 6360064, 6361088, 6362112, 6574080, 6575104, 6363136, 0, 0, 0
.long 3981312, 1, 6656000, 6657024, 6658048, 6659072, 6660096, 6661120, 6914048, 6915072, 6662144, 6663168, 6664192, 6665216, 6666240, 6667264, 6668288, 6916096, 6917120, 6669312, 6670336, 6671360, 6672384, 6673408, 6674432, 6675456, 6918144, 6919168, 6676480, 0, 0, 0
.long 3981312, 1, 7091200, 7092224, 7093248, 7094272, 7095296, 7096320, 7292928, 7293952, 7097344, 7112704, 7113728, 7114752, 7115776, 7116800, 7117824, 7299072, 7300096, 7118848, 7134208, 7135232, 7136256, 7137280, 7138304, 7139328, 7305216, 7306240, 7140352, 0, 0, 0
.long 3981312, 1, 7440384, 7441408, 7442432, 7443456, 7444480, 7445504, 7647232, 7648256, 7446528, 7461888, 7462912, 7463936, 7464960, 7465984, 7467008, 7653376, 7654400, 7468032, 7483392, 7484416, 7485440, 7486464, 7487488, 7488512, 7659520, 7660544, 7489536, 0, 0, 0
.long 3981312, 1, 7789568, 7790592, 7791616, 7792640, 7793664, 7794688, 8001536, 8002560, 7795712, 7811072, 7812096, 7813120, 7814144, 7815168, 7816192, 8007680, 8008704, 7817216, 7832576, 7833600, 7834624, 7835648, 7836672, 7837696, 8013824, 8014848, 7838720, 0, 0, 0
.long 4091904, 1, 6677504, 6678528, 6679552, 6680576, 6681600, 6682624, 6920192, 6921216, 6683648, 6684672, 6685696, 6686720, 6687744, 6688768, 6689792, 6922240, 6923264, 6690816, 6691840, 6692864, 6693888, 6694912, 6695936, 6696960, 6924288, 6925312, 6697984, 0, 0, 0
.long 4091904, 1, 7155712, 7156736, 7157760, 7158784, 7159808, 7160832, 7311360, 7312384, 7161856, 7166976, 7168000, 7197696, 7198720, 7228416, 7229440, 7317504, 7318528, 7257088, 7173120, 7174144, 7203840, 7204864, 7234560, 7235584, 7323648, 7324672, 7260160, 0, 0, 0
.long 4091904, 1, 7504896, 7505920, 7506944, 7507968, 7508992, 7510016, 7665664, 7666688, 7511040, 7521280, 7522304, 7552000, 7553024, 7582720, 7583744, 7671808, 7672832, 7612416, 7527424, 7528448, 7558144, 7559168, 7588864, 7589888, 7677952, 7678976, 7615488, 0, 0, 0
.long 4091904, 1, 7854080, 7855104, 7856128, 7857152, 7858176, 7859200, 8019968, 8020992, 7860224, 7875584, 7876608, 7906304, 7907328, 7937024, 7938048, 8026112, 8027136, 7967744, 7881728, 7882752, 7912448, 7913472, 7943168, 7944192, 8032256, 8033280, 7970816, 0, 0, 0
.long 4202496, 1, 6706176, 6707200, 6708224, 6709248, 6710272, 6711296, 6928384, 6929408, 6712320, 6713344, 6714368, 6715392, 6716416, 6717440, 6718464, 6930432, 6931456, 6719488, 6699008, 6700032, 6701056, 6702080, 6703104, 6704128, 6926336, 6927360, 6705152, 0, 0, 0
.long 4202496, 1, 7185408, 7186432, 7216128, 7217152, 7246848, 7247872, 7335936, 7336960, 7266304, 7191552, 7192576, 7222272, 7223296, 7252992, 7254016, 7342080, 7343104, 7269376, 7179264, 7180288, 7209984, 7211008, 7240704, 7241728, 7329792, 7330816, 7263232, 0, 0, 0
.long 4202496, 1, 7539712, 7540736, 7570432, 7571456, 7601152, 7602176, 7690240, 7691264, 7621632, 7545856, 7546880, 7576576, 7577600, 7607296, 7608320, 7696384, 7697408, 7624704, 7533568, 7534592, 7564288, 7565312, 7595008, 7596032, 7684096, 7685120, 7618560, 0, 0, 0
.long 4202496, 1, 7894016, 7895040, 7924736, 7925760, 7955456, 7956480, 8044544, 8045568, 7976960, 7900160, 7901184, 7930880, 7931904, 7961600, 7962624, 8050688, 8051712, 7980032, 7887872, 7888896, 7918592, 7919616, 7949312, 7950336, 8038400, 8039424, 7973888, 0, 0, 0
.long 4313088, 1, 6818816, 6819840, 6849536, 6850560, 6880256, 6881280, 6969344, 6970368, 6904832, 6720512, 6721536, 6722560, 6723584, 6724608, 6725632, 6932480, 6933504, 6726656, 6742016, 6743040, 6744064, 6745088, 6746112, 6747136, 6938624, 6939648, 6748160, 0, 0, 0
.long 4313088, 1, 7055360, 7056384, 7057408, 7058432, 7059456, 7060480, 7282688, 7283712, 7061504, 7012352, 7013376, 7014400, 7015424, 7016448, 7017472, 7270400, 7271424, 7018496, 7019520, 7020544, 7021568, 7022592, 7023616, 7024640, 7272448, 7273472, 7025664, 0, 0, 0
.long 4313088, 1, 7535616, 7536640, 7566336, 7567360, 7597056, 7598080, 7686144, 7687168, 7619584, 7447552, 7448576, 7449600, 7450624, 7451648, 7452672, 7649280, 7650304, 7453696, 7469056, 7470080, 7471104, 7472128, 7473152, 7474176, 7655424, 7656448, 7475200, 0, 0, 0
.long 4313088, 1, 7889920, 7890944, 7920640, 7921664, 7951360, 7952384, 8040448, 8041472, 7974912, 7796736, 7797760, 7798784, 7799808, 7800832, 7801856, 8003584, 8004608, 7802880, 7818240, 7819264, 7820288, 7821312, 7822336, 7823360, 8009728, 8010752, 7824384, 0, 0, 0
.long 4423680, 1, 6763520, 6764544, 6765568, 6766592, 6767616, 6768640, 6944768, 6945792, 6769664, 6785024, 6786048, 6787072, 6788096, 6789120, 6790144, 6950912, 6951936, 6791168, 6806528, 6807552, 6837248, 6838272, 6867968, 6868992, 6957056, 6958080, 6898688, 0, 0, 0
.long 4423680, 1, 7026688, 7027712, 7028736, 7029760, 7030784, 7031808, 7274496, 7275520, 7032832, 7033856, 7034880, 7035904, 7036928, 7037952, 7038976, 7276544, 7277568, 7040000, 7041024, 7042048, 7043072, 7044096, 7045120, 7046144, 7278592, 7279616, 7047168, 0, 0, 0
.long 4423680, 1, 7490560, 7491584, 7492608, 7493632, 7494656, 7495680, 7661568, 7662592, 7496704, 7512064, 7513088, 7514112, 7515136, 7516160, 7517184, 7667712, 7668736, 7518208, 7523328, 7524352, 7554048, 7555072, 7584768, 7585792, 7673856, 7674880, 7613440, 0, 0, 0
.long 4423680, 1, 7839744, 7840768, 7841792, 7842816, 7843840, 7844864, 8015872, 8016896, 7845888, 7861248, 7862272, 7863296, 7864320, 7865344, 7866368, 8022016, 8023040, 7867392, 7877632, 7878656, 7908352, 7909376, 7939072, 7940096, 8028160, 8029184, 7968768, 0, 0, 0
.long 4534272, 1, 6812672, 6813696, 6843392, 6844416, 6874112, 6875136, 6963200, 6964224, 6901760, 6824960, 6825984, 6855680, 6856704, 6886400, 6887424, 6975488, 6976512, 6907904, 6831104, 6832128, 6861824, 6862848, 6892544, 6893568, 6981632, 6982656, 6910976, 0, 0, 0
.long 4534272, 1, 7048192, 7049216, 7050240, 7051264, 7052288, 7053312, 7280640, 7281664, 7054336, 7062528, 7063552, 7064576, 7065600, 7066624, 7067648, 7284736, 7285760, 7068672, 7069696, 7070720, 7071744, 7072768, 7073792, 7074816, 7286784, 7287808, 7075840, 0, 0, 0
.long 4534272, 1, 7529472, 7530496, 7560192, 7561216, 7590912, 7591936, 7680000, 7681024, 7616512, 7541760, 7542784, 7572480, 7573504, 7603200, 7604224, 7692288, 7693312, 7622656, 7547904, 7548928, 7578624, 7579648, 7609344, 7610368, 7698432, 7699456, 7625728, 0, 0, 0
.long 4534272, 1, 7883776, 7884800, 7914496, 7915520, 7945216, 7946240, 8034304, 8035328, 7971840, 7896064, 7897088, 7926784, 7927808, 7957504, 7958528, 8046592, 8047616, 7977984, 7902208, 7903232, 7932928, 7933952, 7963648, 7964672, 8052736, 8053760, 7981056, 0, 0, 0
.long 4644864, 1, 6727680, 6728704, 6729728, 6730752, 6731776, 6732800, 6934528, 6935552, 6733824, 6749184, 6750208, 6751232, 6752256, 6753280, 6754304, 6940672, 6941696, 6755328, 6770688, 6771712, 6772736, 6773760, 6774784, 6775808, 6946816, 6947840, 6776832, 0, 0, 0
.long 4644864, 1, 7076864, 7077888, 7078912, 7079936, 7080960, 7081984, 7288832, 7289856, 7083008, 7098368, 7099392, 7100416, 7101440, 7102464, 7103488, 7294976, 7296000, 7104512, 7119872, 7120896, 7121920, 7122944, 7123968, 7124992, 7301120, 7302144, 7126016, 0, 0, 0
.long 4644864, 1, 7368704, 7369728, 7370752, 7371776, 7372800, 7373824, 7626752, 7627776, 7374848, 7375872, 7376896, 7377920, 7378944, 7379968, 7380992, 7628800, 7629824, 7382016, 7383040, 7384064, 7385088, 7386112, 7387136, 7388160, 7630848, 7631872, 7389184, 0, 0, 0
.long 4644864, 1, 7803904, 7804928, 7805952, 7806976, 7808000, 7809024, 8005632, 8006656, 7810048, 7825408, 7826432, 7827456, 7828480, 7829504, 7830528, 8011776, 8012800, 7831552, 7846912, 7847936, 7848960, 7849984, 7851008, 7852032, 8017920, 8018944, 7853056, 0, 0, 0
.long 4755456, 1, 6792192, 6793216, 6794240, 6795264, 6796288, 6797312, 6952960, 6953984, 6798336, 6808576, 6809600, 6839296, 6840320, 6870016, 6871040, 6959104, 6960128, 6899712, 6814720, 6815744, 6845440, 6846464, 6876160, 6877184, 6965248, 6966272, 6902784, 0, 0, 0
.long 4755456, 1, 7141376, 7142400, 7143424, 7144448, 7145472, 7146496, 7307264, 7308288, 7147520, 7162880, 7163904, 7193600, 7194624, 7224320, 7225344, 7313408, 7314432, 7255040, 7169024, 7170048, 7199744, 7200768, 7230464, 7231488, 7319552, 7320576, 7258112, 0, 0, 0
.long 4755456, 1, 7390208, 7391232, 7392256, 7393280, 7394304, 7395328, 7632896, 7633920, 7396352, 7397376, 7398400, 7399424, 7400448, 7401472, 7402496, 7634944, 7635968, 7403520, 7404544, 7405568, 7406592, 7407616, 7408640, 7409664, 7636992, 7638016, 7410688, 0, 0, 0
.long 4755456, 1, 7868416, 7869440, 7870464, 7871488, 7872512, 7873536, 8024064, 8025088, 7874560, 7879680, 7880704, 7910400, 7911424, 7941120, 7942144, 8030208, 8031232, 7969792, 7885824, 7886848, 7916544, 7917568, 7947264, 7948288, 8036352, 8037376, 7972864, 0, 0, 0
.long 4866048, 1, 6827008, 6828032, 6857728, 6858752, 6888448, 6889472, 6977536, 6978560, 6908928, 6833152, 6834176, 6863872, 6864896, 6894592, 6895616, 6983680, 6984704, 6912000, 6820864, 6821888, 6851584, 6852608, 6882304, 6883328, 6971392, 6972416, 6905856, 0, 0, 0
.long 4866048, 1, 7181312, 7182336, 7212032, 7213056, 7242752, 7243776, 7331840, 7332864, 7264256, 7187456, 7188480, 7218176, 7219200, 7248896, 7249920, 7337984, 7339008, 7267328, 7175168, 7176192, 7205888, 7206912, 7236608, 7237632, 7325696, 7326720, 7261184, 0, 0, 0
.long 4866048, 1, 7418880, 7419904, 7420928, 7421952, 7422976, 7424000, 7641088, 7642112, 7425024, 7426048, 7427072, 7428096, 7429120, 7430144, 7431168, 7643136, 7644160, 7432192, 7411712, 7412736, 7413760, 7414784, 7415808, 7416832, 7639040, 7640064, 7417856, 0, 0, 0
.long 4866048, 1, 7898112, 7899136, 7928832, 7929856, 7959552, 7960576, 8048640, 8049664, 7979008, 7904256, 7905280, 7934976, 7936000, 7965696, 7966720, 8054784, 8055808, 7982080, 7891968, 7892992, 7922688, 7923712, 7953408, 7954432, 8042496, 8043520, 7975936, 0, 0, 0
.long 4976640, 1, 6822912, 6823936, 6853632, 6854656, 6884352, 6885376, 6973440, 6974464, 6906880, 6734848, 6735872, 6736896, 6737920, 6738944, 6739968, 6936576, 6937600, 6740992, 6756352, 6757376, 6758400, 6759424, 6760448, 6761472, 6942720, 6943744, 6762496, 0, 0, 0
.long 4976640, 1, 7177216, 7178240, 7207936, 7208960, 7238656, 7239680, 7327744, 7328768, 7262208, 7084032, 7085056, 7086080, 7087104, 7088128, 7089152, 7290880, 7291904, 7090176, 7105536, 7106560, 7107584, 7108608, 7109632, 7110656, 7297024, 7298048, 7111680, 0, 0, 0
.long 4976640, 1, 7531520, 7532544, 7562240, 7563264, 7592960, 7593984, 7682048, 7683072, 7617536, 7433216, 7434240, 7435264, 7436288, 7437312, 7438336, 7645184, 7646208, 7439360, 7454720, 7455744, 7456768, 7457792, 7458816, 7459840, 7651328, 7652352, 7460864, 0, 0, 0
.long 4976640, 1, 7768064, 7769088, 7770112, 7771136, 7772160, 7773184, 7995392, 7996416, 7774208, 7725056, 7726080, 7727104, 7728128, 7729152, 7730176, 7983104, 7984128, 7731200, 7732224, 7733248, 7734272, 7735296, 7736320, 7737344, 7985152, 7986176, 7738368, 0, 0, 0
.long 5087232, 1, 6777856, 6778880, 6779904, 6780928, 6781952, 6782976, 6948864, 6949888, 6784000, 6799360, 6800384, 6801408, 6802432, 6803456, 6804480, 6955008, 6956032, 6805504, 6810624, 6811648, 6841344, 6842368, 6872064, 6873088, 6961152, 6962176, 6900736, 0, 0, 0
.long 5087232, 1, 7127040, 7128064, 7129088, 7130112, 7131136, 7132160, 7303168, 7304192, 7133184, 7148544, 7149568, 7150592, 7151616, 7152640, 7153664, 7309312, 7310336, 7154688, 7164928, 7165952, 7195648, 7196672, 7226368, 7227392, 7315456, 7316480, 7256064, 0, 0, 0
.long 5087232, 1, 7476224, 7477248, 7478272, 7479296, 7480320, 7481344, 7657472, 7658496, 7482368, 7497728, 7498752, 7499776, 7500800, 7501824, 7502848, 7663616, 7664640, 7503872, 7519232, 7520256, 7549952, 7550976, 7580672, 7581696, 7669760, 7670784, 7611392, 0, 0, 0
.long 5087232, 1, 7739392, 7740416, 7741440, 7742464, 7743488, 7744512, 7987200, 7988224, 7745536, 7746560, 7747584, 7748608, 7749632, 7750656, 7751680, 7989248, 7990272, 7752704, 7753728, 7754752, 7755776, 7756800, 7757824, 7758848, 7991296, 7992320, 7759872, 0, 0, 0
.long 5197824, 1, 6816768, 6817792, 6847488, 6848512, 6878208, 6879232, 6967296, 6968320, 6903808, 6829056, 6830080, 6859776, 6860800, 6890496, 6891520, 6979584, 6980608, 6909952, 6835200, 6836224, 6865920, 6866944, 6896640, 6897664, 6985728, 6986752, 6913024, 0, 0, 0
.long 5197824, 1, 7171072, 7172096, 7201792, 7202816, 7232512, 7233536, 7321600, 7322624, 7259136, 7183360, 7184384, 7214080, 7215104, 7244800, 7245824, 7333888, 7334912, 7265280, 7189504, 7190528, 7220224, 7221248, 7250944, 7251968, 7340032, 7341056, 7268352, 0, 0, 0
.long 5197824, 1, 7525376, 7526400, 7556096, 7557120, 7586816, 7587840, 7675904, 7676928, 7614464, 7537664, 7538688, 7568384, 7569408, 7599104, 7600128, 7688192, 7689216, 7620608, 7543808, 7544832, 7574528, 7575552, 7605248, 7606272, 7694336, 7695360, 7623680, 0, 0, 0
.long 5197824, 1, 7760896, 7761920, 7762944, 7763968, 7764992, 7766016, 7993344, 7994368, 7767040, 7775232, 7776256, 7777280, 7778304, 7779328, 7780352, 7997440, 7998464, 7781376, 7782400, 7783424, 7784448, 7785472, 7786496, 7787520, 7999488, 8000512, 7788544, 0, 0, 0
.long 0, 2, 128, 128, 2363392, 256, 256, 2367488, 384, 384, 2373632, 0, 0, 0, 0, 0, 0, 0, 0, 0, 0, 0, 0, 0, 0, 0, 0, 0, 0, 0, 0, 2359296
.long 0, 2, 128, 160, 2364416, 256, 288, 2368512, 384, 416, 2374656, 0, 0, 0, 0, 0, 0, 0, 0, 0, 0, 0, 0, 0, 0, 0, 0, 0, 0, 0, 32, 2360320
.long 0, 2, 128, 192, 2365440, 256, 320, 2369536, 384, 448, 2375680, 0, 0, 0, 0, 0, 0, 0, 0, 0, 0, 0, 0, 0, 0, 0, 0, 0, 0, 0, 64, 2361344
.long 0, 2, 128, 224, 2366464, 256, 352, 2370560, 384, 480, 2376704, 0, 0, 0, 0, 0, 0, 0, 0, 0, 0, 0, 0, 0, 0, 0, 0, 0, 0, 0, 96, 2362368
.long 0, 2, 1280, 1280, 3076096, 1408, 1408, 3080192, 1536, 1536, 3086336, 0, 0, 0, 0, 0, 0, 0, 0, 0, 0, 0, 0, 0, 0, 0, 0, 0, 0, 1152, 1152, 3072000
.long 0, 2, 1280, 1312, 3077120, 1408, 1440, 3081216, 1536, 1568, 3087360, 0, 0, 0, 0, 0, 0, 0, 0, 0, 0, 0, 0, 0, 0, 0, 0, 0, 0, 1152, 1184, 3073024
.long 0, 2, 1280, 1344, 3078144, 1408, 1472, 3082240, 1536, 1600, 3088384, 0, 0, 0, 0, 0, 0, 0, 0, 0, 0, 0, 0, 0, 0, 0, 0, 0, 0, 1152, 1216, 3074048
.long 0, 2, 1280, 1376, 3079168, 1408, 1504, 3083264, 1536, 1632, 3089408, 0, 0, 0, 0, 0, 0, 0, 0, 0, 0, 0, 0, 0, 0, 0, 0, 0, 0, 1152, 1248, 3075072
.long 0, 2, 2432, 2432, 3788800, 2560, 2560, 3792896, 2688, 2688, 3799040, 0, 0, 0, 0, 0, 0, 0, 0, 0, 0, 0, 0, 0, 0, 0, 0, 0, 0, 2304, 2304, 3784704
.long 0, 2, 2432, 2464, 3789824, 2560, 2592, 3793920, 2688, 2720, 3800064, 0, 0, 0, 0, 0, 0, 0, 0, 0, 0, 0, 0, 0, 0, 0, 0, 0, 0, 2304, 2336, 3785728
.long 0, 2, 2432, 2496, 3790848, 2560, 2624, 3794944, 2688, 2752, 3801088, 0, 0, 0, 0, 0, 0, 0, 0, 0, 0, 0, 0, 0, 0, 0, 0, 0, 0, 2304, 2368, 3786752
.long 0, 2, 2432, 2528, 3791872, 2560, 2656, 3795968, 2688, 2784, 3802112, 0, 0, 0, 0, 0, 0, 0, 0, 0, 0, 0, 0, 0, 0, 0, 0, 0, 0, 2304, 2400, 3787776
.long 0, 2, 3584, 3584, 4501504, 3712, 3712, 4505600, 3840, 3840, 4511744, 0, 0, 0, 0, 0, 0, 0, 0, 0, 0, 0, 0, 0, 0, 0, 0, 0, 0, 3456, 3456, 4497408
.long 0, 2, 3584, 3616, 4502528, 3712, 3744, 4506624, 3840, 3872, 4512768, 0, 0, 0, 0, 0, 0, 0, 0, 0, 0, 0, 0, 0, 0, 0, 0, 0, 0, 3456, 3488, 4498432
.long 0, 2, 3584, 3648, 4503552, 3712, 3776, 4507648, 3840, 3904, 4513792, 0, 0, 0, 0, 0, 0, 0, 0, 0, 0, 0, 0, 0, 0, 0, 0, 0, 0, 3456, 3520, 4499456
.long 0, 2, 3584, 3680, 4504576, 3712, 3808, 4508672, 3840, 3936, 4514816, 0, 0, 0, 0, 0, 0, 0, 0, 0, 0, 0, 0, 0, 0, 0, 0, 0, 0, 3456, 3552, 4500480
.long 0, 2, 4736, 4736, 5214208, 4864, 4864, 5218304, 4992, 4992, 5224448, 0, 0, 0, 0, 0, 0, 0, 0, 0, 0, 0, 0, 0, 0, 0, 0, 0, 0, 4608, 4608, 5210112
.long 0, 2, 4736, 4768, 5215232, 4864, 4896, 5219328, 4992, 5024, 5225472, 0, 0, 0, 0, 0, 0, 0, 0, 0, 0, 0, 0, 0, 0, 0, 0, 0, 0, 4608, 4640, 5211136
.long 0, 2, 4736, 4800, 5216256, 4864, 4928, 5220352, 4992, 5056, 5226496, 0, 0, 0, 0, 0, 0, 0, 0, 0, 0, 0, 0, 0, 0, 0, 0, 0, 0, 4608, 4672, 5212160
.long 0, 2, 4736, 4832, 5217280, 4864, 4960, 5221376, 4992, 5088, 5227520, 0, 0, 0, 0, 0, 0, 0, 0, 0, 0, 0, 0, 0, 0, 0, 0, 0, 0, 4608, 4704, 5213184
.long 0, 2, 5888, 5888, 5926912, 6016, 6016, 5931008, 6144, 6144, 5937152, 0, 0, 0, 0, 0, 0, 0, 0, 0, 0, 0, 0, 0, 0, 0, 0, 0, 0, 5760, 5760, 5922816
.long 0, 2, 5888, 5920, 5927936, 6016, 6048, 5932032, 6144, 6176, 5938176, 0, 0, 0, 0, 0, 0, 0, 0, 0, 0, 0, 0, 0, 0, 0, 0, 0, 0, 5760, 5792, 5923840
.long 0, 2, 5888, 5952, 5928960, 6016, 6080, 5933056, 6144, 6208, 5939200, 0, 0, 0, 0, 0, 0, 0, 0, 0, 0, 0, 0, 0, 0, 0, 0, 0, 0, 5760, 5824, 5924864
.long 0, 2, 5888, 5984, 5929984, 6016, 6112, 5934080, 6144, 6240, 5940224, 0, 0, 0, 0, 0, 0, 0, 0, 0, 0, 0, 0, 0, 0, 0, 0, 0, 0, 5760, 5856, 5925888
.long 0, 2, 7040, 7040, 6639616, 7168, 7168, 6643712, 7296, 7296, 6649856, 0, 0, 0, 0, 0, 0, 0, 0, 0, 0, 0, 0, 0, 0, 0, 0, 0, 0, 6912, 6912, 6635520
.long 0, 2, 7040, 7072, 6640640, 7168, 7200, 6644736, 7296, 7328, 6650880, 0, 0, 0, 0, 0, 0, 0, 0, 0, 0, 0, 0, 0, 0, 0, 0, 0, 0, 6912, 6944, 6636544
.long 0, 2, 7040, 7104, 6641664, 7168, 7232, 6645760, 7296, 7360, 6651904, 0, 0, 0, 0, 0, 0, 0, 0, 0, 0, 0, 0, 0, 0, 0, 0, 0, 0, 6912, 6976, 6637568
.long 0, 2, 7040, 7136, 6642688, 7168, 7264, 6646784, 7296, 7392, 6652928, 0, 0, 0, 0, 0, 0, 0, 0, 0, 0, 0, 0, 0, 0, 0, 0, 0, 0, 6912, 7008, 6638592
.long 0, 2, 8192, 8192, 7352320, 8320, 8320, 7356416, 8448, 8448, 7362560, 0, 0, 0, 0, 0, 0, 0, 0, 0, 0, 0, 0, 0, 0, 0, 0, 0, 0, 8064, 8064, 7348224
.long 0, 2, 8192, 8224, 7353344, 8320, 8352, 7357440, 8448, 8480, 7363584, 0, 0, 0, 0, 0, 0, 0, 0, 0, 0, 0, 0, 0, 0, 0, 0, 0, 0, 8064, 8096, 7349248
.long 0, 2, 8192, 8256, 7354368, 8320, 8384, 7358464, 8448, 8512, 7364608, 0, 0, 0, 0, 0, 0, 0, 0, 0, 0, 0, 0, 0, 0, 0, 0, 0, 0, 8064, 8128, 7350272
.long 0, 2, 8192, 8288, 7355392, 8320, 8416, 7359488, 8448, 8544, 7365632, 0, 0, 0, 0, 0, 0, 0, 0, 0, 0, 0, 0, 0, 0, 0, 0, 0, 0, 8064, 8160, 7351296
.long 0, 2, 640, 640, 2715648, 768, 768, 2719744, 896, 896, 2723840, 0, 0, 0, 0, 0, 0, 0, 0, 0, 0, 0, 0, 0, 0, 0, 0, 0, 0, 512, 512, 2371584
.long 0, 2, 640, 672, 2716672, 768, 800, 2720768, 896, 928, 2724864, 0, 0, 0, 0, 0, 0, 0, 0, 0, 0, 0, 0, 0, 0, 0, 0, 0, 0, 512, 544, 2372608
.long 0, 2, 640, 704, 2717696, 768, 832, 2721792, 896, 960, 2725888, 0, 0, 0, 0, 0, 0, 0, 0, 0, 0, 0, 0, 0, 0, 0, 0, 0, 0, 512, 576, 2727936
.long 0, 2, 640, 736, 2718720, 768, 864, 2722816, 896, 992, 2726912, 0, 0, 0, 0, 0, 0, 0, 0, 0, 0, 0, 0, 0, 0, 0, 0, 0, 0, 512, 608, 2728960
.long 0, 2, 1792, 1792, 3428352, 1920, 1920, 3432448, 2048, 2048, 3436544, 0, 0, 0, 0, 0, 0, 0, 0, 0, 0, 0, 0, 0, 0, 0, 0, 0, 0, 1664, 1664, 3084288
.long 0, 2, 1792, 1824, 3429376, 1920, 1952, 3433472, 2048, 2080, 3437568, 0, 0, 0, 0, 0, 0, 0, 0, 0, 0, 0, 0, 0, 0, 0, 0, 0, 0, 1664, 1696, 3085312
.long 0, 2, 1792, 1856, 3430400, 1920, 1984, 3434496, 2048, 2112, 3438592, 0, 0, 0, 0, 0, 0, 0, 0, 0, 0, 0, 0, 0, 0, 0, 0, 0, 0, 1664, 1728, 3440640
.long 0, 2, 1792, 1888, 3431424, 1920, 2016, 3435520, 2048, 2144, 3439616, 0, 0, 0, 0, 0, 0, 0, 0, 0, 0, 0, 0, 0, 0, 0, 0, 0, 0, 1664, 1760, 3441664
.long 0, 2, 2944, 2944, 4141056, 3072, 3072, 4145152, 3200, 3200, 4149248, 0, 0, 0, 0, 0, 0, 0, 0, 0, 0, 0, 0, 0, 0, 0, 0, 0, 0, 2816, 2816, 3796992
.long 0, 2, 2944, 2976, 4142080, 3072, 3104, 4146176, 3200, 3232, 4150272, 0, 0, 0, 0, 0, 0, 0, 0, 0, 0, 0, 0, 0, 0, 0, 0, 0, 0, 2816, 2848, 3798016
.long 0, 2, 2944, 3008, 4143104, 3072, 3136, 4147200, 3200, 3264, 4151296, 0, 0, 0, 0, 0, 0, 0, 0, 0, 0, 0, 0, 0, 0, 0, 0, 0, 0, 2816, 2880, 4153344
.long 0, 2, 2944, 3040, 4144128, 3072, 3168, 4148224, 3200, 3296, 4152320, 0, 0, 0, 0, 0, 0, 0, 0, 0, 0, 0, 0, 0, 0, 0, 0, 0, 0, 2816, 2912, 4154368
.long 0, 2, 4096, 4096, 4853760, 4224, 4224, 4857856, 4352, 4352, 4861952, 0, 0, 0, 0, 0, 0, 0, 0, 0, 0, 0, 0, 0, 0, 0, 0, 0, 0, 3968, 3968, 4509696
.long 0, 2, 4096, 4128, 4854784, 4224, 4256, 4858880, 4352, 4384, 4862976, 0, 0, 0, 0, 0, 0, 0, 0, 0, 0, 0, 0, 0, 0, 0, 0, 0, 0, 3968, 4000, 4510720
.long 0, 2, 4096, 4160, 4855808, 4224, 4288, 4859904, 4352, 4416, 4864000, 0, 0, 0, 0, 0, 0, 0, 0, 0, 0, 0, 0, 0, 0, 0, 0, 0, 0, 3968, 4032, 4866048
.long 0, 2, 4096, 4192, 4856832, 4224, 4320, 4860928, 4352, 4448, 4865024, 0, 0, 0, 0, 0, 0, 0, 0, 0, 0, 0, 0, 0, 0, 0, 0, 0, 0, 3968, 4064, 4867072
.long 0, 2, 5248, 5248, 5566464, 5376, 5376, 5570560, 5504, 5504, 5574656, 0, 0, 0, 0, 0, 0, 0, 0, 0, 0, 0, 0, 0, 0, 0, 0, 0, 0, 5120, 5120, 5222400
.long 0, 2, 5248, 5280, 5567488, 5376, 5408, 5571584, 5504, 5536, 5575680, 0, 0, 0, 0, 0, 0, 0, 0, 0, 0, 0, 0, 0, 0, 0, 0, 0, 0, 5120, 5152, 5223424
.long 0, 2, 5248, 5312, 5568512, 5376, 5440, 5572608, 5504, 5568, 5576704, 0, 0, 0, 0, 0, 0, 0, 0, 0, 0, 0, 0, 0, 0, 0, 0, 0, 0, 5120, 5184, 5578752
.long 0, 2, 5248, 5344, 5569536, 5376, 5472, 5573632, 5504, 5600, 5577728, 0, 0, 0, 0, 0, 0, 0, 0, 0, 0, 0, 0, 0, 0, 0, 0, 0, 0, 5120, 5216, 5579776
.long 0, 2, 6400, 6400, 6279168, 6528, 6528, 6283264, 6656, 6656, 6287360, 0, 0, 0, 0, 0, 0, 0, 0, 0, 0, 0, 0, 0, 0, 0, 0, 0, 0, 6272, 6272, 5935104
.long 0, 2, 6400, 6432, 6280192, 6528, 6560, 6284288, 6656, 6688, 6288384, 0, 0, 0, 0, 0, 0, 0, 0, 0, 0, 0, 0, 0, 0, 0, 0, 0, 0, 6272, 6304, 5936128
.long 0, 2, 6400, 6464, 6281216, 6528, 6592, 6285312, 6656, 6720, 6289408, 0, 0, 0, 0, 0, 0, 0, 0, 0, 0, 0, 0, 0, 0, 0, 0, 0, 0, 6272, 6336, 6291456
.long 0, 2, 6400, 6496, 6282240, 6528, 6624, 6286336, 6656, 6752, 6290432, 0, 0, 0, 0, 0, 0, 0, 0, 0, 0, 0, 0, 0, 0, 0, 0, 0, 0, 6272, 6368, 6292480
.long 0, 2, 7552, 7552, 6991872, 7680, 7680, 6995968, 7808, 7808, 7000064, 0, 0, 0, 0, 0, 0, 0, 0, 0, 0, 0, 0, 0, 0, 0, 0, 0, 0, 7424, 7424, 6647808
.long 0, 2, 7552, 7584, 6992896, 7680, 7712, 6996992, 7808, 7840, 7001088, 0, 0, 0, 0, 0, 0, 0, 0, 0, 0, 0, 0, 0, 0, 0, 0, 0, 0, 7424, 7456, 6648832
.long 0, 2, 7552, 7616, 6993920, 7680, 7744, 6998016, 7808, 7872, 7002112, 0, 0, 0, 0, 0, 0, 0, 0, 0, 0, 0, 0, 0, 0, 0, 0, 0, 0, 7424, 7488, 7004160
.long 0, 2, 7552, 7648, 6994944, 7680, 7776, 6999040, 7808, 7904, 7003136, 0, 0, 0, 0, 0, 0, 0, 0, 0, 0, 0, 0, 0, 0, 0, 0, 0, 0, 7424, 7520, 7005184
.long 0, 2, 8704, 8704, 7704576, 8832, 8832, 7708672, 8960, 8960, 7712768, 0, 0, 0, 0, 0, 0, 0, 0, 0, 0, 0, 0, 0, 0, 0, 0, 0, 0, 8576, 8576, 7360512
.long 0, 2, 8704, 8736, 7705600, 8832, 8864, 7709696, 8960, 8992, 7713792, 0, 0, 0, 0, 0, 0, 0, 0, 0, 0, 0, 0, 0, 0, 0, 0, 0, 0, 8576, 8608, 7361536
.long 0, 2, 8704, 8768, 7706624, 8832, 8896, 7710720, 8960, 9024, 7714816, 0, 0, 0, 0, 0, 0, 0, 0, 0, 0, 0, 0, 0, 0, 0, 0, 0, 0, 8576, 8640, 7716864
.long 0, 2, 8704, 8800, 7707648, 8832, 8928, 7711744, 8960, 9056, 7715840, 0, 0, 0, 0, 0, 0, 0, 0, 0, 0, 0, 0, 0, 0, 0, 0, 0, 0, 8576, 8672, 7717888
.long 0, 2, 1769472, 65536, 2359296, 1769600, 65664, 2363392, 1769728, 65792, 2367488, 0, 0, 0, 0, 0, 0, 0, 0, 0, 0, 0, 0, 0, 0, 0, 0, 0, 0, 1024, 1024, 2729984
.long 0, 2, 1769472, 65568, 2360320, 1769600, 65696, 2364416, 1769728, 65824, 2368512, 0, 0, 0, 0, 0, 0, 0, 0, 0, 0, 0, 0, 0, 0, 0, 0, 0, 0, 1024, 1056, 2731008
.long 0, 2, 1769472, 65600, 2361344, 1769600, 65728, 2365440, 1769728, 65856, 2369536, 0, 0, 0, 0, 0, 0, 0, 0, 0, 0, 0, 0, 0, 0, 0, 0, 0, 0, 1024, 1088, 2732032
.long 0, 2, 1769472, 65632, 2362368, 1769600, 65760, 2366464, 1769728, 65888, 2370560, 0, 0, 0, 0, 0, 0, 0, 0, 0, 0, 0, 0, 0, 0, 0, 0, 0, 0, 1024, 1120, 2733056
.long 0, 2, 1770624, 66688, 3072000, 1770752, 66816, 3076096, 1770880, 66944, 3080192, 0, 0, 0, 0, 0, 0, 0, 0, 0, 0, 0, 0, 0, 0, 0, 0, 0, 0, 2176, 2176, 3442688
.long 0, 2, 1770624, 66720, 3073024, 1770752, 66848, 3077120, 1770880, 66976, 3081216, 0, 0, 0, 0, 0, 0, 0, 0, 0, 0, 0, 0, 0, 0, 0, 0, 0, 0, 2176, 2208, 3443712
.long 0, 2, 1770624, 66752, 3074048, 1770752, 66880, 3078144, 1770880, 67008, 3082240, 0, 0, 0, 0, 0, 0, 0, 0, 0, 0, 0, 0, 0, 0, 0, 0, 0, 0, 2176, 2240, 3444736
.long 0, 2, 1770624, 66784, 3075072, 1770752, 66912, 3079168, 1770880, 67040, 3083264, 0, 0, 0, 0, 0, 0, 0, 0, 0, 0, 0, 0, 0, 0, 0, 0, 0, 0, 2176, 2272, 3445760
.long 0, 2, 1771776, 67840, 3784704, 1771904, 67968, 3788800, 1772032, 68096, 3792896, 0, 0, 0, 0, 0, 0, 0, 0, 0, 0, 0, 0, 0, 0, 0, 0, 0, 0, 3328, 3328, 4155392
.long 0, 2, 1771776, 67872, 3785728, 1771904, 68000, 3789824, 1772032, 68128, 3793920, 0, 0, 0, 0, 0, 0, 0, 0, 0, 0, 0, 0, 0, 0, 0, 0, 0, 0, 3328, 3360, 4156416
.long 0, 2, 1771776, 67904, 3786752, 1771904, 68032, 3790848, 1772032, 68160, 3794944, 0, 0, 0, 0, 0, 0, 0, 0, 0, 0, 0, 0, 0, 0, 0, 0, 0, 0, 3328, 3392, 4157440
.long 0, 2, 1771776, 67936, 3787776, 1771904, 68064, 3791872, 1772032, 68192, 3795968, 0, 0, 0, 0, 0, 0, 0, 0, 0, 0, 0, 0, 0, 0, 0, 0, 0, 0, 3328, 3424, 4158464
.long 0, 2, 1772928, 68992, 4497408, 1773056, 69120, 4501504, 1773184, 69248, 4505600, 0, 0, 0, 0, 0, 0, 0, 0, 0, 0, 0, 0, 0, 0, 0, 0, 0, 0, 4480, 4480, 4868096
.long 0, 2, 1772928, 69024, 4498432, 1773056, 69152, 4502528, 1773184, 69280, 4506624, 0, 0, 0, 0, 0, 0, 0, 0, 0, 0, 0, 0, 0, 0, 0, 0, 0, 0, 4480, 4512, 4869120
.long 0, 2, 1772928, 69056, 4499456, 1773056, 69184, 4503552, 1773184, 69312, 4507648, 0, 0, 0, 0, 0, 0, 0, 0, 0, 0, 0, 0, 0, 0, 0, 0, 0, 0, 4480, 4544, 4870144
.long 0, 2, 1772928, 69088, 4500480, 1773056, 69216, 4504576, 1773184, 69344, 4508672, 0, 0, 0, 0, 0, 0, 0, 0, 0, 0, 0, 0, 0, 0, 0, 0, 0, 0, 4480, 4576, 4871168
.long 0, 2, 1774080, 70144, 5210112, 1774208, 70272, 5214208, 1774336, 70400, 5218304, 0, 0, 0, 0, 0, 0, 0, 0, 0, 0, 0, 0, 0, 0, 0, 0, 0, 0, 5632, 5632, 5580800
.long 0, 2, 1774080, 70176, 5211136, 1774208, 70304, 5215232, 1774336, 70432, 5219328, 0, 0, 0, 0, 0, 0, 0, 0, 0, 0, 0, 0, 0, 0, 0, 0, 0, 0, 5632, 5664, 5581824
.long 0, 2, 1774080, 70208, 5212160, 1774208, 70336, 5216256, 1774336, 70464, 5220352, 0, 0, 0, 0, 0, 0, 0, 0, 0, 0, 0, 0, 0, 0, 0, 0, 0, 0, 5632, 5696, 5582848
.long 0, 2, 1774080, 70240, 5213184, 1774208, 70368, 5217280, 1774336, 70496, 5221376, 0, 0, 0, 0, 0, 0, 0, 0, 0, 0, 0, 0, 0, 0, 0, 0, 0, 0, 5632, 5728, 5583872
.long 0, 2, 1775232, 71296, 5922816, 1775360, 71424, 5926912, 1775488, 71552, 5931008, 0, 0, 0, 0, 0, 0, 0, 0, 0, 0, 0, 0, 0, 0, 0, 0, 0, 0, 6784, 6784, 6293504
.long 0, 2, 1775232, 71328, 5923840, 1775360, 71456, 5927936, 1775488, 71584, 5932032, 0, 0, 0, 0, 0, 0, 0, 0, 0, 0, 0, 0, 0, 0, 0, 0, 0, 0, 6784, 6816, 6294528
.long 0, 2, 1775232, 71360, 5924864, 1775360, 71488, 5928960, 1775488, 71616, 5933056, 0, 0, 0, 0, 0, 0, 0, 0, 0, 0, 0, 0, 0, 0, 0, 0, 0, 0, 6784, 6848, 6295552
.long 0, 2, 1775232, 71392, 5925888, 1775360, 71520, 5929984, 1775488, 71648, 5934080, 0, 0, 0, 0, 0, 0, 0, 0, 0, 0, 0, 0, 0, 0, 0, 0, 0, 0, 6784, 6880, 6296576
.long 0, 2, 1776384, 72448, 6635520, 1776512, 72576, 6639616, 1776640, 72704, 6643712, 0, 0, 0, 0, 0, 0, 0, 0, 0, 0, 0, 0, 0, 0, 0, 0, 0, 0, 7936, 7936, 7006208
.long 0, 2, 1776384, 72480, 6636544, 1776512, 72608, 6640640, 1776640, 72736, 6644736, 0, 0, 0, 0, 0, 0, 0, 0, 0, 0, 0, 0, 0, 0, 0, 0, 0, 0, 7936, 7968, 7007232
.long 0, 2, 1776384, 72512, 6637568, 1776512, 72640, 6641664, 1776640, 72768, 6645760, 0, 0, 0, 0, 0, 0, 0, 0, 0, 0, 0, 0, 0, 0, 0, 0, 0, 0, 7936, 8000, 7008256
.long 0, 2, 1776384, 72544, 6638592, 1776512, 72672, 6642688, 1776640, 72800, 6646784, 0, 0, 0, 0, 0, 0, 0, 0, 0, 0, 0, 0, 0, 0, 0, 0, 0, 0, 7936, 8032, 7009280
.long 0, 2, 1777536, 73600, 7348224, 1777664, 73728, 7352320, 1777792, 73856, 7356416, 0, 0, 0, 0, 0, 0, 0, 0, 0, 0, 0, 0, 0, 0, 0, 0, 0, 0, 9088, 9088, 7718912
.long 0, 2, 1777536, 73632, 7349248, 1777664, 73760, 7353344, 1777792, 73888, 7357440, 0, 0, 0, 0, 0, 0, 0, 0, 0, 0, 0, 0, 0, 0, 0, 0, 0, 0, 9088, 9120, 7719936
.long 0, 2, 1777536, 73664, 7350272, 1777664, 73792, 7354368, 1777792, 73920, 7358464, 0, 0, 0, 0, 0, 0, 0, 0, 0, 0, 0, 0, 0, 0, 0, 0, 0, 0, 9088, 9152, 7720960
.long 0, 2, 1777536, 73696, 7351296, 1777664, 73824, 7355392, 1777792, 73952, 7359488, 0, 0, 0, 0, 0, 0, 0, 0, 0, 0, 0, 0, 0, 0, 0, 0, 0, 0, 9088, 9184, 7721984
.long 0, 0, 1769984, 66048, 2371584, 1770112, 66176, 2715648, 0, 0, 0, 0, 0, 0, 0, 0, 0, 0, 0, 0, 0, 0, 0, 0, 0, 0, 0, 0, 0, 1769856, 65920, 2373632
.long 0, 0, 1769984, 66080, 2372608, 1770112, 66208, 2716672, 0, 0, 0, 0, 0, 0, 0, 0, 0, 0, 0, 0, 0, 0, 0, 0, 0, 0, 0, 0, 0, 1769856, 65952, 2374656
.long 0, 0, 1769984, 66112, 2727936, 1770112, 66240, 2717696, 0, 0, 0, 0, 0, 0, 0, 0, 0, 0, 0, 0, 0, 0, 0, 0, 0, 0, 0, 0, 0, 1769856, 65984, 2375680
.long 0, 0, 1769984, 66144, 2728960, 1770112, 66272, 2718720, 0, 0, 0, 0, 0, 0, 0, 0, 0, 0, 0, 0, 0, 0, 0, 0, 0, 0, 0, 0, 0, 1769856, 66016, 2376704
.long 0, 0, 1771136, 67200, 3084288, 1771264, 67328, 3428352, 0, 0, 0, 0, 0, 0, 0, 0, 0, 0, 0, 0, 0, 0, 0, 0, 0, 0, 0, 0, 0, 1771008, 67072, 3086336
.long 0, 0, 1771136, 67232, 3085312, 1771264, 67360, 3429376, 0, 0, 0, 0, 0, 0, 0, 0, 0, 0, 0, 0, 0, 0, 0, 0, 0, 0, 0, 0, 0, 1771008, 67104, 3087360
.long 0, 0, 1771136, 67264, 3440640, 1771264, 67392, 3430400, 0, 0, 0, 0, 0, 0, 0, 0, 0, 0, 0, 0, 0, 0, 0, 0, 0, 0, 0, 0, 0, 1771008, 67136, 3088384
.long 0, 0, 1771136, 67296, 3441664, 1771264, 67424, 3431424, 0, 0, 0, 0, 0, 0, 0, 0, 0, 0, 0, 0, 0, 0, 0, 0, 0, 0, 0, 0, 0, 1771008, 67168, 3089408
.long 0, 0, 1772288, 68352, 3796992, 1772416, 68480, 4141056, 0, 0, 0, 0, 0, 0, 0, 0, 0, 0, 0, 0, 0, 0, 0, 0, 0, 0, 0, 0, 0, 1772160, 68224, 3799040
.long 0, 0, 1772288, 68384, 3798016, 1772416, 68512, 4142080, 0, 0, 0, 0, 0, 0, 0, 0, 0, 0, 0, 0, 0, 0, 0, 0, 0, 0, 0, 0, 0, 1772160, 68256, 3800064
.long 0, 0, 1772288, 68416, 4153344, 1772416, 68544, 4143104, 0, 0, 0, 0, 0, 0, 0, 0, 0, 0, 0, 0, 0, 0, 0, 0, 0, 0, 0, 0, 0, 1772160, 68288, 3801088
.long 0, 0, 1772288, 68448, 4154368, 1772416, 68576, 4144128, 0, 0, 0, 0, 0, 0, 0, 0, 0, 0, 0, 0, 0, 0, 0, 0, 0, 0, 0, 0, 0, 1772160, 68320, 3802112
.long 0, 0, 1773440, 69504, 4509696, 1773568, 69632, 4853760, 0, 0, 0, 0, 0, 0, 0, 0, 0, 0, 0, 0, 0, 0, 0, 0, 0, 0, 0, 0, 0, 1773312, 69376, 4511744
.long 0, 0, 1773440, 69536, 4510720, 1773568, 69664, 4854784, 0, 0, 0, 0, 0, 0, 0, 0, 0, 0, 0, 0, 0, 0, 0, 0, 0, 0, 0, 0, 0, 1773312, 69408, 4512768
.long 0, 0, 1773440, 69568, 4866048, 1773568, 69696, 4855808, 0, 0, 0, 0, 0, 0, 0, 0, 0, 0, 0, 0, 0, 0, 0, 0, 0, 0, 0, 0, 0, 1773312, 69440, 4513792
.long 0, 0, 1773440, 69600, 4867072, 1773568, 69728, 4856832, 0, 0, 0, 0, 0, 0, 0, 0, 0, 0, 0, 0, 0, 0, 0, 0, 0, 0, 0, 0, 0, 1773312, 69472, 4514816
.long 0, 0, 1774592, 70656, 5222400, 1774720, 70784, 5566464, 0, 0, 0, 0, 0, 0, 0, 0, 0, 0, 0, 0, 0, 0, 0, 0, 0, 0, 0, 0, 0, 1774464, 70528, 5224448
.long 0, 0, 1774592, 70688, 5223424, 1774720, 70816, 5567488, 0, 0, 0, 0, 0, 0, 0, 0, 0, 0, 0, 0, 0, 0, 0, 0, 0, 0, 0, 0, 0, 1774464, 70560, 5225472
.long 0, 0, 1774592, 70720, 5578752, 1774720, 70848, 5568512, 0, 0, 0, 0, 0, 0, 0, 0, 0, 0, 0, 0, 0, 0, 0, 0, 0, 0, 0, 0, 0, 1774464, 70592, 5226496
.long 0, 0, 1774592, 70752, 5579776, 1774720, 70880, 5569536, 0, 0, 0, 0, 0, 0, 0, 0, 0, 0, 0, 0, 0, 0, 0, 0, 0, 0, 0, 0, 0, 1774464, 70624, 5227520
.long 0, 0, 1775744, 71808, 5935104, 1775872, 71936, 6279168, 0, 0, 0, 0, 0, 0, 0, 0, 0, 0, 0, 0, 0, 0, 0, 0, 0, 0, 0, 0, 0, 1775616, 71680, 5937152
.long 0, 0, 1775744, 71840, 5936128, 1775872, 71968, 6280192, 0, 0, 0, 0, 0, 0, 0, 0, 0, 0, 0, 0, 0, 0, 0, 0, 0, 0, 0, 0, 0, 1775616, 71712, 5938176
.long 0, 0, 1775744, 71872, 6291456, 1775872, 72000, 6281216, 0, 0, 0, 0, 0, 0, 0, 0, 0, 0, 0, 0, 0, 0, 0, 0, 0, 0, 0, 0, 0, 1775616, 71744, 5939200
.long 0, 0, 1775744, 71904, 6292480, 1775872, 72032, 6282240, 0, 0, 0, 0, 0, 0, 0, 0, 0, 0, 0, 0, 0, 0, 0, 0, 0, 0, 0, 0, 0, 1775616, 71776, 5940224
.long 0, 0, 1776896, 72960, 6647808, 1777024, 73088, 6991872, 0, 0, 0, 0, 0, 0, 0, 0, 0, 0, 0, 0, 0, 0, 0, 0, 0, 0, 0, 0, 0, 1776768, 72832, 6649856
.long 0, 0, 1776896, 72992, 6648832, 1777024, 73120, 6992896, 0, 0, 0, 0, 0, 0, 0, 0, 0, 0, 0, 0, 0, 0, 0, 0, 0, 0, 0, 0, 0, 1776768, 72864, 6650880
.long 0, 0, 1776896, 73024, 7004160, 1777024, 73152, 6993920, 0, 0, 0, 0, 0, 0, 0, 0, 0, 0, 0, 0, 0, 0, 0, 0, 0, 0, 0, 0, 0, 1776768, 72896, 6651904
.long 0, 0, 1776896, 73056, 7005184, 1777024, 73184, 6994944, 0, 0, 0, 0, 0, 0, 0, 0, 0, 0, 0, 0, 0, 0, 0, 0, 0, 0, 0, 0, 0, 1776768, 72928, 6652928
.long 0, 0, 1778048, 74112, 7360512, 1778176, 74240, 7704576, 0, 0, 0, 0, 0, 0, 0, 0, 0, 0, 0, 0, 0, 0, 0, 0, 0, 0, 0, 0, 0, 1777920, 73984, 7362560
.long 0, 0, 1778048, 74144, 7361536, 1778176, 74272, 7705600, 0, 0, 0, 0, 0, 0, 0, 0, 0, 0, 0, 0, 0, 0, 0, 0, 0, 0, 0, 0, 0, 1777920, 74016, 7363584
.long 0, 0, 1778048, 74176, 7716864, 1778176, 74304, 7706624, 0, 0, 0, 0, 0, 0, 0, 0, 0, 0, 0, 0, 0, 0, 0, 0, 0, 0, 0, 0, 0, 1777920, 74048, 7364608
.long 0, 0, 1778048, 74208, 7717888, 1778176, 74336, 7707648, 0, 0, 0, 0, 0, 0, 0, 0, 0, 0, 0, 0, 0, 0, 0, 0, 0, 0, 0, 0, 0, 1777920, 74080, 7365632
.long 0, 4, 1770368, 66432, 2723840, 1770496, 66560, 2729984, 0, 0, 0, 0, 0, 0, 0, 0, 0, 0, 0, 0, 0, 0, 0, 0, 0, 0, 0, 0, 0, 1770240, 66304, 2719744
.long 0, 4, 1770368, 66464, 2724864, 1770496, 66592, 2731008, 0, 0, 0, 0, 0, 0, 0, 0, 0, 0, 0, 0, 0, 0, 0, 0, 0, 0, 0, 0, 0, 1770240, 66336, 2720768
.long 0, 4, 1770368, 66496, 2725888, 1770496, 66624, 2732032, 0, 0, 0, 0, 0, 0, 0, 0, 0, 0, 0, 0, 0, 0, 0, 0, 0, 0, 0, 0, 0, 1770240, 66368, 2721792
.long 0, 4, 1770368, 66528, 2726912, 1770496, 66656, 2733056, 0, 0, 0, 0, 0, 0, 0, 0, 0, 0, 0, 0, 0, 0, 0, 0, 0, 0, 0, 0, 0, 1770240, 66400, 2722816
.long 0, 4, 1771520, 67584, 3436544, 1771648, 67712, 3442688, 0, 0, 0, 0, 0, 0, 0, 0, 0, 0, 0, 0, 0, 0, 0, 0, 0, 0, 0, 0, 0, 1771392, 67456, 3432448
.long 0, 4, 1771520, 67616, 3437568, 1771648, 67744, 3443712, 0, 0, 0, 0, 0, 0, 0, 0, 0, 0, 0, 0, 0, 0, 0, 0, 0, 0, 0, 0, 0, 1771392, 67488, 3433472
.long 0, 4, 1771520, 67648, 3438592, 1771648, 67776, 3444736, 0, 0, 0, 0, 0, 0, 0, 0, 0, 0, 0, 0, 0, 0, 0, 0, 0, 0, 0, 0, 0, 1771392, 67520, 3434496
.long 0, 4, 1771520, 67680, 3439616, 1771648, 67808, 3445760, 0, 0, 0, 0, 0, 0, 0, 0, 0, 0, 0, 0, 0, 0, 0, 0, 0, 0, 0, 0, 0, 1771392, 67552, 3435520
.long 0, 4, 1772672, 68736, 4149248, 1772800, 68864, 4155392, 0, 0, 0, 0, 0, 0, 0, 0, 0, 0, 0, 0, 0, 0, 0, 0, 0, 0, 0, 0, 0, 1772544, 68608, 4145152
.long 0, 4, 1772672, 68768, 4150272, 1772800, 68896, 4156416, 0, 0, 0, 0, 0, 0, 0, 0, 0, 0, 0, 0, 0, 0, 0, 0, 0, 0, 0, 0, 0, 1772544, 68640, 4146176
.long 0, 4, 1772672, 68800, 4151296, 1772800, 68928, 4157440, 0, 0, 0, 0, 0, 0, 0, 0, 0, 0, 0, 0, 0, 0, 0, 0, 0, 0, 0, 0, 0, 1772544, 68672, 4147200
.long 0, 4, 1772672, 68832, 4152320, 1772800, 68960, 4158464, 0, 0, 0, 0, 0, 0, 0, 0, 0, 0, 0, 0, 0, 0, 0, 0, 0, 0, 0, 0, 0, 1772544, 68704, 4148224
.long 0, 4, 1773824, 69888, 4861952, 1773952, 70016, 4868096, 0, 0, 0, 0, 0, 0, 0, 0, 0, 0, 0, 0, 0, 0, 0, 0, 0, 0, 0, 0, 0, 1773696, 69760, 4857856
.long 0, 4, 1773824, 69920, 4862976, 1773952, 70048, 4869120, 0, 0, 0, 0, 0, 0, 0, 0, 0, 0, 0, 0, 0, 0, 0, 0, 0, 0, 0, 0, 0, 1773696, 69792, 4858880
.long 0, 4, 1773824, 69952, 4864000, 1773952, 70080, 4870144, 0, 0, 0, 0, 0, 0, 0, 0, 0, 0, 0, 0, 0, 0, 0, 0, 0, 0, 0, 0, 0, 1773696, 69824, 4859904
.long 0, 4, 1773824, 69984, 4865024, 1773952, 70112, 4871168, 0, 0, 0, 0, 0, 0, 0, 0, 0, 0, 0, 0, 0, 0, 0, 0, 0, 0, 0, 0, 0, 1773696, 69856, 4860928
.long 0, 4, 1774976, 71040, 5574656, 1775104, 71168, 5580800, 0, 0, 0, 0, 0, 0, 0, 0, 0, 0, 0, 0, 0, 0, 0, 0, 0, 0, 0, 0, 0, 1774848, 70912, 5570560
.long 0, 4, 1774976, 71072, 5575680, 1775104, 71200, 5581824, 0, 0, 0, 0, 0, 0, 0, 0, 0, 0, 0, 0, 0, 0, 0, 0, 0, 0, 0, 0, 0, 1774848, 70944, 5571584
.long 0, 4, 1774976, 71104, 5576704, 1775104, 71232, 5582848, 0, 0, 0, 0, 0, 0, 0, 0, 0, 0, 0, 0, 0, 0, 0, 0, 0, 0, 0, 0, 0, 1774848, 70976, 5572608
.long 0, 4, 1774976, 71136, 5577728, 1775104, 71264, 5583872, 0, 0, 0, 0, 0, 0, 0, 0, 0, 0, 0, 0, 0, 0, 0, 0, 0, 0, 0, 0, 0, 1774848, 71008, 5573632
.long 0, 4, 1776128, 72192, 6287360, 1776256, 72320, 6293504, 0, 0, 0, 0, 0, 0, 0, 0, 0, 0, 0, 0, 0, 0, 0, 0, 0, 0, 0, 0, 0, 1776000, 72064, 6283264
.long 0, 4, 1776128, 72224, 6288384, 1776256, 72352, 6294528, 0, 0, 0, 0, 0, 0, 0, 0, 0, 0, 0, 0, 0, 0, 0, 0, 0, 0, 0, 0, 0, 1776000, 72096, 6284288
.long 0, 4, 1776128, 72256, 6289408, 1776256, 72384, 6295552, 0, 0, 0, 0, 0, 0, 0, 0, 0, 0, 0, 0, 0, 0, 0, 0, 0, 0, 0, 0, 0, 1776000, 72128, 6285312
.long 0, 4, 1776128, 72288, 6290432, 1776256, 72416, 6296576, 0, 0, 0, 0, 0, 0, 0, 0, 0, 0, 0, 0, 0, 0, 0, 0, 0, 0, 0, 0, 0, 1776000, 72160, 6286336
.long 0, 4, 1777280, 73344, 7000064, 1777408, 73472, 7006208, 0, 0, 0, 0, 0, 0, 0, 0, 0, 0, 0, 0, 0, 0, 0, 0, 0, 0, 0, 0, 0, 1777152, 73216, 6995968
.long 0, 4, 1777280, 73376, 7001088, 1777408, 73504, 7007232, 0, 0, 0, 0, 0, 0, 0, 0, 0, 0, 0, 0, 0, 0, 0, 0, 0, 0, 0, 0, 0, 1777152, 73248, 6996992
.long 0, 4, 1777280, 73408, 7002112, 1777408, 73536, 7008256, 0, 0, 0, 0, 0, 0, 0, 0, 0, 0, 0, 0, 0, 0, 0, 0, 0, 0, 0, 0, 0, 1777152, 73280, 6998016
.long 0, 4, 1777280, 73440, 7003136, 1777408, 73568, 7009280, 0, 0, 0, 0, 0, 0, 0, 0, 0, 0, 0, 0, 0, 0, 0, 0, 0, 0, 0, 0, 0, 1777152, 73312, 6999040
.long 0, 4, 1778432, 74496, 7712768, 1778560, 74624, 7718912, 0, 0, 0, 0, 0, 0, 0, 0, 0, 0, 0, 0, 0, 0, 0, 0, 0, 0, 0, 0, 0, 1778304, 74368, 7708672
.long 0, 4, 1778432, 74528, 7713792, 1778560, 74656, 7719936, 0, 0, 0, 0, 0, 0, 0, 0, 0, 0, 0, 0, 0, 0, 0, 0, 0, 0, 0, 0, 0, 1778304, 74400, 7709696
.long 0, 4, 1778432, 74560, 7714816, 1778560, 74688, 7720960, 0, 0, 0, 0, 0, 0, 0, 0, 0, 0, 0, 0, 0, 0, 0, 0, 0, 0, 0, 0, 0, 1778304, 74432, 7710720
.long 0, 4, 1778432, 74592, 7715840, 1778560, 74720, 7721984, 0, 0, 0, 0, 0, 0, 0, 0, 0, 0, 0, 0, 0, 0, 0, 0, 0, 0, 0, 0, 0, 1778304, 74464, 7711744
.long 0, 4, 3539072, 131200, 2363392, 3539200, 131328, 2367488, 0, 0, 0, 0, 0, 0, 0, 0, 0, 0, 0, 0, 0, 0, 0, 0, 0, 0, 0, 0, 0, 3538944, 131072, 2359296
.long 0, 4, 3539072, 131232, 2364416, 3539200, 131360, 2368512, 0, 0, 0, 0, 0, 0, 0, 0, 0, 0, 0, 0, 0, 0, 0, 0, 0, 0, 0, 0, 0, 3538944, 131104, 2360320
.long 0, 4, 3539072, 131264, 2365440, 3539200, 131392, 2369536, 0, 0, 0, 0, 0, 0, 0, 0, 0, 0, 0, 0, 0, 0, 0, 0, 0, 0, 0, 0, 0, 3538944, 131136, 2361344
.long 0, 4, 3539072, 131296, 2366464, 3539200, 131424, 2370560, 0, 0, 0, 0, 0, 0, 0, 0, 0, 0, 0, 0, 0, 0, 0, 0, 0, 0, 0, 0, 0, 3538944, 131168, 2362368
.long 0, 4, 3540224, 132352, 3076096, 3540352, 132480, 3080192, 0, 0, 0, 0, 0, 0, 0, 0, 0, 0, 0, 0, 0, 0, 0, 0, 0, 0, 0, 0, 0, 3540096, 132224, 3072000
.long 0, 4, 3540224, 132384, 3077120, 3540352, 132512, 3081216, 0, 0, 0, 0, 0, 0, 0, 0, 0, 0, 0, 0, 0, 0, 0, 0, 0, 0, 0, 0, 0, 3540096, 132256, 3073024
.long 0, 4, 3540224, 132416, 3078144, 3540352, 132544, 3082240, 0, 0, 0, 0, 0, 0, 0, 0, 0, 0, 0, 0, 0, 0, 0, 0, 0, 0, 0, 0, 0, 3540096, 132288, 3074048
.long 0, 4, 3540224, 132448, 3079168, 3540352, 132576, 3083264, 0, 0, 0, 0, 0, 0, 0, 0, 0, 0, 0, 0, 0, 0, 0, 0, 0, 0, 0, 0, 0, 3540096, 132320, 3075072
.long 0, 4, 3541376, 133504, 3788800, 3541504, 133632, 3792896, 0, 0, 0, 0, 0, 0, 0, 0, 0, 0, 0, 0, 0, 0, 0, 0, 0, 0, 0, 0, 0, 3541248, 133376, 3784704
.long 0, 4, 3541376, 133536, 3789824, 3541504, 133664, 3793920, 0, 0, 0, 0, 0, 0, 0, 0, 0, 0, 0, 0, 0, 0, 0, 0, 0, 0, 0, 0, 0, 3541248, 133408, 3785728
.long 0, 4, 3541376, 133568, 3790848, 3541504, 133696, 3794944, 0, 0, 0, 0, 0, 0, 0, 0, 0, 0, 0, 0, 0, 0, 0, 0, 0, 0, 0, 0, 0, 3541248, 133440, 3786752
.long 0, 4, 3541376, 133600, 3791872, 3541504, 133728, 3795968, 0, 0, 0, 0, 0, 0, 0, 0, 0, 0, 0, 0, 0, 0, 0, 0, 0, 0, 0, 0, 0, 3541248, 133472, 3787776
.long 0, 4, 3542528, 134656, 4501504, 3542656, 134784, 4505600, 0, 0, 0, 0, 0, 0, 0, 0, 0, 0, 0, 0, 0, 0, 0, 0, 0, 0, 0, 0, 0, 3542400, 134528, 4497408
.long 0, 4, 3542528, 134688, 4502528, 3542656, 134816, 4506624, 0, 0, 0, 0, 0, 0, 0, 0, 0, 0, 0, 0, 0, 0, 0, 0, 0, 0, 0, 0, 0, 3542400, 134560, 4498432
.long 0, 4, 3542528, 134720, 4503552, 3542656, 134848, 4507648, 0, 0, 0, 0, 0, 0, 0, 0, 0, 0, 0, 0, 0, 0, 0, 0, 0, 0, 0, 0, 0, 3542400, 134592, 4499456
.long 0, 4, 3542528, 134752, 4504576, 3542656, 134880, 4508672, 0, 0, 0, 0, 0, 0, 0, 0, 0, 0, 0, 0, 0, 0, 0, 0, 0, 0, 0, 0, 0, 3542400, 134624, 4500480
.long 0, 4, 3543680, 135808, 5214208, 3543808, 135936, 5218304, 0, 0, 0, 0, 0, 0, 0, 0, 0, 0, 0, 0, 0, 0, 0, 0, 0, 0, 0, 0, 0, 3543552, 135680, 5210112
.long 0, 4, 3543680, 135840, 5215232, 3543808, 135968, 5219328, 0, 0, 0, 0, 0, 0, 0, 0, 0, 0, 0, 0, 0, 0, 0, 0, 0, 0, 0, 0, 0, 3543552, 135712, 5211136
.long 0, 4, 3543680, 135872, 5216256, 3543808, 136000, 5220352, 0, 0, 0, 0, 0, 0, 0, 0, 0, 0, 0, 0, 0, 0, 0, 0, 0, 0, 0, 0, 0, 3543552, 135744, 5212160
.long 0, 4, 3543680, 135904, 5217280, 3543808, 136032, 5221376, 0, 0, 0, 0, 0, 0, 0, 0, 0, 0, 0, 0, 0, 0, 0, 0, 0, 0, 0, 0, 0, 3543552, 135776, 5213184
.long 0, 4, 3544832, 136960, 5926912, 3544960, 137088, 5931008, 0, 0, 0, 0, 0, 0, 0, 0, 0, 0, 0, 0, 0, 0, 0, 0, 0, 0, 0, 0, 0, 3544704, 136832, 5922816
.long 0, 4, 3544832, 136992, 5927936, 3544960, 137120, 5932032, 0, 0, 0, 0, 0, 0, 0, 0, 0, 0, 0, 0, 0, 0, 0, 0, 0, 0, 0, 0, 0, 3544704, 136864, 5923840
.long 0, 4, 3544832, 137024, 5928960, 3544960, 137152, 5933056, 0, 0, 0, 0, 0, 0, 0, 0, 0, 0, 0, 0, 0, 0, 0, 0, 0, 0, 0, 0, 0, 3544704, 136896, 5924864
.long 0, 4, 3544832, 137056, 5929984, 3544960, 137184, 5934080, 0, 0, 0, 0, 0, 0, 0, 0, 0, 0, 0, 0, 0, 0, 0, 0, 0, 0, 0, 0, 0, 3544704, 136928, 5925888
.long 0, 4, 3545984, 138112, 6639616, 3546112, 138240, 6643712, 0, 0, 0, 0, 0, 0, 0, 0, 0, 0, 0, 0, 0, 0, 0, 0, 0, 0, 0, 0, 0, 3545856, 137984, 6635520
.long 0, 4, 3545984, 138144, 6640640, 3546112, 138272, 6644736, 0, 0, 0, 0, 0, 0, 0, 0, 0, 0, 0, 0, 0, 0, 0, 0, 0, 0, 0, 0, 0, 3545856, 138016, 6636544
.long 0, 4, 3545984, 138176, 6641664, 3546112, 138304, 6645760, 0, 0, 0, 0, 0, 0, 0, 0, 0, 0, 0, 0, 0, 0, 0, 0, 0, 0, 0, 0, 0, 3545856, 138048, 6637568
.long 0, 4, 3545984, 138208, 6642688, 3546112, 138336, 6646784, 0, 0, 0, 0, 0, 0, 0, 0, 0, 0, 0, 0, 0, 0, 0, 0, 0, 0, 0, 0, 0, 3545856, 138080, 6638592
.long 0, 4, 3547136, 139264, 7352320, 3547264, 139392, 7356416, 0, 0, 0, 0, 0, 0, 0, 0, 0, 0, 0, 0, 0, 0, 0, 0, 0, 0, 0, 0, 0, 3547008, 139136, 7348224
.long 0, 4, 3547136, 139296, 7353344, 3547264, 139424, 7357440, 0, 0, 0, 0, 0, 0, 0, 0, 0, 0, 0, 0, 0, 0, 0, 0, 0, 0, 0, 0, 0, 3547008, 139168, 7349248
.long 0, 4, 3547136, 139328, 7354368, 3547264, 139456, 7358464, 0, 0, 0, 0, 0, 0, 0, 0, 0, 0, 0, 0, 0, 0, 0, 0, 0, 0, 0, 0, 0, 3547008, 139200, 7350272
.long 0, 4, 3547136, 139360, 7355392, 3547264, 139488, 7359488, 0, 0, 0, 0, 0, 0, 0, 0, 0, 0, 0, 0, 0, 0, 0, 0, 0, 0, 0, 0, 0, 3547008, 139232, 7351296
.long 0, 0, 3539456, 131584, 2371584, 3539584, 131712, 2715648, 0, 0, 0, 0, 0, 0, 0, 0, 0, 0, 0, 0, 0, 0, 0, 0, 0, 0, 0, 0, 0, 3539328, 131456, 2373632
.long 0, 0, 3539456, 131616, 2372608, 3539584, 131744, 2716672, 0, 0, 0, 0, 0, 0, 0, 0, 0, 0, 0, 0, 0, 0, 0, 0, 0, 0, 0, 0, 0, 3539328, 131488, 2374656
.long 0, 0, 3539456, 131648, 2727936, 3539584, 131776, 2717696, 0, 0, 0, 0, 0, 0, 0, 0, 0, 0, 0, 0, 0, 0, 0, 0, 0, 0, 0, 0, 0, 3539328, 131520, 2375680
.long 0, 0, 3539456, 131680, 2728960, 3539584, 131808, 2718720, 0, 0, 0, 0, 0, 0, 0, 0, 0, 0, 0, 0, 0, 0, 0, 0, 0, 0, 0, 0, 0, 3539328, 131552, 2376704
.long 0, 0, 3540608, 132736, 3084288, 3540736, 132864, 3428352, 0, 0, 0, 0, 0, 0, 0, 0, 0, 0, 0, 0, 0, 0, 0, 0, 0, 0, 0, 0, 0, 3540480, 132608, 3086336
.long 0, 0, 3540608, 132768, 3085312, 3540736, 132896, 3429376, 0, 0, 0, 0, 0, 0, 0, 0, 0, 0, 0, 0, 0, 0, 0, 0, 0, 0, 0, 0, 0, 3540480, 132640, 3087360
.long 0, 0, 3540608, 132800, 3440640, 3540736, 132928, 3430400, 0, 0, 0, 0, 0, 0, 0, 0, 0, 0, 0, 0, 0, 0, 0, 0, 0, 0, 0, 0, 0, 3540480, 132672, 3088384
.long 0, 0, 3540608, 132832, 3441664, 3540736, 132960, 3431424, 0, 0, 0, 0, 0, 0, 0, 0, 0, 0, 0, 0, 0, 0, 0, 0, 0, 0, 0, 0, 0, 3540480, 132704, 3089408
.long 0, 0, 3541760, 133888, 3796992, 3541888, 134016, 4141056, 0, 0, 0, 0, 0, 0, 0, 0, 0, 0, 0, 0, 0, 0, 0, 0, 0, 0, 0, 0, 0, 3541632, 133760, 3799040
.long 0, 0, 3541760, 133920, 3798016, 3541888, 134048, 4142080, 0, 0, 0, 0, 0, 0, 0, 0, 0, 0, 0, 0, 0, 0, 0, 0, 0, 0, 0, 0, 0, 3541632, 133792, 3800064
.long 0, 0, 3541760, 133952, 4153344, 3541888, 134080, 4143104, 0, 0, 0, 0, 0, 0, 0, 0, 0, 0, 0, 0, 0, 0, 0, 0, 0, 0, 0, 0, 0, 3541632, 133824, 3801088
.long 0, 0, 3541760, 133984, 4154368, 3541888, 134112, 4144128, 0, 0, 0, 0, 0, 0, 0, 0, 0, 0, 0, 0, 0, 0, 0, 0, 0, 0, 0, 0, 0, 3541632, 133856, 3802112
.long 0, 0, 3542912, 135040, 4509696, 3543040, 135168, 4853760, 0, 0, 0, 0, 0, 0, 0, 0, 0, 0, 0, 0, 0, 0, 0, 0, 0, 0, 0, 0, 0, 3542784, 134912, 4511744
.long 0, 0, 3542912, 135072, 4510720, 3543040, 135200, 4854784, 0, 0, 0, 0, 0, 0, 0, 0, 0, 0, 0, 0, 0, 0, 0, 0, 0, 0, 0, 0, 0, 3542784, 134944, 4512768
.long 0, 0, 3542912, 135104, 4866048, 3543040, 135232, 4855808, 0, 0, 0, 0, 0, 0, 0, 0, 0, 0, 0, 0, 0, 0, 0, 0, 0, 0, 0, 0, 0, 3542784, 134976, 4513792
.long 0, 0, 3542912, 135136, 4867072, 3543040, 135264, 4856832, 0, 0, 0, 0, 0, 0, 0, 0, 0, 0, 0, 0, 0, 0, 0, 0, 0, 0, 0, 0, 0, 3542784, 135008, 4514816
.long 0, 0, 3544064, 136192, 5222400, 3544192, 136320, 5566464, 0, 0, 0, 0, 0, 0, 0, 0, 0, 0, 0, 0, 0, 0, 0, 0, 0, 0, 0, 0, 0, 3543936, 136064, 5224448
.long 0, 0, 3544064, 136224, 5223424, 3544192, 136352, 5567488, 0, 0, 0, 0, 0, 0, 0, 0, 0, 0, 0, 0, 0, 0, 0, 0, 0, 0, 0, 0, 0, 3543936, 136096, 5225472
.long 0, 0, 3544064, 136256, 5578752, 3544192, 136384, 5568512, 0, 0, 0, 0, 0, 0, 0, 0, 0, 0, 0, 0, 0, 0, 0, 0, 0, 0, 0, 0, 0, 3543936, 136128, 5226496
.long 0, 0, 3544064, 136288, 5579776, 3544192, 136416, 5569536, 0, 0, 0, 0, 0, 0, 0, 0, 0, 0, 0, 0, 0, 0, 0, 0, 0, 0, 0, 0, 0, 3543936, 136160, 5227520
.long 0, 0, 3545216, 137344, 5935104, 3545344, 137472, 6279168, 0, 0, 0, 0, 0, 0, 0, 0, 0, 0, 0, 0, 0, 0, 0, 0, 0, 0, 0, 0, 0, 3545088, 137216, 5937152
.long 0, 0, 3545216, 137376, 5936128, 3545344, 137504, 6280192, 0, 0, 0, 0, 0, 0, 0, 0, 0, 0, 0, 0, 0, 0, 0, 0, 0, 0, 0, 0, 0, 3545088, 137248, 5938176
.long 0, 0, 3545216, 137408, 6291456, 3545344, 137536, 6281216, 0, 0, 0, 0, 0, 0, 0, 0, 0, 0, 0, 0, 0, 0, 0, 0, 0, 0, 0, 0, 0, 3545088, 137280, 5939200
.long 0, 0, 3545216, 137440, 6292480, 3545344, 137568, 6282240, 0, 0, 0, 0, 0, 0, 0, 0, 0, 0, 0, 0, 0, 0, 0, 0, 0, 0, 0, 0, 0, 3545088, 137312, 5940224
.long 0, 0, 3546368, 138496, 6647808, 3546496, 138624, 6991872, 0, 0, 0, 0, 0, 0, 0, 0, 0, 0, 0, 0, 0, 0, 0, 0, 0, 0, 0, 0, 0, 3546240, 138368, 6649856
.long 0, 0, 3546368, 138528, 6648832, 3546496, 138656, 6992896, 0, 0, 0, 0, 0, 0, 0, 0, 0, 0, 0, 0, 0, 0, 0, 0, 0, 0, 0, 0, 0, 3546240, 138400, 6650880
.long 0, 0, 3546368, 138560, 7004160, 3546496, 138688, 6993920, 0, 0, 0, 0, 0, 0, 0, 0, 0, 0, 0, 0, 0, 0, 0, 0, 0, 0, 0, 0, 0, 3546240, 138432, 6651904
.long 0, 0, 3546368, 138592, 7005184, 3546496, 138720, 6994944, 0, 0, 0, 0, 0, 0, 0, 0, 0, 0, 0, 0, 0, 0, 0, 0, 0, 0, 0, 0, 0, 3546240, 138464, 6652928
.long 0, 0, 3547520, 139648, 7360512, 3547648, 139776, 7704576, 0, 0, 0, 0, 0, 0, 0, 0, 0, 0, 0, 0, 0, 0, 0, 0, 0, 0, 0, 0, 0, 3547392, 139520, 7362560
.long 0, 0, 3547520, 139680, 7361536, 3547648, 139808, 7705600, 0, 0, 0, 0, 0, 0, 0, 0, 0, 0, 0, 0, 0, 0, 0, 0, 0, 0, 0, 0, 0, 3547392, 139552, 7363584
.long 0, 0, 3547520, 139712, 7716864, 3547648, 139840, 7706624, 0, 0, 0, 0, 0, 0, 0, 0, 0, 0, 0, 0, 0, 0, 0, 0, 0, 0, 0, 0, 0, 3547392, 139584, 7364608
.long 0, 0, 3547520, 139744, 7717888, 3547648, 139872, 7707648, 0, 0, 0, 0, 0, 0, 0, 0, 0, 0, 0, 0, 0, 0, 0, 0, 0, 0, 0, 0, 0, 3547392, 139616, 7365632
.long 0, 0, 3539840, 131968, 2723840, 3539968, 132096, 2729984, 0, 0, 0, 0, 0, 0, 0, 0, 0, 0, 0, 0, 0, 0, 0, 0, 0, 0, 0, 0, 0, 3539712, 131840, 2719744
.long 0, 0, 3539840, 132000, 2724864, 3539968, 132128, 2731008, 0, 0, 0, 0, 0, 0, 0, 0, 0, 0, 0, 0, 0, 0, 0, 0, 0, 0, 0, 0, 0, 3539712, 131872, 2720768
.long 0, 0, 3539840, 132032, 2725888, 3539968, 132160, 2732032, 0, 0, 0, 0, 0, 0, 0, 0, 0, 0, 0, 0, 0, 0, 0, 0, 0, 0, 0, 0, 0, 3539712, 131904, 2721792
.long 0, 0, 3539840, 132064, 2726912, 3539968, 132192, 2733056, 0, 0, 0, 0, 0, 0, 0, 0, 0, 0, 0, 0, 0, 0, 0, 0, 0, 0, 0, 0, 0, 3539712, 131936, 2722816
.long 0, 0, 3540992, 133120, 3436544, 3541120, 133248, 3442688, 0, 0, 0, 0, 0, 0, 0, 0, 0, 0, 0, 0, 0, 0, 0, 0, 0, 0, 0, 0, 0, 3540864, 132992, 3432448
.long 0, 0, 3540992, 133152, 3437568, 3541120, 133280, 3443712, 0, 0, 0, 0, 0, 0, 0, 0, 0, 0, 0, 0, 0, 0, 0, 0, 0, 0, 0, 0, 0, 3540864, 133024, 3433472
.long 0, 0, 3540992, 133184, 3438592, 3541120, 133312, 3444736, 0, 0, 0, 0, 0, 0, 0, 0, 0, 0, 0, 0, 0, 0, 0, 0, 0, 0, 0, 0, 0, 3540864, 133056, 3434496
.long 0, 0, 3540992, 133216, 3439616, 3541120, 133344, 3445760, 0, 0, 0, 0, 0, 0, 0, 0, 0, 0, 0, 0, 0, 0, 0, 0, 0, 0, 0, 0, 0, 3540864, 133088, 3435520
.long 0, 0, 3542144, 134272, 4149248, 3542272, 134400, 4155392, 0, 0, 0, 0, 0, 0, 0, 0, 0, 0, 0, 0, 0, 0, 0, 0, 0, 0, 0, 0, 0, 3542016, 134144, 4145152
.long 0, 0, 3542144, 134304, 4150272, 3542272, 134432, 4156416, 0, 0, 0, 0, 0, 0, 0, 0, 0, 0, 0, 0, 0, 0, 0, 0, 0, 0, 0, 0, 0, 3542016, 134176, 4146176
.long 0, 0, 3542144, 134336, 4151296, 3542272, 134464, 4157440, 0, 0, 0, 0, 0, 0, 0, 0, 0, 0, 0, 0, 0, 0, 0, 0, 0, 0, 0, 0, 0, 3542016, 134208, 4147200
.long 0, 0, 3542144, 134368, 4152320, 3542272, 134496, 4158464, 0, 0, 0, 0, 0, 0, 0, 0, 0, 0, 0, 0, 0, 0, 0, 0, 0, 0, 0, 0, 0, 3542016, 134240, 4148224
.long 0, 0, 3543296, 135424, 4861952, 3543424, 135552, 4868096, 0, 0, 0, 0, 0, 0, 0, 0, 0, 0, 0, 0, 0, 0, 0, 0, 0, 0, 0, 0, 0, 3543168, 135296, 4857856
.long 0, 0, 3543296, 135456, 4862976, 3543424, 135584, 4869120, 0, 0, 0, 0, 0, 0, 0, 0, 0, 0, 0, 0, 0, 0, 0, 0, 0, 0, 0, 0, 0, 3543168, 135328, 4858880
.long 0, 0, 3543296, 135488, 4864000, 3543424, 135616, 4870144, 0, 0, 0, 0, 0, 0, 0, 0, 0, 0, 0, 0, 0, 0, 0, 0, 0, 0, 0, 0, 0, 3543168, 135360, 4859904
.long 0, 0, 3543296, 135520, 4865024, 3543424, 135648, 4871168, 0, 0, 0, 0, 0, 0, 0, 0, 0, 0, 0, 0, 0, 0, 0, 0, 0, 0, 0, 0, 0, 3543168, 135392, 4860928
.long 0, 0, 3544448, 136576, 5574656, 3544576, 136704, 5580800, 0, 0, 0, 0, 0, 0, 0, 0, 0, 0, 0, 0, 0, 0, 0, 0, 0, 0, 0, 0, 0, 3544320, 136448, 5570560
.long 0, 0, 3544448, 136608, 5575680, 3544576, 136736, 5581824, 0, 0, 0, 0, 0, 0, 0, 0, 0, 0, 0, 0, 0, 0, 0, 0, 0, 0, 0, 0, 0, 3544320, 136480, 5571584
.long 0, 0, 3544448, 136640, 5576704, 3544576, 136768, 5582848, 0, 0, 0, 0, 0, 0, 0, 0, 0, 0, 0, 0, 0, 0, 0, 0, 0, 0, 0, 0, 0, 3544320, 136512, 5572608
.long 0, 0, 3544448, 136672, 5577728, 3544576, 136800, 5583872, 0, 0, 0, 0, 0, 0, 0, 0, 0, 0, 0, 0, 0, 0, 0, 0, 0, 0, 0, 0, 0, 3544320, 136544, 5573632
.long 0, 0, 3545600, 137728, 6287360, 3545728, 137856, 6293504, 0, 0, 0, 0, 0, 0, 0, 0, 0, 0, 0, 0, 0, 0, 0, 0, 0, 0, 0, 0, 0, 3545472, 137600, 6283264
.long 0, 0, 3545600, 137760, 6288384, 3545728, 137888, 6294528, 0, 0, 0, 0, 0, 0, 0, 0, 0, 0, 0, 0, 0, 0, 0, 0, 0, 0, 0, 0, 0, 3545472, 137632, 6284288
.long 0, 0, 3545600, 137792, 6289408, 3545728, 137920, 6295552, 0, 0, 0, 0, 0, 0, 0, 0, 0, 0, 0, 0, 0, 0, 0, 0, 0, 0, 0, 0, 0, 3545472, 137664, 6285312
.long 0, 0, 3545600, 137824, 6290432, 3545728, 137952, 6296576, 0, 0, 0, 0, 0, 0, 0, 0, 0, 0, 0, 0, 0, 0, 0, 0, 0, 0, 0, 0, 0, 3545472, 137696, 6286336
.long 0, 0, 3546752, 138880, 7000064, 3546880, 139008, 7006208, 0, 0, 0, 0, 0, 0, 0, 0, 0, 0, 0, 0, 0, 0, 0, 0, 0, 0, 0, 0, 0, 3546624, 138752, 6995968
.long 0, 0, 3546752, 138912, 7001088, 3546880, 139040, 7007232, 0, 0, 0, 0, 0, 0, 0, 0, 0, 0, 0, 0, 0, 0, 0, 0, 0, 0, 0, 0, 0, 3546624, 138784, 6996992
.long 0, 0, 3546752, 138944, 7002112, 3546880, 139072, 7008256, 0, 0, 0, 0, 0, 0, 0, 0, 0, 0, 0, 0, 0, 0, 0, 0, 0, 0, 0, 0, 0, 3546624, 138816, 6998016
.long 0, 0, 3546752, 138976, 7003136, 3546880, 139104, 7009280, 0, 0, 0, 0, 0, 0, 0, 0, 0, 0, 0, 0, 0, 0, 0, 0, 0, 0, 0, 0, 0, 3546624, 138848, 6999040
.long 0, 0, 3547904, 140032, 7712768, 3548032, 140160, 7718912, 0, 0, 0, 0, 0, 0, 0, 0, 0, 0, 0, 0, 0, 0, 0, 0, 0, 0, 0, 0, 0, 3547776, 139904, 7708672
.long 0, 0, 3547904, 140064, 7713792, 3548032, 140192, 7719936, 0, 0, 0, 0, 0, 0, 0, 0, 0, 0, 0, 0, 0, 0, 0, 0, 0, 0, 0, 0, 0, 3547776, 139936, 7709696
.long 0, 0, 3547904, 140096, 7714816, 3548032, 140224, 7720960, 0, 0, 0, 0, 0, 0, 0, 0, 0, 0, 0, 0, 0, 0, 0, 0, 0, 0, 0, 0, 0, 3547776, 139968, 7710720
.long 0, 0, 3547904, 140128, 7715840, 3548032, 140256, 7721984, 0, 0, 0, 0, 0, 0, 0, 0, 0, 0, 0, 0, 0, 0, 0, 0, 0, 0, 0, 0, 0, 3547776, 140000, 7711744
.size T_w, .-T_w
.section .rodata,"a"
.p2align 6
.amdhsa_kernel sequential_preLN__ssm_conv_s4d__dense_activation_squared_relu__prompt_kernel
  .amdhsa_next_free_vgpr 512
  .amdhsa_next_free_sgpr 102
  .amdhsa_accum_offset 256
  .amdhsa_group_segment_fixed_size 0
  .amdhsa_kernarg_size 120
  .amdhsa_user_sgpr_count 2
  .amdhsa_user_sgpr_kernarg_segment_ptr 1
  .amdhsa_system_sgpr_workgroup_id_x 1
.end_amdhsa_kernel
```
